```python
import torch

def _softmax(x, axis=-1):
    return torch.softmax(x, dim=axis)

def _gelu(x):
    return torch.nn.functional.gelu(x, approximate='tanh')

def _silu(x):
    return torch.nn.functional.silu(x)

def _sigmoid(x):
    return torch.sigmoid(x)

def _layernorm(x, axis=-1, eps=1e-05):
    m = x.mean(dim=axis, keepdim=True)
    v = x.var(dim=axis, keepdim=True, unbiased=False)
    return (x - m) / torch.sqrt(v + eps)

def _scatter_add(tgt, idx, src, axis=0):
    return tgt.clone().index_add_(axis, idx, src)

def _segment_sum(src, seg, n):
    out = torch.zeros((n,) + src.shape[1:], dtype=src.dtype)
    return out.index_add_(0, seg, src)

def _pad(x, pw):
    flat = tuple((v for pair in reversed(pw) for v in pair))
    return torch.nn.functional.pad(x, flat)
kernel_name = 'adaLN_cond__linear_kernel_hedgehog__glu_gated_swiglu__prompt'

def setup_inputs():

    _w = lambda a: (lambda t: t.to(torch.bfloat16) if t.is_floating_point() else t)(torch.as_tensor(a))

    def _A_setup():
        B, S, D, H = (1, 2048, 640, 32)
        Dh = D // H
        return {'x': _w((lambda *s: torch.randn(*s, dtype=torch.bfloat16) * 0.05)(B, S, D)), 'wqkv': _w((lambda *s: torch.randn(*s, dtype=torch.bfloat16) * 0.4)(D, 3 * D)), 'w_phi': _w((lambda *s: torch.randn(*s, dtype=torch.bfloat16) * 0.4)(H, Dh, Dh) * Dh ** (-0.5)), 'wo': _w((lambda *s: torch.randn(*s, dtype=torch.bfloat16) * 0.05)(D, D))}
    _A_in = _A_setup()

    def _B_setup():
        B, S, D, F = (1, 2048, 640, 1728)
        return {'x': _w((lambda *s: torch.randn(*s, dtype=torch.bfloat16) * 0.05)(B, S, D)), 'w1': _w((lambda *s: torch.randn(*s, dtype=torch.bfloat16) * 0.8)(D, F) * (2.0 / D) ** 0.5), 'w3': _w((lambda *s: torch.randn(*s, dtype=torch.bfloat16) * 0.8)(D, F) * (2.0 / D) ** 0.5), 'w2': _w((lambda *s: torch.randn(*s, dtype=torch.bfloat16) * 0.8)(F, D) * (2.0 / F) ** 0.5)}
    _B_in = _B_setup()
    return {'A_x': _A_in['x'], 'A_wqkv': _A_in['wqkv'], 'A_w_phi': _A_in['w_phi'], 'A_wo': _A_in['wo'], 'B_x': _B_in['x'], 'B_w1': _B_in['w1'], 'B_w3': _B_in['w3'], 'B_w2': _B_in['w2'], 'c': _w((lambda *s: torch.randn(*s, dtype=torch.bfloat16) * 0.2)(1, 640) * 8.0), 'w_mod': _w((lambda *s: torch.randn(*s, dtype=torch.bfloat16) * 0.2)(640, 6 * 640) * 640 ** (-0.5) * 8.0)}

def reference(A_x, A_wqkv, A_w_phi, A_wo, B_x, B_w1, B_w3, B_w2, c, w_mod):

    def _A_ref(x, wqkv, w_phi, wo):
        B, S, D = x.shape
        H = 32
        Dh = D // H
        qkv = (lambda x, *d: x.permute(*d))((x @ wqkv).reshape(B, S, 3, H, Dh), 2, 0, 3, 1, 4)
        q, k, v = (qkv[0], qkv[1], qkv[2])
        pq = torch.einsum('bhsd,hdf->bhsf', q, w_phi)
        pk = torch.einsum('bhsd,hdf->bhsf', k, w_phi)
        phi_q = torch.concatenate([_softmax(pq, axis=-1), _softmax(-pq, axis=-1)], axis=-1)
        phi_k = torch.concatenate([_softmax(pk, axis=-1), _softmax(-pk, axis=-1)], axis=-1)
        kv = torch.einsum('bhsf,bhsd->bhfd', phi_k, v)
        z = torch.einsum('bhsf->bhf', phi_k)
        num = torch.einsum('bhqf,bhfd->bhqd', phi_q, kv)
        den = torch.einsum('bhqf,bhf->bhq', phi_q, z)[..., None] + 1e-06
        o = num / den
        return (lambda x, *d: x.permute(*d))(o, 0, 2, 1, 3).reshape(B, S, D) @ wo

    def _B_ref(x, w1, w3, w2):
        gate = torch.einsum('bsd,df->bsf', x, w1)
        up = torch.einsum('bsd,df->bsf', x, w3)
        h = _silu(gate) * up
        out = torch.einsum('bsf,fd->bsd', h, w2)
        return out
    x = A_x
    mod = (_silu(c) @ w_mod).reshape(c.shape[0], 6, 1, -1)
    sa, ca, ga, sb, cb, gb = (mod[:, 0].clone(), mod[:, 1].clone(), mod[:, 2].clone(), mod[:, 3].clone(), mod[:, 4].clone(), mod[:, 5].clone())
    h = _layernorm(x, axis=-1) * (1 + ca) + sa
    x = x + ga * _A_ref(h, A_wqkv, A_w_phi, A_wo)
    h = _layernorm(x, axis=-1) * (1 + cb) + sb
    x = x + gb * _B_ref(h, B_w1, B_w3, B_w2)
    return x
```

```asm
; @launch grid=(256,1,1) block=(256,1,1) lds=163840
.amdgcn_target "amdgcn-amd-amdhsa--gfx950"
.text
.globl adaLN_cond__linear_kernel_hedgehog__glu_gated_swiglu__prompt_kernel
.p2align 8
.type adaLN_cond__linear_kernel_hedgehog__glu_gated_swiglu__prompt_kernel,@function
adaLN_cond__linear_kernel_hedgehog__glu_gated_swiglu__prompt_kernel:
    s_cmp_ge_u32 s2, 256
    s_cbranch_scc1 L_end
    s_getpc_b64 s[48:49]
L_pc:
    s_load_dwordx2 s[20:21], s[0:1], 72
    s_load_dwordx2 s[24:25], s[0:1], 64
    s_load_dwordx2 s[16:17], s[0:1], 8
    s_load_dwordx2 s[28:29], s[0:1], 16
    s_load_dwordx2 s[8:9], s[0:1], 0
    s_load_dwordx2 s[4:5], s[0:1], 96
    s_load_dwordx2 s[32:33], s[0:1], 24
    s_load_dwordx2 s[64:65], s[0:1], 56
    s_load_dwordx2 s[12:13], s[0:1], 80
    s_load_dwordx4 s[68:71], s[0:1], 40
    s_lshr_b32 s47, s2, 3
    s_lshl_b32 s50, s47, 11
    v_lshl_add_u32 v16, v0, 3, s50
    v_min_u32 v16, L_code_end-L_pc-8, v16
    v_mov_b32 v19, s49
    v_add_co_u32 v18, vcc, s48, v16
    s_nop 1
    v_addc_co_u32 v19, vcc, 0, v19, vcc
    global_load_dwordx2 v[214:215], v[18:19], off
    v_lshrrev_b32 v16, 6, v0
    v_and_b32 v1, 63, v0
    v_readfirstlane_b32 s42, v16
    v_lshlrev_b32 v2, 4, v1
    s_mov_b32 s100, 0x7f000000
    s_mov_b32 s26, 1280
    s_mov_b32 s27, 0x20000
    s_mov_b32 s10, 2621440
    s_mov_b32 s11, 0x20000
    s_mov_b32 s22, 4915200
    s_mov_b32 s23, 0x20000
    s_lshr_b32 s43, s47, 3
    s_and_b32 s56, s2, 7
    s_lshr_b32 s56, s56, 1
    s_lshl2_add_u32 s43, s56, s43
    s_and_b32 s44, s47, 7
    s_and_b32 s56, s2, 1
    s_lshl3_add_u32 s44, s56, s44
    s_mul_i32 s3, s42, 0x1400
    v_lshlrev_b32 v212, 1, v0
    v_and_b32 v30, 7, v1
    v_mul_u32_u24 v30, 0x500, v30
    v_lshrrev_b32 v16, 3, v1
    v_lshl_add_u32 v30, v16, 4, v30
    s_lshl4_add_u32 s54, s43, s44
    s_mul_i32 s54, s54, 0x2800
    s_lshl_b32 s56, s42, 7
    s_add_u32 s54, s54, s56
    s_cmp_lt_u32 s42, 2
    s_cselect_b32 s55, s54, s100
    s_cmp_ge_u32 s2, 96
    s_cbranch_scc1 L_role_b
    s_mul_i32 s50, s2, 0xccd
    s_lshr_b32 s50, s50, 16
    s_mul_i32 s56, s50, 20
    s_sub_u32 s51, s2, s56
    s_lshl2_add_u32 s91, s50, s42
    s_mul_i32 s91, s91, 0x4b000
    s_lshl_b32 s56, s51, 7
    s_add_u32 s91, s91, s56
    v_lshrrev_b32 v210, 3, v1
    v_mul_u32_u24 v210, 0x1e00, v210
    s_and_b32 s56, s42, 1
    s_lshl_b32 s56, s56, 2
    v_bfe_u32 v17, v1, 4, 1
    v_lshlrev_b32 v17, 1, v17
    v_and_b32 v16, 7, v1
    v_xor_b32 v16, v16, v17
    v_xor_b32 v16, s56, v16
    v_lshl_add_u32 v210, v16, 4, v210
    v_xor_b32 v211, 64, v210
    s_waitcnt lgkmcnt(0)
    s_mov_b32 s1, s50
    s_mov_b32 s0, s51
    s_mul_i32 s50, s1, 0x140
    buffer_load_ushort v209, v212, s[24:27], s50 offen
    s_add_u32 m0, s3, 0
    s_nop 0
    buffer_load_dwordx4 v210, s[20:23], s91 offen lds
    s_add_u32 s91, s91, 61440
    s_add_u32 m0, s3, 1024
    s_nop 0
    buffer_load_dwordx4 v211, s[20:23], s91 offen lds
    s_add_u32 s91, s91, 61440
    s_add_u32 m0, s3, 2048
    s_nop 0
    buffer_load_dwordx4 v210, s[20:23], s91 offen lds
    s_add_u32 s91, s91, 61440
    s_add_u32 m0, s3, 3072
    s_nop 0
    buffer_load_dwordx4 v211, s[20:23], s91 offen lds
    s_add_u32 s91, s91, 61440
    s_add_u32 m0, s3, 4096
    s_nop 0
    buffer_load_dwordx4 v210, s[20:23], s91 offen lds
    buffer_load_dwordx4 v[32:35], v30, s[8:11], s54 offen
    buffer_load_dwordx4 v[36:39], v30, s[8:11], s54 offen offset:512
    buffer_load_dwordx4 v[40:43], v30, s[8:11], s55 offen offset:1024
    s_mov_b32 s66, 2211840
    s_mov_b32 s67, 0x20000
    s_cmp_lt_u32 s2, 40
    s_cselect_b64 s[32:33], s[32:33], s[64:65]
    s_mov_b32 s34, 2211840
    s_cselect_b32 s34, 819200, s34
    s_mov_b32 s35, 0x20000
    v_add_u32 v16, 0, v1
    v_lshlrev_b32 v140, 4, v16
    v_mul_u32_u24 v17, 0x667, v16
    v_lshrrev_b32 v17, 16, v17
    v_mul_u32_u24 v17, 0x280, v17
    v_add_u32 v140, v140, v17
    v_add_u32 v16, 64, v1
    v_lshlrev_b32 v141, 4, v16
    v_mul_u32_u24 v17, 0x667, v16
    v_lshrrev_b32 v17, 16, v17
    v_mul_u32_u24 v17, 0x280, v17
    v_add_u32 v141, v141, v17
    v_add_u32 v16, 128, v1
    v_lshlrev_b32 v142, 4, v16
    v_mul_u32_u24 v17, 0x667, v16
    v_lshrrev_b32 v17, 16, v17
    v_mul_u32_u24 v17, 0x280, v17
    v_add_u32 v142, v142, v17
    v_add_u32 v16, 192, v1
    v_lshlrev_b32 v143, 4, v16
    v_mul_u32_u24 v17, 0x667, v16
    v_lshrrev_b32 v17, 16, v17
    v_mul_u32_u24 v17, 0x280, v17
    v_add_u32 v143, v143, v17
    v_add_u32 v16, 256, v1
    v_lshlrev_b32 v144, 4, v16
    v_mul_u32_u24 v17, 0x667, v16
    v_lshrrev_b32 v17, 16, v17
    v_mul_u32_u24 v17, 0x280, v17
    v_add_u32 v144, v144, v17
    s_cmp_lt_u32 s2, 20
    s_cselect_b32 s56, 0, 1
    s_cmp_lt_u32 s2, 0x44
    s_cselect_b32 s57, 0, 1
    s_cmp_lt_u32 s2, 40
    s_cselect_b32 s52, s56, s57
    s_mul_i32 s56, s52, 28
    s_sub_u32 s48, s2, s56
    s_add_u32 s48, s48, 0xffffffd8
    s_mul_i32 s57, s52, 20
    s_sub_u32 s56, s2, s57
    s_mul_i32 s57, s48, 37
    s_lshr_b32 s57, s57, 8
    s_add_u32 s57, s57, s48
    s_cmp_lt_u32 s2, 40
    s_cselect_b32 s50, s56, s57
    s_mov_b32 s57, 0x43800
    s_cmp_lt_u32 s2, 40
    s_cselect_b32 s49, 0x19000, s57
    s_lshl2_add_u32 s92, s50, s42
    s_mul_i32 s92, s92, 0x2800
    s_mul_i32 s56, s52, 0x280
    s_add_u32 s92, s92, s56
    s_mul_i32 s94, s50, 0x1400
    s_lshl_b32 s56, s42, 8
    s_add_u32 s94, s94, s56
    s_mov_b32 s58, 0x1130000
    s_cmp_lt_u32 s2, 40
    s_cselect_b32 s56, 0xc20000, s58
    s_add_u32 s94, s94, s56
    s_mul_i32 s56, s52, s49
    s_lshl2_add_u32 s94, s56, s94
    s_add_u32 m0, s3, 20480
    s_nop 0
    buffer_load_dwordx4 v140, s[32:35], s92 offen lds
    s_add_u32 m0, s3, 21504
    s_nop 0
    buffer_load_dwordx4 v141, s[32:35], s92 offen lds
    s_add_u32 m0, s3, 22528
    s_nop 0
    buffer_load_dwordx4 v142, s[32:35], s92 offen lds
    s_add_u32 m0, s3, 23552
    s_nop 0
    buffer_load_dwordx4 v143, s[32:35], s92 offen lds
    s_add_u32 m0, s3, 24576
    s_nop 0
    buffer_load_dwordx4 v144, s[32:35], s92 offen lds
    s_load_dword s40, s[4:5], 0
    s_mov_b32 s6, 27590656
    s_mov_b32 s7, 0x20000
    s_mov_b32 s62, 0x3fb8aa3b
    s_mov_b32 s63, 0x3fb8aa3b
    s_mov_b32 s14, 2621440
    s_mov_b32 s15, 0x20000
    s_mov_b32 s38, 2211840
    s_mov_b32 s39, 0x20000
    s_lshr_b32 s45, s47, 3
    s_and_b32 s56, s2, 7
    s_lshr_b32 s56, s56, 0
    s_lshl2_add_u32 s45, s56, s45
    s_and_b32 s46, s47, 7
    s_mul_i32 s56, s2, 36
    s_mul_i32 s57, s42, 9
    s_add_u32 s56, s56, s57
    v_add_u32 v17, s56, v1
    v_lshlrev_b32 v17, 7, v17
    v_add_u32 v17, 0x10000, v17
    s_lshl4_add_u32 s56, s44, s43
    s_mul_i32 s56, s56, 0xe00
    s_add_u32 s56, s56, 0x12fb80
    s_mul_i32 s57, s42, 7
    v_min_u32 v18, 15, v1
    v_add_u32 v18, s57, v18
    v_lshl_add_u32 v18, v18, 7, s56
    v_cmp_gt_u32 vcc, 9, v1
    s_nop 1
    v_cndmask_b32 v16, v18, v17, vcc
    s_mov_b64 exec, 0xffff
    buffer_load_dword v213, v16, s[4:7], 0 offen
    s_mov_b64 exec, -1
    v_and_b32 v16, 15, v1
    v_mul_u32_u24 v16, 1280, v16
    v_lshrrev_b32 v18, 4, v1
    v_mul_u32_u24 v17, 40, v18
    v_add_u32 v17, v17, v16
    v_and_b32 v18, 1, v18
    v_lshl_add_u32 v16, v18, 3, v17
    v_xor_b32 v18, 1, v18
    v_lshl_add_u32 v17, v18, 5, v17
    s_lshl2_add_u32 s101, s45, s42
    s_mul_i32 s101, s101, 0x5000
    s_mul_i32 s56, s46, 0xa0
    s_add_u32 s101, s101, s56
    buffer_load_dwordx4 v[4:7], v16, s[8:11], s101 offen
    buffer_load_dwordx4 v[8:11], v16, s[8:11], s101 offen offset:16
    buffer_load_dwordx2 v[12:13], v17, s[8:11], s101 offen
    s_bitcmp1_b32 s2, 0
    s_cselect_b64 s[36:37], s[70:71], s[68:69]
    s_mul_i32 s56, s1, 0x3c00
    s_lshl_b32 s57, s0, 8
    s_add_u32 s56, s56, s57
    s_lshl_b32 s57, s42, 6
    s_add_u32 s56, s56, s57
    s_add_u32 s56, s56, 0x10000
    s_cmp_lt_u32 s1, 4
    s_cselect_b32 s97, s56, s100
    v_bfe_u32 v208, v1, 2, 2
    v_lshrrev_b32 v16, 4, v1
    v_lshl_add_u32 v208, v16, 3, v208
    v_lshlrev_b32 v208, 7, v208
    v_bfe_u32 v16, v1, 3, 1
    v_bfe_u32 v17, v1, 4, 1
    v_lshl_add_u32 v16, v17, 1, v16
    v_xor_b32 v16, s42, v16
    v_lshl_add_u32 v208, v16, 5, v208
    v_and_b32 v16, 3, v1
    v_lshl_add_u32 v208, v16, 3, v208
    s_waitcnt lgkmcnt(0)
    s_add_u32 s40, s40, 0x9e3779b9
    s_mov_b32 s41, s40
    s_and_b32 s76, s40, 0xff
    s_bfe_u32 s77, s40, 0x80008
    s_bfe_u32 s78, s40, 0x80010
    s_lshr_b32 s79, s40, 24
    s_waitcnt vmcnt(17)
    v_lshlrev_b32 v209, 16, v209
    v_mul_f32 v16, 0xbfb8aa3b, v209
    v_exp_f32 v16, v16
    s_nop 0
    v_add_f32 v16, 1.0, v16
    v_rcp_f32 v16, v16
    s_nop 0
    v_mul_f32 v209, v16, v209
    v_cvt_pk_bf16_f32 v209, v209, v209
    ds_write_b16 v212, v209 offset:43008
    s_cmp_lt_u32 s2, 0x46
    s_cselect_b32 s52, 1, 0
    s_mul_i32 s56, s52, 26
    s_sub_u32 s48, 0x5f, s2
    s_sub_u32 s48, s48, s56
    s_lshl_b32 s56, s48, 3
    s_add_u32 s56, s56, 7
    s_add_u32 s57, s48, 28
    s_cmp_lt_u32 s48, 4
    s_cselect_b32 s50, s56, s57
    s_lshl2_add_u32 s57, s50, s42
    s_mul_i32 s57, s57, 0x2800
    s_mul_i32 s58, s52, 0x280
    s_add_u32 s57, s57, s58
    s_cmp_lt_u32 s2, 44
    s_cselect_b32 s93, s100, s57
    s_mul_i32 s57, s52, 0x10e000
    s_mul_i32 s58, s50, 0x1400
    s_add_u32 s57, s57, s58
    s_lshl_b32 s58, s42, 8
    s_add_u32 s57, s57, s58
    s_add_u32 s57, s57, 0x1130000
    s_cmp_lt_u32 s2, 44
    s_cselect_b32 s95, s100, s57
    s_waitcnt vmcnt(12)
    s_waitcnt lgkmcnt(0)
    s_barrier
    v_and_b32 v24, 48, v1
    ds_read_b128 v[84:87], v24 offset:43008
    ds_read_b128 v[88:91], v24 offset:43072
    ds_read_b128 v[92:95], v24 offset:43136
    ds_read_b128 v[96:99], v24 offset:43200
    ds_read_b128 v[100:103], v24 offset:43264
    v_and_b32 v24, 48, v1
    ds_read_b64_tr_b16 v[44:45], v208
    ds_read_b64_tr_b16 v[46:47], v208 offset:512
    ds_read_b64_tr_b16 v[48:49], v208 offset:4096
    ds_read_b64_tr_b16 v[50:51], v208 offset:4608
    ds_read_b64_tr_b16 v[52:53], v208 offset:8192
    ds_read_b64_tr_b16 v[54:55], v208 offset:8704
    ds_read_b64_tr_b16 v[56:57], v208 offset:12288
    ds_read_b64_tr_b16 v[58:59], v208 offset:12800
    ds_read_b64_tr_b16 v[60:61], v208 offset:16384
    ds_read_b64_tr_b16 v[62:63], v208 offset:16896
    s_waitcnt lgkmcnt(8)
    v_mfma_f32_16x16x32_bf16 v[26:29], v[44:47], v[84:87], 0
    s_waitcnt lgkmcnt(6)
    v_mfma_f32_16x16x32_bf16 v[26:29], v[48:51], v[88:91], v[26:29]
    s_waitcnt lgkmcnt(4)
    v_mfma_f32_16x16x32_bf16 v[26:29], v[52:55], v[92:95], v[26:29]
    s_waitcnt lgkmcnt(2)
    v_mfma_f32_16x16x32_bf16 v[26:29], v[56:59], v[96:99], v[26:29]
    s_waitcnt lgkmcnt(0)
    v_mfma_f32_16x16x32_bf16 v[26:29], v[60:63], v[100:103], v[26:29]
    s_nop 7
    v_add_u32 v26, 0x80, v26
    v_add_u32 v27, 0x80, v27
    v_add_u32 v28, 0x80, v28
    v_add_u32 v29, 0x80, v29
    v_and_b32 v26, 0xffffff00, v26
    v_and_b32 v27, 0xffffff00, v27
    v_and_b32 v28, 0xffffff00, v28
    v_and_b32 v29, 0xffffff00, v29
    v_or_b32 v26, s76, v26
    v_or_b32 v27, s77, v27
    v_or_b32 v28, s78, v28
    v_or_b32 v29, s79, v29
    s_mov_b32 exec_lo, 0x00010001
    s_mov_b32 exec_hi, 0x00010001
    buffer_store_dwordx4 v[26:29], v24, s[4:7], s97 offen sc1
    s_mov_b64 exec, -1
    s_barrier
    s_add_u32 m0, s3, 0
    s_nop 0
    buffer_load_dwordx4 v140, s[64:67], s93 offen lds
    s_add_u32 m0, s3, 1024
    s_nop 0
    buffer_load_dwordx4 v141, s[64:67], s93 offen lds
    s_add_u32 m0, s3, 2048
    s_nop 0
    buffer_load_dwordx4 v142, s[64:67], s93 offen lds
    s_add_u32 m0, s3, 3072
    s_nop 0
    buffer_load_dwordx4 v143, s[64:67], s93 offen lds
    s_add_u32 m0, s3, 4096
    s_nop 0
    buffer_load_dwordx4 v144, s[64:67], s93 offen lds
    v_bfe_u32 v16, v1, 2, 2
    v_mul_u32_u24 v16, 0x280, v16
    v_add_u32 v16, s3, v16
    v_lshrrev_b32 v17, 4, v1
    v_mul_u32_u24 v17, 0xa0, v17
    v_add_u32 v16, v16, v17
    v_and_b32 v17, 3, v1
    v_mad_u32_u24 v16, v17, 40, v16
    v_and_b32 v204, 1, v1
    v_lshl_add_u32 v204, v204, 3, v16
    v_and_b32 v205, 1, v1
    v_xor_b32 v205, 1, v205
    v_lshl_add_u32 v205, v205, 5, v16
    v_lshrrev_b32 v19, 4, v1
    v_mul_u32_u24 v19, s49, v19
    v_and_b32 v20, 15, v1
    v_lshl_add_u32 v19, v20, 4, v19
    v_lshrrev_b32 v203, 4, v1
    v_mul_u32_u24 v203, 0x43800, v203
    v_and_b32 v21, 15, v1
    v_lshl_add_u32 v203, v21, 4, v203
    s_waitcnt vmcnt(10)
    ds_read_b64_tr_b16 v[96:97], v204 offset:20480
    ds_read_b64_tr_b16 v[98:99], v204 offset:23040
    ds_read_b64_tr_b16 v[100:101], v204 offset:20488
    ds_read_b64_tr_b16 v[102:103], v204 offset:23048
    ds_read_b64_tr_b16 v[104:105], v204 offset:20496
    ds_read_b64_tr_b16 v[106:107], v204 offset:23056
    ds_read_b64_tr_b16 v[108:109], v204 offset:20504
    ds_read_b64_tr_b16 v[110:111], v204 offset:23064
    ds_read_b64_tr_b16 v[112:113], v205 offset:20480
    ds_read_b64_tr_b16 v[114:115], v205 offset:23040
    s_waitcnt lgkmcnt(8)
    buffer_store_dwordx4 v[96:99], v19, s[4:7], s94 offen sc1
    s_waitcnt lgkmcnt(6)
    buffer_store_dwordx4 v[100:103], v19, s[4:7], s94 offen offset:1024 sc1
    s_waitcnt lgkmcnt(4)
    buffer_store_dwordx4 v[104:107], v19, s[4:7], s94 offen offset:2048 sc1
    s_waitcnt lgkmcnt(2)
    buffer_store_dwordx4 v[108:111], v19, s[4:7], s94 offen offset:3072 sc1
    s_add_u32 s94, s94, 4096
    s_waitcnt lgkmcnt(0)
    buffer_store_dwordx4 v[112:115], v19, s[4:7], s94 offen sc1
    s_mov_b32 s88, s100
    s_mov_b32 s97, s100
    s_mov_b32 s90, s100
    s_branch L_join
L_role_b:
    s_mov_b32 s18, 2457600
    s_mov_b32 s19, 0x20000
    s_mov_b32 s30, 25600
    s_mov_b32 s31, 0x20000
    s_add_u32 s52, s2, 0xffffffa0
    s_mul_i32 s48, s52, 0xccd
    s_lshr_b32 s48, s48, 16
    s_mul_i32 s56, s48, 20
    s_sub_u32 s49, s52, s56
    s_mul_i32 s50, s49, 0x1e000
    s_mul_i32 s56, s48, 0xa0
    s_add_u32 s50, s50, s56
    s_mul_i32 s56, s42, 0x7800
    s_add_u32 s50, s50, s56
    v_add_u32 v19, 0xffffffe2, v1
    v_cmp_gt_u32 vcc, 30, v1
    s_nop 1
    v_cndmask_b32 v17, v19, v1, vcc
    v_mov_b32 v19, 0
    v_mov_b32 v20, 0xf00
    v_cmp_gt_u32 vcc, 30, v1
    s_nop 1
    v_cndmask_b32 v18, v20, v19, vcc
    v_lshl_add_u32 v18, v17, 4, v18
    v_mul_u32_u24 v19, 26, v17
    v_lshrrev_b32 v19, 8, v19
    v_mul_u32_u24 v19, 0x460, v19
    v_add_u32 v18, v18, v19
    v_mov_b32 v19, s100
    v_cmp_gt_u32 vcc, 60, v1
    s_nop 1
    v_cndmask_b32 v24, v19, v18, vcc
    s_lshr_b32 s53, s42, 1
    s_lshl1_add_u32 s53, s48, s53
    s_mul_i32 s53, s53, 0x640
    s_and_b32 s56, s42, 1
    s_lshl_b32 s56, s56, 10
    s_add_u32 s53, s53, s56
    s_mul_i32 m0, s42, 0x1040
    s_waitcnt lgkmcnt(0)
    buffer_load_dwordx4 v24, s[16:19], s50 offen lds
    s_add_u32 s50, s50, 7680
    s_add_u32 m0, m0, 1040
    s_nop 0
    buffer_load_dwordx4 v24, s[16:19], s50 offen lds
    s_add_u32 s50, s50, 7680
    s_add_u32 m0, m0, 1040
    s_nop 0
    buffer_load_dwordx4 v24, s[16:19], s50 offen lds
    s_add_u32 s50, s50, 7680
    s_add_u32 m0, m0, 1040
    s_nop 0
    buffer_load_dwordx4 v24, s[16:19], s50 offen lds
    s_lshr_b32 m0, s42, 1
    s_mul_i32 m0, m0, 0xc00
    s_and_b32 s56, s42, 1
    s_lshl_b32 s56, s56, 10
    s_add_u32 m0, m0, s56
    s_add_u32 m0, m0, 0x4200
    s_nop 0
    buffer_load_dwordx4 v2, s[28:31], s53 offen lds
    buffer_load_dwordx4 v[32:35], v30, s[8:11], s54 offen
    buffer_load_dwordx4 v[36:39], v30, s[8:11], s54 offen offset:512
    buffer_load_dwordx4 v[40:43], v30, s[8:11], s55 offen offset:1024
    s_mul_i32 s1, s52, 0x667
    s_lshr_b32 s1, s1, 16
    s_mul_i32 s56, s1, 40
    s_sub_u32 s0, s52, s56
    s_add_u32 s0, s0, 20
    s_mul_i32 s50, s1, 0x140
    buffer_load_ushort v209, v212, s[24:27], s50 offen
    s_lshl2_add_u32 s90, s1, s42
    s_mul_i32 s90, s90, 0x4b000
    s_lshl_b32 s56, s0, 7
    s_add_u32 s90, s90, s56
    v_lshrrev_b32 v210, 3, v1
    v_mul_u32_u24 v210, 0x1e00, v210
    s_and_b32 s56, s42, 1
    s_lshl_b32 s56, s56, 2
    v_bfe_u32 v17, v1, 4, 1
    v_lshlrev_b32 v17, 1, v17
    v_and_b32 v16, 7, v1
    v_xor_b32 v16, v16, v17
    v_xor_b32 v16, s56, v16
    v_lshl_add_u32 v210, v16, 4, v210
    v_xor_b32 v211, 64, v210
    s_load_dword s40, s[4:5], 0
    s_mov_b32 s6, 27590656
    s_mov_b32 s7, 0x20000
    s_mov_b32 s62, 0x3fb8aa3b
    s_mov_b32 s63, 0x3fb8aa3b
    s_mov_b32 s14, 2621440
    s_mov_b32 s15, 0x20000
    s_mov_b32 s38, 2211840
    s_mov_b32 s39, 0x20000
    s_lshr_b32 s45, s47, 3
    s_and_b32 s56, s2, 7
    s_lshr_b32 s56, s56, 0
    s_lshl2_add_u32 s45, s56, s45
    s_and_b32 s46, s47, 7
    s_mul_i32 s56, s2, 36
    s_mul_i32 s57, s42, 9
    s_add_u32 s56, s56, s57
    v_add_u32 v17, s56, v1
    v_lshlrev_b32 v17, 7, v17
    v_add_u32 v17, 0x10000, v17
    s_lshl4_add_u32 s56, s44, s43
    s_mul_i32 s56, s56, 0xe00
    s_add_u32 s56, s56, 0x12fb80
    s_mul_i32 s57, s42, 7
    v_min_u32 v18, 15, v1
    v_add_u32 v18, s57, v18
    v_lshl_add_u32 v18, v18, 7, s56
    v_cmp_gt_u32 vcc, 9, v1
    s_nop 1
    v_cndmask_b32 v16, v18, v17, vcc
    s_mov_b64 exec, 0xffff
    buffer_load_dword v213, v16, s[4:7], 0 offen
    s_mov_b64 exec, -1
    v_and_b32 v16, 15, v1
    v_mul_u32_u24 v16, 1280, v16
    v_lshrrev_b32 v18, 4, v1
    v_mul_u32_u24 v17, 40, v18
    v_add_u32 v17, v17, v16
    v_and_b32 v18, 1, v18
    v_lshl_add_u32 v16, v18, 3, v17
    v_xor_b32 v18, 1, v18
    v_lshl_add_u32 v17, v18, 5, v17
    s_lshl2_add_u32 s101, s45, s42
    s_mul_i32 s101, s101, 0x5000
    s_mul_i32 s56, s46, 0xa0
    s_add_u32 s101, s101, s56
    buffer_load_dwordx4 v[4:7], v16, s[8:11], s101 offen
    buffer_load_dwordx4 v[8:11], v16, s[8:11], s101 offen offset:16
    buffer_load_dwordx2 v[12:13], v17, s[8:11], s101 offen
    s_bitcmp1_b32 s2, 0
    s_cselect_b64 s[36:37], s[70:71], s[68:69]
    s_mul_i32 s56, s1, 0x3c00
    s_lshl_b32 s57, s0, 8
    s_add_u32 s56, s56, s57
    s_lshl_b32 s57, s42, 6
    s_add_u32 s56, s56, s57
    s_add_u32 s56, s56, 0x10000
    s_cmp_lt_u32 s1, 4
    s_cselect_b32 s97, s56, s100
    v_bfe_u32 v208, v1, 2, 2
    v_lshrrev_b32 v16, 4, v1
    v_lshl_add_u32 v208, v16, 3, v208
    v_lshlrev_b32 v208, 7, v208
    v_bfe_u32 v16, v1, 3, 1
    v_bfe_u32 v17, v1, 4, 1
    v_lshl_add_u32 v16, v17, 1, v16
    v_xor_b32 v16, s42, v16
    v_lshl_add_u32 v208, v16, 5, v208
    v_and_b32 v16, 3, v1
    v_lshl_add_u32 v208, v16, 3, v208
    s_waitcnt lgkmcnt(0)
    s_add_u32 s40, s40, 0x9e3779b9
    s_mov_b32 s41, s40
    s_and_b32 s76, s40, 0xff
    s_bfe_u32 s77, s40, 0x80008
    s_bfe_u32 s78, s40, 0x80010
    s_lshr_b32 s79, s40, 24
    v_mul_u32_u24 v17, 0xc31, v212
    v_lshrrev_b32 v17, 16, v17
    v_mul_u32_u24 v17, 21, v17
    v_sub_u32 v16, v212, v17
    v_mov_b32 v19, 0x3f80
    v_mov_b32 v21, 0x3f800000
    v_cmp_eq_u32 vcc, 20, v16
    s_nop 1
    v_cndmask_b32 v20, 0, v21, vcc
    v_cmp_eq_u32 vcc, 0, v16
    s_nop 1
    v_cndmask_b32 v17, v20, v19, vcc
    v_cmp_gt_u32 vcc, 0xc8, v0
    s_nop 1
    v_cndmask_b32 v18, 0, v17, vcc
    v_lshlrev_b32 v19, 2, v0
    ds_write_b32 v19, v18 offset:18944
    ds_write_b32 v19, v18 offset:22016
    v_bfe_u32 v16, v1, 1, 1
    v_mul_u32_u24 v16, 20, v16
    v_bfe_u32 v20, v1, 2, 2
    v_lshrrev_b32 v17, 4, v1
    v_lshl_add_u32 v20, v17, 3, v20
    v_sub_u32 v20, v20, v16
    v_and_b32 v16, 1, v1
    v_mul_u32_u24 v16, 40, v16
    v_sub_u32 v23, v20, v16
    v_mov_b32 v16, 0x800
    v_bfe_u32 v17, v1, 1, 1
    v_mul_u32_u24 v17, 0x320, v17
    v_and_b32 v18, 1, v1
    v_cmp_eq_u32 vcc, 1, v18
    s_nop 1
    v_cndmask_b32 v22, v17, v16, vcc
    v_add_u32 v16, 32, v22
    s_lshl_b32 s56, s42, 3
    s_add_u32 s56, s56, -8
    v_bfe_u32 v17, v1, 1, 1
    v_mul_u32_u24 v17, 0x320, v17
    v_add_u32 v17, s56, v17
    v_and_b32 v18, 1, v1
    v_mad_u32_u24 v17, v18, 24, v17
    s_cmp_eq_u32 s42, 0
    s_cselect_b64 vcc, -1, 0
    v_cndmask_b32 v21, v17, v16, vcc
    s_cmp_eq_u32 s42, 3
    s_cselect_b32 s56, 0x1000, 0
    v_and_b32 v17, 1, v1
    v_mul_u32_u24 v17, s56, v17
    v_add_u32 v17, v20, v17
    s_cmp_eq_u32 s42, 0
    s_cselect_b64 vcc, -1, 0
    v_cndmask_b32 v20, v17, v23, vcc
    s_lshl_b32 s56, s42, 3
    v_add_u32 v22, s56, v22
    v_mov_b32 v29, 2848
    v_add_u32 v17, 0, v23
    v_mad_u32_u24 v152, v17, 40, v22
    v_cmp_gt_u32 vcc, 20, v17
    s_nop 1
    v_cndmask_b32 v152, v29, v152, vcc
    v_add_u32 v17, 4, v23
    v_mad_u32_u24 v153, v17, 40, v22
    v_cmp_gt_u32 vcc, 20, v17
    s_nop 1
    v_cndmask_b32 v153, v29, v153, vcc
    v_add_u32 v17, 32, v23
    v_mad_u32_u24 v154, v17, 40, v22
    v_cmp_gt_u32 vcc, 20, v17
    s_nop 1
    v_cndmask_b32 v154, v29, v154, vcc
    v_add_u32 v17, 36, v23
    v_mad_u32_u24 v155, v17, 40, v22
    v_cmp_gt_u32 vcc, 20, v17
    s_nop 1
    v_cndmask_b32 v155, v29, v155, vcc
    v_add_u32 v17, 64, v23
    v_mad_u32_u24 v156, v17, 40, v22
    v_cmp_gt_u32 vcc, 20, v17
    s_nop 1
    v_cndmask_b32 v156, v29, v156, vcc
    v_add_u32 v17, 68, v23
    v_mad_u32_u24 v157, v17, 40, v22
    v_cmp_gt_u32 vcc, 20, v17
    s_nop 1
    v_cndmask_b32 v157, v29, v157, vcc
    v_add_u32 v17, 0, v20
    v_mad_u32_u24 v158, v17, 40, v21
    v_cmp_gt_u32 vcc, 20, v17
    s_nop 1
    v_cndmask_b32 v158, v29, v158, vcc
    v_add_u32 v17, 4, v20
    v_mad_u32_u24 v159, v17, 40, v21
    v_cmp_gt_u32 vcc, 20, v17
    s_nop 1
    v_cndmask_b32 v159, v29, v159, vcc
    v_add_u32 v17, 32, v20
    v_mad_u32_u24 v160, v17, 40, v21
    v_cmp_gt_u32 vcc, 20, v17
    s_nop 1
    v_cndmask_b32 v160, v29, v160, vcc
    v_add_u32 v17, 36, v20
    v_mad_u32_u24 v161, v17, 40, v21
    v_cmp_gt_u32 vcc, 20, v17
    s_nop 1
    v_cndmask_b32 v161, v29, v161, vcc
    v_add_u32 v17, 64, v20
    v_mad_u32_u24 v162, v17, 40, v21
    v_cmp_gt_u32 vcc, 20, v17
    s_nop 1
    v_cndmask_b32 v162, v29, v162, vcc
    v_add_u32 v17, 68, v20
    v_mad_u32_u24 v163, v17, 40, v21
    v_cmp_gt_u32 vcc, 20, v17
    s_nop 1
    v_cndmask_b32 v163, v29, v163, vcc
    v_bfe_u32 v17, v1, 1, 1
    v_bfe_u32 v16, v1, 2, 2
    v_lshl_add_u32 v17, v16, 2, v17
    v_mul_u32_u24 v17, 0x410, v17
    v_and_b32 v16, 1, v1
    v_mul_u32_u24 v16, 0x1e0, v16
    v_add_u32 v17, v17, v16
    v_lshrrev_b32 v16, 4, v1
    v_lshl_add_u32 v17, v16, 4, v17
    v_add_u32 v164, 0xa0, v17
    v_mov_b32 v16, 0xe0
    v_mov_b32 v18, 0x130
    v_cmp_gt_u32 vcc, 16, v1
    s_nop 1
    v_cndmask_b32 v165, v18, v16, vcc
    v_add_u32 v165, v17, v165
    v_add_u32 v166, 0x170, v17
    s_cmp_eq_u32 s42, 0
    s_cselect_b64 vcc, -1, 0
    v_cndmask_b32 v167, v17, v164, vcc
    v_add_u32 v18, 64, v17
    s_cmp_eq_u32 s42, 0
    s_cselect_b64 vcc, -1, 0
    v_cndmask_b32 v168, v18, v165, vcc
    v_add_u32 v18, 64, v17
    s_cmp_eq_u32 s42, 0
    s_cselect_b64 vcc, -1, 0
    v_cndmask_b32 v169, v18, v166, vcc
    s_mul_i32 s50, s48, 0x50000
    s_add_u32 s50, s50, 0x220000
    s_mul_i32 s52, s49, 5
    s_add_u32 s52, s52, s42
    s_add_u32 s52, s52, 60
    s_lshl_b32 s52, s52, 10
    s_add_u32 s52, s52, s50
    s_mul_i32 s56, s49, 5
    s_add_u32 s56, s56, 64
    s_mul_i32 s57, s49, 3
    s_add_u32 s57, s57, s42
    s_add_u32 s57, s57, -1
    s_cmp_eq_u32 s42, 0
    s_cselect_b32 s53, s56, s57
    s_lshl_b32 s53, s53, 10
    s_add_u32 s53, s53, s50
    s_mul_i32 s56, s48, 20
    s_add_u32 s56, s56, s49
    s_lshl_b32 s56, s56, 7
    s_add_u32 s56, s56, 0x20000
    s_cmp_eq_u32 s42, 0
    s_cselect_b32 s88, s56, s100
    s_waitcnt vmcnt(8)
    s_waitcnt lgkmcnt(0)
    s_barrier
    ds_read_b64_tr_b16 v[44:45], v152 offset:16896
    ds_read_b64_tr_b16 v[46:47], v153 offset:16896
    ds_read_b128 v[92:95], v164
    ds_read_b128 v[96:99], v164 offset:2080
    ds_read_b64_tr_b16 v[48:49], v154 offset:16896
    ds_read_b64_tr_b16 v[50:51], v155 offset:16896
    ds_read_b128 v[100:103], v165
    ds_read_b128 v[104:107], v165 offset:2080
    ds_read_b64_tr_b16 v[52:53], v156 offset:16896
    ds_read_b64_tr_b16 v[54:55], v157 offset:16896
    ds_read_b128 v[108:111], v166
    ds_read_b128 v[112:115], v166 offset:2080
    ds_read_b64_tr_b16 v[56:57], v158 offset:16896
    ds_read_b64_tr_b16 v[58:59], v159 offset:16896
    ds_read_b128 v[116:119], v167
    ds_read_b128 v[120:123], v167 offset:2080
    s_waitcnt lgkmcnt(12)
    v_mfma_f32_16x16x32_bf16 v[176:179], v[92:95], v[44:47], 0
    v_mfma_f32_16x16x32_bf16 v[180:183], v[96:99], v[44:47], 0
    ds_read_b64_tr_b16 v[60:61], v160 offset:16896
    ds_read_b64_tr_b16 v[62:63], v161 offset:16896
    ds_read_b128 v[124:127], v168
    ds_read_b128 v[128:131], v168 offset:2080
    s_waitcnt lgkmcnt(12)
    v_mfma_f32_16x16x32_bf16 v[176:179], v[100:103], v[48:51], v[176:179]
    v_mfma_f32_16x16x32_bf16 v[180:183], v[104:107], v[48:51], v[180:183]
    ds_read_b64_tr_b16 v[64:65], v162 offset:16896
    ds_read_b64_tr_b16 v[66:67], v163 offset:16896
    ds_read_b128 v[132:135], v169
    ds_read_b128 v[136:139], v169 offset:2080
    s_waitcnt lgkmcnt(12)
    v_mfma_f32_16x16x32_bf16 v[176:179], v[108:111], v[52:55], v[176:179]
    v_mfma_f32_16x16x32_bf16 v[180:183], v[112:115], v[52:55], v[180:183]
    ds_read_b64_tr_b16 v[68:69], v152 offset:19968
    ds_read_b64_tr_b16 v[70:71], v153 offset:19968
    ds_read_b128 v[216:219], v164 offset:80
    ds_read_b128 v[220:223], v164 offset:2160
    s_waitcnt lgkmcnt(12)
    v_mfma_f32_16x16x32_bf16 v[184:187], v[116:119], v[56:59], 0
    v_mfma_f32_16x16x32_bf16 v[188:191], v[120:123], v[56:59], 0
    ds_read_b64_tr_b16 v[72:73], v154 offset:19968
    ds_read_b64_tr_b16 v[74:75], v155 offset:19968
    ds_read_b128 v[224:227], v165 offset:80
    ds_read_b128 v[228:231], v165 offset:2160
    s_waitcnt lgkmcnt(12)
    v_mfma_f32_16x16x32_bf16 v[184:187], v[124:127], v[60:63], v[184:187]
    v_mfma_f32_16x16x32_bf16 v[188:191], v[128:131], v[60:63], v[188:191]
    ds_read_b64_tr_b16 v[76:77], v156 offset:19968
    ds_read_b64_tr_b16 v[78:79], v157 offset:19968
    ds_read_b128 v[232:235], v166 offset:80
    ds_read_b128 v[236:239], v166 offset:2160
    s_waitcnt lgkmcnt(12)
    v_mfma_f32_16x16x32_bf16 v[184:187], v[132:135], v[64:67], v[184:187]
    v_mfma_f32_16x16x32_bf16 v[188:191], v[136:139], v[64:67], v[188:191]
    ds_read_b64_tr_b16 v[80:81], v158 offset:19968
    ds_read_b64_tr_b16 v[82:83], v159 offset:19968
    ds_read_b128 v[240:243], v167 offset:80
    ds_read_b128 v[244:247], v167 offset:2160
    s_waitcnt lgkmcnt(12)
    v_mfma_f32_16x16x32_bf16 v[192:195], v[216:219], v[68:71], 0
    v_mfma_f32_16x16x32_bf16 v[196:199], v[220:223], v[68:71], 0
    ds_read_b64_tr_b16 v[84:85], v160 offset:19968
    ds_read_b64_tr_b16 v[86:87], v161 offset:19968
    ds_read_b128 v[248:251], v168 offset:80
    ds_read_b128 v[252:255], v168 offset:2160
    s_waitcnt lgkmcnt(12)
    v_mfma_f32_16x16x32_bf16 v[192:195], v[224:227], v[72:75], v[192:195]
    v_mfma_f32_16x16x32_bf16 v[196:199], v[228:231], v[72:75], v[196:199]
    ds_read_b64_tr_b16 v[88:89], v162 offset:19968
    ds_read_b64_tr_b16 v[90:91], v163 offset:19968
    ds_read_b128 v[140:143], v169 offset:80
    ds_read_b128 v[144:147], v169 offset:2160
    s_waitcnt lgkmcnt(12)
    v_mfma_f32_16x16x32_bf16 v[192:195], v[232:235], v[76:79], v[192:195]
    v_mfma_f32_16x16x32_bf16 v[196:199], v[236:239], v[76:79], v[196:199]
    s_waitcnt lgkmcnt(8)
    v_mfma_f32_16x16x32_bf16 v[200:203], v[240:243], v[80:83], 0
    v_mfma_f32_16x16x32_bf16 v[204:207], v[244:247], v[80:83], 0
    s_waitcnt lgkmcnt(4)
    v_mfma_f32_16x16x32_bf16 v[200:203], v[248:251], v[84:87], v[200:203]
    v_mfma_f32_16x16x32_bf16 v[204:207], v[252:255], v[84:87], v[204:207]
    s_waitcnt lgkmcnt(0)
    v_mfma_f32_16x16x32_bf16 v[200:203], v[140:143], v[88:91], v[200:203]
    v_mfma_f32_16x16x32_bf16 v[204:207], v[144:147], v[88:91], v[204:207]
    s_waitcnt vmcnt(4)
    v_lshlrev_b32 v209, 16, v209
    v_mul_f32 v16, 0xbfb8aa3b, v209
    v_exp_f32 v16, v16
    s_nop 0
    v_add_f32 v16, 1.0, v16
    v_rcp_f32 v16, v16
    s_nop 0
    v_mul_f32 v209, v16, v209
    v_cvt_pk_bf16_f32 v209, v209, v209
    v_cvt_pk_bf16_f32 v44, v176, v177
    v_cvt_pk_bf16_f32 v45, v178, v179
    v_cvt_pk_bf16_f32 v46, v180, v181
    v_cvt_pk_bf16_f32 v47, v182, v183
    buffer_store_dwordx4 v[44:47], v2, s[4:7], s52 offen sc1
    s_add_u32 s52, s52, 163840
    v_cvt_pk_bf16_f32 v48, v184, v185
    v_cvt_pk_bf16_f32 v49, v186, v187
    v_cvt_pk_bf16_f32 v50, v188, v189
    v_cvt_pk_bf16_f32 v51, v190, v191
    buffer_store_dwordx4 v[48:51], v2, s[4:7], s53 offen sc1
    s_add_u32 s53, s53, 163840
    v_cvt_pk_bf16_f32 v52, v192, v193
    v_cvt_pk_bf16_f32 v53, v194, v195
    v_cvt_pk_bf16_f32 v54, v196, v197
    v_cvt_pk_bf16_f32 v55, v198, v199
    buffer_store_dwordx4 v[52:55], v2, s[4:7], s52 offen sc1
    v_cvt_pk_bf16_f32 v56, v200, v201
    v_cvt_pk_bf16_f32 v57, v202, v203
    v_cvt_pk_bf16_f32 v58, v204, v205
    v_cvt_pk_bf16_f32 v59, v206, v207
    buffer_store_dwordx4 v[56:59], v2, s[4:7], s53 offen sc1
    ds_write_b16 v212, v209 offset:43008
    s_mov_b32 s95, s100
    v_mov_b32 v203, 0
    s_waitcnt lgkmcnt(0)
L_join:
    v_lshrrev_b32 v19, 5, v1
    v_mul_u32_u24 v19, 0xa00, v19
    v_bfe_u32 v16, v1, 4, 1
    v_lshl_add_u32 v19, v16, 10, v19
    v_and_b32 v16, 15, v1
    v_lshl_add_u32 v19, v16, 4, v19
    s_cmp_lt_u32 s42, 2
    s_cselect_b32 s56, 0x800, 0
    v_bfe_u32 v20, v1, 4, 1
    v_mul_u32_u24 v20, 0xa00, v20
    v_add_u32 v20, s56, v20
    v_and_b32 v16, 15, v1
    v_lshl_add_u32 v20, v16, 4, v20
    s_lshl_b32 s68, s42, 8
    s_add_u32 s68, s68, 0x10000
    s_lshl_b32 s69, s42, 8
    s_add_u32 s69, s69, 0x13c00
    s_lshl_b32 s70, s42, 8
    s_add_u32 s70, s70, 0x17800
    s_lshl_b32 s71, s42, 8
    s_add_u32 s71, s71, 0x1b400
    buffer_load_dwordx4 v[64:67], v19, s[4:7], s68 offen sc1
    buffer_load_dwordx4 v[80:83], v20, s[4:7], s68 offen sc1
    buffer_load_dwordx4 v[68:71], v19, s[4:7], s69 offen sc1
    buffer_load_dwordx4 v[84:87], v20, s[4:7], s69 offen sc1
    buffer_load_dwordx4 v[72:75], v19, s[4:7], s70 offen sc1
    buffer_load_dwordx4 v[88:91], v20, s[4:7], s70 offen sc1
    buffer_load_dwordx4 v[76:79], v19, s[4:7], s71 offen sc1
    buffer_load_dwordx4 v[92:95], v20, s[4:7], s71 offen sc1
    v_lshlrev_b32 v176, 16, v32
    v_and_b32 v177, 0xffff0000, v32
    v_lshlrev_b32 v178, 16, v33
    v_and_b32 v179, 0xffff0000, v33
    v_lshlrev_b32 v180, 16, v34
    v_and_b32 v181, 0xffff0000, v34
    v_lshlrev_b32 v182, 16, v35
    v_and_b32 v183, 0xffff0000, v35
    v_lshlrev_b32 v184, 16, v36
    v_and_b32 v185, 0xffff0000, v36
    v_lshlrev_b32 v186, 16, v37
    v_and_b32 v187, 0xffff0000, v37
    v_lshlrev_b32 v188, 16, v38
    v_and_b32 v189, 0xffff0000, v38
    v_lshlrev_b32 v190, 16, v39
    v_and_b32 v191, 0xffff0000, v39
    v_lshlrev_b32 v192, 16, v40
    v_and_b32 v193, 0xffff0000, v40
    v_lshlrev_b32 v194, 16, v41
    v_and_b32 v195, 0xffff0000, v41
    v_lshlrev_b32 v196, 16, v42
    v_and_b32 v197, 0xffff0000, v42
    v_lshlrev_b32 v198, 16, v43
    v_and_b32 v199, 0xffff0000, v43
    v_pk_add_f32 v[16:17], v[176:177], v[178:179]
    v_pk_mul_f32 v[30:31], v[176:177], v[176:177]
    v_pk_fma_f32 v[30:31], v[178:179], v[178:179], v[30:31]
    v_pk_add_f32 v[16:17], v[16:17], v[180:181]
    v_pk_fma_f32 v[30:31], v[180:181], v[180:181], v[30:31]
    v_pk_add_f32 v[16:17], v[16:17], v[182:183]
    v_pk_fma_f32 v[30:31], v[182:183], v[182:183], v[30:31]
    v_pk_add_f32 v[16:17], v[16:17], v[184:185]
    v_pk_fma_f32 v[30:31], v[184:185], v[184:185], v[30:31]
    v_pk_add_f32 v[16:17], v[16:17], v[186:187]
    v_pk_fma_f32 v[30:31], v[186:187], v[186:187], v[30:31]
    v_pk_add_f32 v[16:17], v[16:17], v[188:189]
    v_pk_fma_f32 v[30:31], v[188:189], v[188:189], v[30:31]
    v_pk_add_f32 v[16:17], v[16:17], v[190:191]
    v_pk_fma_f32 v[30:31], v[190:191], v[190:191], v[30:31]
    v_pk_add_f32 v[16:17], v[16:17], v[192:193]
    v_pk_fma_f32 v[30:31], v[192:193], v[192:193], v[30:31]
    v_pk_add_f32 v[16:17], v[16:17], v[194:195]
    v_pk_fma_f32 v[30:31], v[194:195], v[194:195], v[30:31]
    v_pk_add_f32 v[16:17], v[16:17], v[196:197]
    v_pk_fma_f32 v[30:31], v[196:197], v[196:197], v[30:31]
    v_pk_add_f32 v[16:17], v[16:17], v[198:199]
    v_pk_fma_f32 v[30:31], v[198:199], v[198:199], v[30:31]
    v_add_f32 v16, v16, v17
    v_add_f32 v17, v30, v31
    s_nop 0
    v_add_f32_dpp v16, v16, v16 row_ror:8 row_mask:0xf bank_mask:0xf
    v_mov_b32 v18, v16
    s_nop 1
    v_permlane16_swap_b32 v16, v18
    v_add_f32 v16, v16, v18
    v_mov_b32 v18, v16
    s_nop 1
    v_permlane32_swap_b32 v16, v18
    v_add_f32 v16, v16, v18
    v_add_f32_dpp v17, v17, v17 row_ror:8 row_mask:0xf bank_mask:0xf
    v_mov_b32 v18, v17
    s_nop 1
    v_permlane16_swap_b32 v17, v18
    v_add_f32 v17, v17, v18
    v_mov_b32 v18, v17
    s_nop 1
    v_permlane32_swap_b32 v17, v18
    v_add_f32 v17, v17, v18
    s_lshl_b32 s56, s42, 3
    v_and_b32 v29, 7, v1
    v_lshl_add_u32 v29, v29, 5, s56
    ds_write_b64 v29, v[16:17] offset:43520
    s_mul_i32 s54, s42, 0x600
    s_add_u32 s54, s54, 0xac00
    v_lshrrev_b32 v21, 5, v1
    v_mul_u32_u24 v21, 0x300, v21
    v_add_u32 v21, s54, v21
    v_bfe_u32 v16, v1, 4, 1
    v_lshl_add_u32 v21, v16, 8, v21
    v_and_b32 v16, 15, v1
    v_lshl_add_u32 v21, v16, 4, v21
    v_bfe_u32 v22, v1, 4, 1
    v_mul_u32_u24 v22, 0x300, v22
    v_add_u32 v22, s54, v22
    v_and_b32 v16, 15, v1
    v_lshl_add_u32 v22, v16, 4, v22
    v_lshrrev_b32 v16, 5, v1
    v_bfe_u32 v17, v1, 4, 1
    v_cvt_f32_u32 v26, v16
    v_cvt_f32_u32 v28, v17
    v_lshrrev_b32 v24, 3, v1
    v_lshl_add_u32 v24, v24, 5, s54
    v_lshrrev_b32 v23, 3, v1
    v_lshlrev_b32 v23, 8, v23
    v_and_b32 v16, 7, v1
    v_lshl_add_u32 v23, v16, 4, v23
    v_and_b32 v25, 7, v1
    v_lshlrev_b32 v25, 5, v25
    s_lshr_b32 s56, s44, 1
    s_mul_i32 s56, s56, 0xa00
    s_add_u32 s56, s56, 0x20000
    v_min_u32 v250, 19, v1
    v_lshl_add_u32 v250, v250, 7, s56
    s_lshr_b32 s50, s44, 1
    s_lshl3_add_u32 s50, s43, s50
    s_mul_i32 s50, s50, 0x5000
    s_and_b32 s56, s44, 1
    s_lshl_b32 s56, s56, 7
    s_add_u32 s50, s50, s56
    s_lshl_b32 s56, s42, 11
    s_add_u32 s50, s50, s56
    s_add_u32 s50, s50, 0x4a0000
    s_add_u32 s51, s50, 0x2000
    s_add_u32 s56, s50, 0x4000
    s_cmp_lt_u32 s42, 2
    s_cselect_b32 s52, s56, s100
    s_lshr_b32 s56, s44, 2
    s_lshl2_add_u32 s56, s43, s56
    s_lshl4_add_u32 s89, s56, s42
    s_and_b32 s56, s44, 3
    s_lshl2_add_u32 s89, s56, s89
    s_lshl_b32 s89, s89, 7
    s_add_u32 s89, s89, 0x30000
    s_waitcnt vmcnt(8)
    s_waitcnt lgkmcnt(0)
    s_barrier
    v_mov_b32 v17, s40
    s_mov_b64 exec, 1
    buffer_store_dword v17, off, s[4:7], s88 sc1
    s_mov_b64 exec, -1
    ds_read_b128 v[56:59], v25 offset:43520
    ds_read_b128 v[60:63], v25 offset:43536
    s_waitcnt lgkmcnt(0)
    v_pk_add_f32 v[56:57], v[56:57], v[58:59]
    v_pk_add_f32 v[60:61], v[60:61], v[62:63]
    v_pk_add_f32 v[56:57], v[56:57], v[60:61]
    v_mul_f32 v56, 0x3acccccd, v56
    v_mul_f32 v58, v56, v56
    v_mov_b32 v59, 0x3acccccd
    v_fma_f32 v57, v57, v59, -v58
    v_max_f32 v57, 0, v57
    v_add_f32 v57, 0x3727c5ac, v57
    v_rsq_f32 v58, v57
    s_nop 0
    v_mul_f32 v60, v56, v58
    v_pk_fma_f32 v[176:177], v[176:177], v[58:59], v[60:61] op_sel_hi:[1,0,0] neg_lo:[0,0,1] neg_hi:[0,0,1]
    v_pk_fma_f32 v[178:179], v[178:179], v[58:59], v[60:61] op_sel_hi:[1,0,0] neg_lo:[0,0,1] neg_hi:[0,0,1]
    v_pk_fma_f32 v[180:181], v[180:181], v[58:59], v[60:61] op_sel_hi:[1,0,0] neg_lo:[0,0,1] neg_hi:[0,0,1]
    v_pk_fma_f32 v[182:183], v[182:183], v[58:59], v[60:61] op_sel_hi:[1,0,0] neg_lo:[0,0,1] neg_hi:[0,0,1]
    v_pk_fma_f32 v[184:185], v[184:185], v[58:59], v[60:61] op_sel_hi:[1,0,0] neg_lo:[0,0,1] neg_hi:[0,0,1]
    v_pk_fma_f32 v[186:187], v[186:187], v[58:59], v[60:61] op_sel_hi:[1,0,0] neg_lo:[0,0,1] neg_hi:[0,0,1]
    v_pk_fma_f32 v[188:189], v[188:189], v[58:59], v[60:61] op_sel_hi:[1,0,0] neg_lo:[0,0,1] neg_hi:[0,0,1]
    v_pk_fma_f32 v[190:191], v[190:191], v[58:59], v[60:61] op_sel_hi:[1,0,0] neg_lo:[0,0,1] neg_hi:[0,0,1]
    v_pk_fma_f32 v[192:193], v[192:193], v[58:59], v[60:61] op_sel_hi:[1,0,0] neg_lo:[0,0,1] neg_hi:[0,0,1]
    v_pk_fma_f32 v[194:195], v[194:195], v[58:59], v[60:61] op_sel_hi:[1,0,0] neg_lo:[0,0,1] neg_hi:[0,0,1]
    v_pk_fma_f32 v[196:197], v[196:197], v[58:59], v[60:61] op_sel_hi:[1,0,0] neg_lo:[0,0,1] neg_hi:[0,0,1]
    v_pk_fma_f32 v[198:199], v[198:199], v[58:59], v[60:61] op_sel_hi:[1,0,0] neg_lo:[0,0,1] neg_hi:[0,0,1]
    s_mov_b32 s96, 400000
    s_waitcnt vmcnt(1)
L_spin_1:
    v_xor_b32 v64, s76, v64
    v_xor_b32 v65, s77, v65
    v_or_b32 v16, v64, v65
    v_xor_b32 v66, s78, v66
    v_xor_b32 v67, s79, v67
    v_or3_b32 v16, v66, v67, v16
    v_xor_b32 v68, s76, v68
    v_xor_b32 v69, s77, v69
    v_or3_b32 v16, v68, v69, v16
    v_xor_b32 v70, s78, v70
    v_xor_b32 v71, s79, v71
    v_or3_b32 v16, v70, v71, v16
    v_xor_b32 v72, s76, v72
    v_xor_b32 v73, s77, v73
    v_or3_b32 v16, v72, v73, v16
    v_xor_b32 v74, s78, v74
    v_xor_b32 v75, s79, v75
    v_or3_b32 v16, v74, v75, v16
    v_xor_b32 v76, s76, v76
    v_xor_b32 v77, s77, v77
    v_or3_b32 v16, v76, v77, v16
    v_xor_b32 v78, s78, v78
    v_xor_b32 v79, s79, v79
    v_or3_b32 v16, v78, v79, v16
    v_xor_b32 v80, s76, v80
    v_xor_b32 v81, s77, v81
    v_or3_b32 v16, v80, v81, v16
    v_xor_b32 v82, s78, v82
    v_xor_b32 v83, s79, v83
    v_or3_b32 v16, v82, v83, v16
    v_xor_b32 v84, s76, v84
    v_xor_b32 v85, s77, v85
    v_or3_b32 v16, v84, v85, v16
    v_xor_b32 v86, s78, v86
    v_xor_b32 v87, s79, v87
    v_or3_b32 v16, v86, v87, v16
    v_xor_b32 v88, s76, v88
    v_xor_b32 v89, s77, v89
    v_or3_b32 v16, v88, v89, v16
    v_xor_b32 v90, s78, v90
    v_xor_b32 v91, s79, v91
    v_or3_b32 v16, v90, v91, v16
    v_xor_b32 v92, s76, v92
    v_xor_b32 v93, s77, v93
    v_or3_b32 v16, v92, v93, v16
    v_xor_b32 v94, s78, v94
    v_xor_b32 v95, s79, v95
    v_or3_b32 v16, v94, v95, v16
    v_and_b32 v16, 0xff, v16
    v_cmp_ne_u32 vcc, 0, v16
    s_nop 0
    s_cmp_eq_u64 vcc, 0
    s_cbranch_scc1 L_seen_2
    s_sleep 1
    buffer_load_dwordx4 v[64:67], v19, s[4:7], s68 offen sc1
    buffer_load_dwordx4 v[80:83], v20, s[4:7], s68 offen sc1
    buffer_load_dwordx4 v[68:71], v19, s[4:7], s69 offen sc1
    buffer_load_dwordx4 v[84:87], v20, s[4:7], s69 offen sc1
    buffer_load_dwordx4 v[72:75], v19, s[4:7], s70 offen sc1
    buffer_load_dwordx4 v[88:91], v20, s[4:7], s70 offen sc1
    buffer_load_dwordx4 v[76:79], v19, s[4:7], s71 offen sc1
    buffer_load_dwordx4 v[92:95], v20, s[4:7], s71 offen sc1
    s_waitcnt vmcnt(0)
    s_sub_u32 s96, s96, 1
    s_cbranch_scc0 L_spin_1
L_seen_2:
    v_pk_add_f32 v[64:65], v[64:65], v[68:69]
    v_pk_add_f32 v[72:73], v[72:73], v[76:77]
    v_pk_add_f32 v[66:67], v[66:67], v[70:71]
    v_pk_add_f32 v[74:75], v[74:75], v[78:79]
    v_pk_add_f32 v[64:65], v[64:65], v[72:73]
    v_pk_add_f32 v[66:67], v[66:67], v[74:75]
    v_cvt_pk_bf16_f32 v68, v64, v65
    v_cvt_pk_bf16_f32 v69, v66, v67
    v_lshlrev_b32 v64, 16, v68
    v_and_b32 v65, 0xffff0000, v68
    v_lshlrev_b32 v66, 16, v69
    v_and_b32 v67, 0xffff0000, v69
    v_pk_add_f32 v[64:65], v[64:65], v[26:27] op_sel_hi:[1,0]
    v_pk_add_f32 v[66:67], v[66:67], v[26:27] op_sel_hi:[1,0]
    v_cvt_pk_bf16_f32 v68, v64, v65
    v_cvt_pk_bf16_f32 v69, v66, v67
    v_lshlrev_b32 v44, 16, v68
    v_and_b32 v45, 0xffff0000, v68
    v_lshlrev_b32 v46, 16, v69
    v_and_b32 v47, 0xffff0000, v69
    ds_write_b128 v21, v[44:47]
    v_pk_add_f32 v[80:81], v[80:81], v[84:85]
    v_pk_add_f32 v[88:89], v[88:89], v[92:93]
    v_pk_add_f32 v[82:83], v[82:83], v[86:87]
    v_pk_add_f32 v[90:91], v[90:91], v[94:95]
    v_pk_add_f32 v[80:81], v[80:81], v[88:89]
    v_pk_add_f32 v[82:83], v[82:83], v[90:91]
    v_cvt_pk_bf16_f32 v84, v80, v81
    v_cvt_pk_bf16_f32 v85, v82, v83
    v_lshlrev_b32 v80, 16, v84
    v_and_b32 v81, 0xffff0000, v84
    v_lshlrev_b32 v82, 16, v85
    v_and_b32 v83, 0xffff0000, v85
    v_pk_add_f32 v[80:81], v[80:81], v[28:29] op_sel_hi:[1,0]
    v_pk_add_f32 v[82:83], v[82:83], v[28:29] op_sel_hi:[1,0]
    v_cvt_pk_bf16_f32 v84, v80, v81
    v_cvt_pk_bf16_f32 v85, v82, v83
    v_lshlrev_b32 v48, 16, v84
    v_and_b32 v49, 0xffff0000, v84
    v_lshlrev_b32 v50, 16, v85
    v_and_b32 v51, 0xffff0000, v85
    ds_write_b128 v22, v[48:51] offset:512
    ds_read_b128 v[96:99], v24
    ds_read_b128 v[100:103], v24 offset:16
    ds_read_b128 v[104:107], v24 offset:768
    ds_read_b128 v[108:111], v24 offset:784
    ds_read_b128 v[112:115], v24 offset:256
    ds_read_b128 v[116:119], v24 offset:272
    ds_read_b128 v[120:123], v24 offset:1024
    ds_read_b128 v[124:127], v24 offset:1040
    ds_read_b128 v[128:131], v24 offset:512
    ds_read_b128 v[132:135], v24 offset:528
    ds_read_b128 v[136:139], v24 offset:1280
    ds_read_b128 v[140:143], v24 offset:1296
    s_waitcnt lgkmcnt(8)
    v_pk_fma_f32 v[176:177], v[176:177], v[104:105], v[96:97]
    v_pk_fma_f32 v[178:179], v[178:179], v[106:107], v[98:99]
    v_pk_fma_f32 v[180:181], v[180:181], v[108:109], v[100:101]
    v_pk_fma_f32 v[182:183], v[182:183], v[110:111], v[102:103]
    v_cvt_pk_bf16_f32 v52, v176, v177
    v_cvt_pk_bf16_f32 v53, v178, v179
    v_cvt_pk_bf16_f32 v54, v180, v181
    v_cvt_pk_bf16_f32 v55, v182, v183
    buffer_store_dwordx4 v[52:55], v23, s[4:7], s50 offen sc1
    s_waitcnt lgkmcnt(4)
    v_pk_fma_f32 v[184:185], v[184:185], v[120:121], v[112:113]
    v_pk_fma_f32 v[186:187], v[186:187], v[122:123], v[114:115]
    v_pk_fma_f32 v[188:189], v[188:189], v[124:125], v[116:117]
    v_pk_fma_f32 v[190:191], v[190:191], v[126:127], v[118:119]
    v_cvt_pk_bf16_f32 v56, v184, v185
    v_cvt_pk_bf16_f32 v57, v186, v187
    v_cvt_pk_bf16_f32 v58, v188, v189
    v_cvt_pk_bf16_f32 v59, v190, v191
    buffer_store_dwordx4 v[56:59], v23, s[4:7], s51 offen sc1
    s_waitcnt lgkmcnt(0)
    v_pk_fma_f32 v[192:193], v[192:193], v[136:137], v[128:129]
    v_pk_fma_f32 v[194:195], v[194:195], v[138:139], v[130:131]
    v_pk_fma_f32 v[196:197], v[196:197], v[140:141], v[132:133]
    v_pk_fma_f32 v[198:199], v[198:199], v[142:143], v[134:135]
    v_cvt_pk_bf16_f32 v60, v192, v193
    v_cvt_pk_bf16_f32 v61, v194, v195
    v_cvt_pk_bf16_f32 v62, v196, v197
    v_cvt_pk_bf16_f32 v63, v198, v199
    buffer_store_dwordx4 v[60:63], v23, s[4:7], s52 offen sc1
    buffer_load_dword v251, v250, s[4:7], 0 offen sc1
    s_mul_i32 s55, s44, 0x28000
    s_add_u32 s55, s55, 0x220000
    s_mul_i32 s82, s42, 0x6400
    s_add_u32 s82, s82, 0xf000
    s_add_u32 s83, s55, s82
    s_lshl2_add_u32 s80, s43, s42
    s_mul_i32 s80, s80, 0xa000
    s_add_u32 s80, s80, 0x4a0000
    s_add_u32 s81, s80, 0x5000
    s_lshl2_add_u32 s56, s43, s42
    s_lshl_b32 s56, s56, 11
    s_add_u32 s56, s56, 0x30000
    v_and_b32 v252, 15, v1
    v_lshl_add_u32 v252, v252, 7, s56
    s_waitcnt vmcnt(1)
    v_mov_b32 v16, s40
    s_mov_b64 exec, 1
    buffer_store_dword v16, off, s[4:7], s89 sc1
    s_mov_b64 exec, -1
    s_waitcnt vmcnt(1)
    v_cmp_ne_u32 vcc, s40, v251
    s_nop 0
    s_cmp_eq_u64 vcc, 0
    s_cbranch_scc1 L_seen_4
    s_mov_b32 s96, 400000
    buffer_load_dword v251, v250, s[4:7], 0 offen sc1
L_spin_3:
    s_sleep 3
    buffer_load_dword v255, v250, s[4:7], 0 offen sc1
    s_waitcnt vmcnt(1)
    v_cmp_ne_u32 vcc, s40, v251
    s_nop 0
    s_cmp_eq_u64 vcc, 0
    s_cbranch_scc1 L_seen_4
    s_sleep 3
    buffer_load_dword v251, v250, s[4:7], 0 offen sc1
    s_waitcnt vmcnt(1)
    v_cmp_ne_u32 vcc, s40, v255
    s_nop 0
    s_cmp_eq_u64 vcc, 0
    s_cbranch_scc1 L_seen_4
    s_sub_u32 s96, s96, 1
    s_cbranch_scc0 L_spin_3
L_seen_4:
    s_mov_b32 m0, s82
    s_nop 0
    buffer_load_dwordx4 v2, s[4:7], s83 offen sc1 lds
    buffer_load_dwordx4 v2, s[4:7], s83 offen offset:1024 sc1 lds
    buffer_load_dwordx4 v2, s[4:7], s83 offen offset:2048 sc1 lds
    buffer_load_dwordx4 v2, s[4:7], s83 offen offset:3072 sc1 lds
    s_add_u32 s83, s83, 4096
    s_add_u32 s82, s82, 4096
    s_mov_b32 m0, s82
    s_nop 0
    buffer_load_dwordx4 v2, s[4:7], s83 offen sc1 lds
    buffer_load_dwordx4 v2, s[4:7], s83 offen offset:1024 sc1 lds
    buffer_load_dwordx4 v2, s[4:7], s83 offen offset:2048 sc1 lds
    buffer_load_dwordx4 v2, s[4:7], s83 offen offset:3072 sc1 lds
    s_add_u32 s83, s83, 4096
    s_add_u32 s82, s82, 4096
    s_mov_b32 m0, s82
    s_nop 0
    buffer_load_dwordx4 v2, s[4:7], s83 offen sc1 lds
    buffer_load_dwordx4 v2, s[4:7], s83 offen offset:1024 sc1 lds
    s_cmp_ge_u32 s2, 96
    s_cbranch_scc1 L_pick_b
    ds_read_b64_tr_b16 v[216:217], v204
    ds_read_b64_tr_b16 v[218:219], v204 offset:2560
    ds_read_b64_tr_b16 v[220:221], v204 offset:8
    ds_read_b64_tr_b16 v[222:223], v204 offset:2568
    ds_read_b64_tr_b16 v[224:225], v204 offset:16
    ds_read_b64_tr_b16 v[226:227], v204 offset:2576
    ds_read_b64_tr_b16 v[228:229], v204 offset:24
    ds_read_b64_tr_b16 v[230:231], v204 offset:2584
    ds_read_b64_tr_b16 v[232:233], v205
    ds_read_b64_tr_b16 v[234:235], v205 offset:2560
    s_branch L_picked
L_pick_b:
    v_and_b32 v16, 48, v1
    ds_read_b128 v[216:219], v16 offset:43008
    ds_read_b128 v[220:223], v16 offset:43072
    ds_read_b128 v[224:227], v16 offset:43136
    ds_read_b128 v[228:231], v16 offset:43200
    ds_read_b128 v[232:235], v16 offset:43264
L_picked:
    s_waitcnt lgkmcnt(0)
    buffer_load_dwordx4 v2, s[4:7], s83 offen offset:2048 sc1 lds
    s_lshr_b32 s48, s2, 1
    s_mul_i32 s50, s48, 0x97c
    s_lshr_b32 s50, s50, 16
    s_mul_i32 s56, s50, 27
    s_sub_u32 s51, s48, s56
    s_and_b32 s52, s2, 1
    s_lshl1_add_u32 s52, s42, s52
    s_lshl2_add_u32 s56, s50, s42
    s_mul_i32 s56, s56, 0x21c00
    s_lshl_b32 s57, s51, 7
    s_add_u32 s56, s56, s57
    s_cmp_lt_u32 s2, 0xd8
    s_cselect_b32 s91, s56, s100
    s_lshl2_add_u32 s53, s51, s50
    s_mul_i32 s53, s53, 40
    s_add_u32 s53, s53, s52
    buffer_load_dwordx4 v2, s[4:7], s83 offen offset:3072 sc1 lds
    s_lshl_b32 s53, s53, 10
    s_add_u32 s53, s53, 0xcf0000
    s_mul_i32 s54, s50, 0x1b8
    s_add_u32 s54, s54, s52
    s_lshl3_add_u32 s54, s51, s54
    s_lshl_b32 s54, s54, 10
    s_add_u32 s54, s54, 0xf50000
    s_cmp_lt_u32 s51, 16
    s_cselect_b32 s56, s53, s54
    s_cmp_lt_u32 s2, 0xd8
    s_cselect_b32 s92, s56, s100
    s_mov_b32 s57, 0x16000
    s_cmp_lt_u32 s51, 16
    s_cselect_b32 s93, 0x2000, s57
    s_and_b32 s27, s50, 3
    s_mul_i32 s56, s50, 0x6c00
    s_add_u32 s83, s83, 4096
    s_add_u32 s82, s82, 4096
    s_mov_b32 m0, s82
    s_nop 0
    buffer_load_dwordx4 v2, s[4:7], s83 offen sc1 lds
    s_and_b32 s57, s2, 1
    s_mul_i32 s57, s57, 0x1b00
    s_add_u32 s56, s56, s57
    s_lshl2_add_u32 s57, s51, s42
    s_lshl_b32 s57, s57, 6
    s_add_u32 s56, s56, s57
    s_add_u32 s56, s56, 0xf0000
    s_cmp_lt_u32 s2, 0xd8
    s_cselect_b32 s28, s56, s100
    s_and_b32 s53, s2, 1
    s_lshl2_add_u32 s56, s51, s50
    s_lshl1_add_u32 s53, s56, s53
    s_lshl_b32 s53, s53, 7
    s_add_u32 s53, s53, 0x110000
    s_cmp_lt_u32 s2, 0xd8
    s_cselect_b32 s53, s53, s100
    buffer_load_dwordx4 v2, s[4:7], s83 offen offset:1024 sc1 lds
    s_sub_u32 s56, 0x5f, s2
    s_lshl_b32 s56, s56, 7
    s_add_u32 s56, s56, 0x117000
    s_sub_u32 s58, 0x5f, s2
    s_cmp_lt_u32 s58, 52
    s_cselect_b32 s54, s56, s100
    s_cmp_eq_u32 s42, 1
    s_cselect_b32 s57, s54, s100
    s_cmp_eq_u32 s42, 0
    s_cselect_b32 s86, s53, s57
    v_lshrrev_b32 v206, 3, v1
    v_mul_u32_u24 v206, 0xd80, v206
    s_and_b32 s56, s42, 1
    s_lshl_b32 s56, s56, 2
    v_bfe_u32 v17, v1, 4, 1
    v_lshlrev_b32 v17, 1, v17
    buffer_load_dwordx4 v2, s[4:7], s83 offen offset:2048 sc1 lds
    v_and_b32 v16, 7, v1
    v_xor_b32 v16, v16, v17
    v_xor_b32 v16, s56, v16
    v_lshl_add_u32 v206, v16, 4, v206
    v_xor_b32 v207, 64, v206
    s_lshl_b32 s57, s2, 7
    s_add_u32 s57, s57, 0x25000
    s_cmp_lt_u32 s2, 40
    s_cselect_b32 s56, s57, s100
    s_cmp_eq_u32 s42, 0
    s_cselect_b32 s88, s56, s100
    s_lshr_b32 s56, s46, 2
    s_mul_i32 s56, s56, 0xa00
    s_add_u32 s56, s56, 0x25000
    v_min_u32 v250, 19, v1
    v_lshl_add_u32 v250, v250, 7, s56
    buffer_load_dwordx4 v2, s[4:7], s83 offen offset:3072 sc1 lds
    v_add_u32 v3, 61440, v2
    v_add_u32 v14, 126976, v2
    s_lshl_b32 s56, s42, 5
    v_and_b32 v200, 31, v1
    v_add_u32 v200, s56, v200
    v_lshrrev_b32 v16, 5, v1
    v_lshl_add_u32 v200, v16, 7, v200
    v_mul_u32_u24 v200, 0x90, v200
    v_add_u32 v200, 0x19000, v200
    s_lshr_b32 s56, s42, 1
    s_lshl_b32 s56, s56, 7
    v_lshrrev_b32 v201, 2, v1
    v_add_u32 v201, s56, v201
    v_mul_u32_u24 v201, 0x90, v201
    v_add_u32 v201, 0x19000, v201
    s_add_u32 s83, s83, 4096
    s_add_u32 s82, s82, 4096
    s_mov_b32 m0, s82
    s_nop 0
    buffer_load_dwordx4 v2, s[4:7], s83 offen sc1 lds
    v_and_b32 v16, 3, v1
    v_lshl_add_u32 v201, v16, 3, v201
    s_and_b32 s56, s42, 1
    s_lshl_b32 s56, s56, 5
    v_add_u32 v202, s56, v201
    s_and_b32 s56, s42, 1
    s_lshl_b32 s56, s56, 4
    s_add_u32 s56, s56, -8
    v_and_b32 v22, 15, v1
    v_add_u32 v22, s56, v22
    v_lshlrev_b32 v16, 6, v22
    v_lshrrev_b32 v17, 4, v1
    v_lshl_add_u32 v16, v17, 4, v16
    v_mov_b32 v17, s100
    v_cmp_gt_u32 vcc, 21, v22
    s_nop 1
    v_cndmask_b32 v213, v17, v16, vcc
    buffer_load_dwordx4 v2, s[4:7], s83 offen offset:1024 sc1 lds
    v_lshlrev_b32 v16, 4, v22
    v_lshrrev_b32 v17, 4, v1
    v_lshl_add_u32 v16, v17, 3, v16
    v_mov_b32 v17, s100
    v_lshrrev_b32 v18, 5, v1
    v_lshl_add_u32 v18, v18, 5, v22
    v_cmp_gt_u32 vcc, 21, v18
    s_nop 1
    v_cndmask_b32 v214, v17, v16, vcc
    v_lshlrev_b32 v16, 4, v0
    v_mov_b32 v17, s100
    v_cmp_gt_u32 vcc, 0xd2, v0
    s_nop 1
    v_cndmask_b32 v215, v17, v16, vcc
    v_mov_b32 v17, 0
    v_mov_b32 v18, 0x69
    v_cmp_gt_u32 vcc, 0x69, v0
    s_nop 1
    v_cndmask_b32 v16, v18, v17, vcc
    buffer_load_dwordx4 v2, s[4:7], s83 offen offset:2048 sc1 lds
    v_sub_u32 v22, v0, v16
    v_lshrrev_b32 v16, 2, v22
    v_mul_u32_u24 v16, 0x50, v16
    v_and_b32 v17, 3, v22
    v_lshl_add_u32 v16, v17, 3, v16
    v_mul_u32_u24 v17, 0x50, v22
    v_add_u32 v17, 0xffffe600, v17
    v_cmp_gt_u32 vcc, 0x54, v22
    s_nop 1
    v_cndmask_b32 v236, v17, v16, vcc
    v_mov_b32 v17, 0xd800
    v_mov_b32 v18, 0xde90
    v_cmp_gt_u32 vcc, 0x69, v0
    s_nop 1
    v_cndmask_b32 v16, v18, v17, vcc
    v_add_u32 v236, v236, v16
    v_mov_b32 v17, 0xe600
    v_cmp_gt_u32 vcc, 0xd2, v0
    buffer_load_dwordx4 v2, s[4:7], s83 offen offset:3072 sc1 lds
    s_nop 0
    v_cndmask_b32 v236, v17, v236, vcc
    v_mov_b32 v16, 32
    v_cmp_gt_u32 vcc, 0x54, v22
    s_nop 1
    v_cndmask_b32 v237, 8, v16, vcc
    v_add_u32 v237, v236, v237
    v_and_b32 v22, 3, v1
    v_bfe_u32 v16, v1, 3, 2
    v_lshl_add_u32 v22, v16, 2, v22
    v_lshrrev_b32 v16, 5, v1
    v_lshl_add_u32 v16, v16, 2, v22
    v_mul_u32_u24 v16, 0x50, v16
    v_add_u32 v16, 0xd800, v16
    v_lshrrev_b32 v17, 5, v1
    v_mul_u32_u24 v17, 0x690, v17
    v_add_u32 v16, v16, v17
    v_mov_b32 v17, 0xe800
    s_add_u32 s83, s83, 4096
    s_add_u32 s82, s82, 4096
    s_mov_b32 m0, s82
    s_nop 0
    buffer_load_dwordx4 v2, s[4:7], s83 offen sc1 lds
    v_bfe_u32 v18, v1, 2, 1
    v_lshrrev_b32 v19, 5, v1
    v_cmp_eq_u32 vcc, v18, v19
    s_nop 1
    v_cndmask_b32 v238, v17, v16, vcc
    v_mov_b32 v16, 20
    v_lshrrev_b32 v17, 5, v1
    v_xor_b32 v17, 1, v17
    v_lshl_add_u32 v17, v17, 4, v22
    v_cmp_eq_u32 vcc, 4, v22
    s_nop 1
    v_cndmask_b32 v239, v17, v16, vcc
    v_mul_u32_u24 v239, 0x50, v239
    v_add_u32 v239, 0xd800, v239
    v_lshrrev_b32 v16, 5, v1
    v_mul_u32_u24 v16, 0x690, v16
    v_add_u32 v239, v239, v16
    v_lshrrev_b32 v16, 5, v1
    buffer_load_dwordx4 v2, s[4:7], s83 offen offset:1024 sc1 lds
    v_bfe_u32 v23, v1, 2, 1
    v_xor_b32 v23, v23, v16
    v_lshl_add_u32 v23, v23, 3, v22
    v_mov_b32 v17, 0xe800
    v_cmp_gt_u32 vcc, 5, v23
    s_nop 1
    v_cndmask_b32 v239, v17, v239, vcc
    v_bfe_u32 v22, v1, 4, 1
    v_mul_u32_u24 v22, 0x5000, v22
    v_and_b32 v16, 15, v1
    v_lshl_add_u32 v22, v16, 4, v22
    v_lshrrev_b32 v248, 5, v1
    v_mul_u32_u24 v248, 0x300, v248
    v_add_u32 v248, v22, v248
    v_lshrrev_b32 v249, 5, v1
    v_lshl_add_u32 v249, v249, 3, v22
    v_and_b32 v254, 31, v1
    buffer_load_dwordx4 v2, s[4:7], s83 offen offset:2048 sc1 lds
    v_lshlrev_b32 v254, 2, v254
    v_add_u32 v208, 61440, v208
    s_lshl4_add_u32 s16, s44, s43
    s_mul_i32 s16, s16, 0xe00
    s_lshr_b32 s56, s42, 1
    s_mul_i32 s56, s56, 0x690
    s_add_u32 s16, s16, s56
    s_add_u32 s16, s16, 0x130000
    s_lshl4_add_u32 s56, s44, s43
    s_lshl_b32 s56, s56, 7
    s_add_u32 s56, s56, 0x28000
    s_cmp_eq_u32 s42, 0
    s_cselect_b32 s17, s56, s100
    s_mul_i32 s18, s44, 0xe000
    s_add_u32 s18, s18, 0x130000
    s_lshl2_add_u32 s19, s43, s42
    buffer_load_dwordx4 v2, s[4:7], s83 offen offset:3072 sc1 lds
    s_mul_i32 s19, s19, 0xa000
    s_mul_i32 s56, s44, 0x500
    s_add_u32 s19, s19, s56
    s_add_u32 s19, s19, 0x720000
    s_lshl2_add_u32 s56, s43, s42
    s_lshl4_add_u32 s24, s56, s44
    s_lshl_b32 s24, s24, 7
    s_add_u32 s24, s24, 0x50000
    s_mul_i32 s25, s42, 0x1800
    s_add_u32 s25, s25, 0x22000
    s_mul_i32 s26, s46, 0x19000
    s_mul_i32 s56, s42, 0x1800
    s_add_u32 s26, s26, s56
    s_add_u32 s26, s26, 0xc33000
    s_mul_i32 s51, s42, 0x2400
    s_add_u32 s51, s51, 0x19000
    s_add_u32 s83, s83, 4096
    s_add_u32 s82, s82, 4096
    s_mov_b32 m0, s82
    s_nop 0
    buffer_load_dwordx4 v2, s[4:7], s83 offen sc1 lds
    s_mul_i32 s52, s46, 0x19000
    s_mul_i32 s56, s42, 0x2400
    s_add_u32 s52, s52, s56
    s_add_u32 s52, s52, 0xc2a000
    s_mul_i32 s53, s42, 0x2800
    s_add_u32 s53, s53, 0xf000
    s_mul_i32 s54, s46, 0x19000
    s_mul_i32 s56, s42, 0x2800
    s_add_u32 s54, s54, s56
    s_add_u32 s54, s54, 0xc20000
    s_mov_b32 s48, 0x00003f80
    s_mov_b32 s49, 0x3f800000
    s_mul_i32 s1, s42, 6
    s_min_u32 s1, s1, 17
    s_add_u32 s1, s1, 32
    s_mul_i32 s84, s46, 54
    s_lshl3_add_u32 s84, s42, s84
    s_mul_i32 s84, s84, 0x1400
    s_add_u32 s84, s84, 0x1130000
    s_mul_i32 s85, s46, 54
    s_add_u32 s85, s85, s1
    s_mul_i32 s85, s85, 0x1400
    s_add_u32 s85, s85, 0x1130000
    s_add_u32 s56, s42, 2
    s_mul_i32 s56, s56, 0xa00
    s_mul_i32 s57, s46, 0x140
    s_add_u32 s56, s56, s57
    v_lshl_add_u32 v16, v1, 4, s56
    s_lshr_b32 s57, s42, 1
    s_sub_u32 s56, 4, s57
    s_mul_i32 s56, s56, 0xa00
    s_mul_i32 s57, s27, 0x280
    s_add_u32 s56, s56, s57
    s_and_b32 s57, s42, 1
    s_mul_i32 s57, s57, 0x140
    s_add_u32 s56, s56, s57
    s_add_u32 s56, s56, 0xfffffec0
    v_min_u32 v17, 39, v1
    v_lshl_add_u32 v17, v17, 4, s56
    v_cmp_gt_u32 vcc, 20, v1
    s_nop 1
    v_cndmask_b32 v196, v17, v16, vcc
    s_cmp_eq_u32 s42, 2
    s_cselect_b32 s56, 0x3f800000, 0
    v_mov_b32 v16, s56
    s_cmp_lt_u32 s42, 2
    s_cselect_b32 s56, 0x3f800000, 0
    v_mov_b32 v17, s56
    v_cmp_gt_u32 vcc, 20, v1
    s_nop 1
    v_cndmask_b32 v198, v17, v16, vcc
    s_mul_i32 s56, s42, 0x140
    s_add_u32 s56, s56, 0xe880
    v_lshl_add_u32 v16, v1, 4, s56
    v_mov_b32 v17, 0xe700
    v_cmp_gt_u32 vcc, 20, v1
    s_nop 1
    v_cndmask_b32 v197, v17, v16, vcc
    v_mov_b32 v16, 0xe700
    s_mul_i32 s56, s42, 0xa0
    s_add_u32 s56, s56, 0xece0
    v_min_u32 v17, 39, v1
    v_lshl_add_u32 v17, v17, 3, s56
    v_cmp_gt_u32 vcc, 20, v1
    s_nop 1
    v_cndmask_b32 v199, v17, v16, vcc
    s_mov_b32 s68, 65536
    s_mov_b32 s69, 80896
    s_mov_b32 s70, 96256
    s_mov_b32 s71, 111616
    buffer_load_dword v253, v252, s[4:7], 0 offen sc1
    s_mul_i32 s82, s42, 0x3c00
    s_add_u32 s83, s55, s82
    s_waitcnt vmcnt(0)
    v_cmp_ne_u32 vcc, s40, v253
    s_nop 0
    s_cmp_eq_u64 vcc, 0
    s_cbranch_scc1 L_seen_6
    s_mov_b32 s96, 400000
    buffer_load_dword v253, v252, s[4:7], 0 offen sc1
L_spin_5:
    s_sleep 3
    buffer_load_dword v255, v252, s[4:7], 0 offen sc1
    s_waitcnt vmcnt(1)
    v_cmp_ne_u32 vcc, s40, v253
    s_nop 0
    s_cmp_eq_u64 vcc, 0
    s_cbranch_scc1 L_seen_6
    s_sleep 3
    buffer_load_dword v253, v252, s[4:7], 0 offen sc1
    s_waitcnt vmcnt(1)
    v_cmp_ne_u32 vcc, s40, v255
    s_nop 0
    s_cmp_eq_u64 vcc, 0
    s_cbranch_scc1 L_seen_6
    s_sub_u32 s96, s96, 1
    s_cbranch_scc0 L_spin_5
L_seen_6:
    s_lshl_b32 s56, s44, 11
    s_add_u32 s56, s56, 0x28000
    v_and_b32 v252, 15, v1
    v_lshl_add_u32 v252, v252, 7, s56
    buffer_load_dwordx4 a[0:3], v2, s[4:7], s80 offen sc1
    buffer_load_dwordx4 a[4:7], v2, s[4:7], s81 offen sc1
    buffer_load_dwordx4 a[8:11], v2, s[4:7], s80 offen offset:1024 sc1
    buffer_load_dwordx4 a[12:15], v2, s[4:7], s81 offen offset:1024 sc1
    buffer_load_dwordx4 a[16:19], v2, s[4:7], s80 offen offset:2048 sc1
    buffer_load_dwordx4 a[20:23], v2, s[4:7], s81 offen offset:2048 sc1
    buffer_load_dwordx4 a[24:27], v2, s[4:7], s80 offen offset:3072 sc1
    buffer_load_dwordx4 a[28:31], v2, s[4:7], s81 offen offset:3072 sc1
    s_barrier
    v_mov_b32 v112, s40
    s_mov_b64 exec, 1
    buffer_store_dword v112, off, s[4:7], s88 sc1
    s_mov_b64 exec, -1
    ds_read_b128 v[80:83], v3
    ds_read_b128 v[84:87], v3 offset:1024
    ds_read_b128 v[88:91], v3 offset:2048
    ds_read_b128 v[92:95], v3 offset:3072
    ds_read_b128 v[96:99], v3 offset:4096
    ds_read_b128 v[100:103], v3 offset:5120
    ds_read_b128 v[104:107], v3 offset:6144
    ds_read_b128 v[108:111], v3 offset:7168
    ds_read_b128 v[112:115], v3 offset:8192
    ds_read_b128 v[116:119], v3 offset:9216
    s_waitcnt vmcnt(7) lgkmcnt(5)
    v_mfma_f32_16x16x32_bf16 v[16:19], v[80:83], a[0:3], 0
    ds_read_b128 v[120:123], v3 offset:10240
    s_add_u32 s80, s80, 4096
    v_mfma_f32_16x16x32_bf16 v[36:39], v[80:83], a[4:7], 0
    buffer_load_dwordx4 a[32:35], v2, s[4:7], s80 offen sc1
    v_mfma_f32_16x16x32_bf16 v[20:23], v[84:87], a[0:3], 0
    ds_read_b128 v[124:127], v3 offset:11264
    v_mfma_f32_16x16x32_bf16 v[40:43], v[84:87], a[4:7], 0
    v_mfma_f32_16x16x32_bf16 v[24:27], v[88:91], a[0:3], 0
    ds_read_b128 v[80:83], v3 offset:12288
    v_mfma_f32_16x16x32_bf16 v[44:47], v[88:91], a[4:7], 0
    s_add_u32 s81, s81, 4096
    v_mfma_f32_16x16x32_bf16 v[28:31], v[92:95], a[0:3], 0
    ds_read_b128 v[84:87], v3 offset:13312
    v_mfma_f32_16x16x32_bf16 v[48:51], v[92:95], a[4:7], 0
    buffer_load_dwordx4 a[36:39], v2, s[4:7], s81 offen sc1
    v_mfma_f32_16x16x32_bf16 v[32:35], v[96:99], a[0:3], 0
    ds_read_b128 v[88:91], v3 offset:14336
    v_mfma_f32_16x16x32_bf16 v[52:55], v[96:99], a[4:7], 0
    s_waitcnt vmcnt(7) lgkmcnt(5)
    v_mfma_f32_16x16x32_bf16 v[16:19], v[100:103], a[8:11], v[16:19]
    ds_read_b128 v[92:95], v3 offset:15360
    v_mfma_f32_16x16x32_bf16 v[36:39], v[100:103], a[12:15], v[36:39]
    buffer_load_dwordx4 a[40:43], v2, s[4:7], s80 offen offset:1024 sc1
    v_mfma_f32_16x16x32_bf16 v[20:23], v[104:107], a[8:11], v[20:23]
    ds_read_b128 v[96:99], v3 offset:16384
    v_mfma_f32_16x16x32_bf16 v[40:43], v[104:107], a[12:15], v[40:43]
    v_mfma_f32_16x16x32_bf16 v[24:27], v[108:111], a[8:11], v[24:27]
    ds_read_b128 v[100:103], v3 offset:17408
    v_mfma_f32_16x16x32_bf16 v[44:47], v[108:111], a[12:15], v[44:47]
    buffer_load_dwordx4 a[44:47], v2, s[4:7], s81 offen offset:1024 sc1
    v_mfma_f32_16x16x32_bf16 v[28:31], v[112:115], a[8:11], v[28:31]
    ds_read_b128 v[104:107], v3 offset:18432
    v_mfma_f32_16x16x32_bf16 v[48:51], v[112:115], a[12:15], v[48:51]
    v_mfma_f32_16x16x32_bf16 v[32:35], v[116:119], a[8:11], v[32:35]
    ds_read_b128 v[108:111], v3 offset:19456
    v_mfma_f32_16x16x32_bf16 v[52:55], v[116:119], a[12:15], v[52:55]
    s_waitcnt vmcnt(7) lgkmcnt(5)
    v_mfma_f32_16x16x32_bf16 v[16:19], v[120:123], a[16:19], v[16:19]
    ds_read_b128 v[112:115], v3 offset:20480
    v_mfma_f32_16x16x32_bf16 v[36:39], v[120:123], a[20:23], v[36:39]
    buffer_load_dwordx4 a[48:51], v2, s[4:7], s80 offen offset:2048 sc1
    v_mfma_f32_16x16x32_bf16 v[20:23], v[124:127], a[16:19], v[20:23]
    ds_read_b128 v[116:119], v3 offset:21504
    v_mfma_f32_16x16x32_bf16 v[40:43], v[124:127], a[20:23], v[40:43]
    v_mfma_f32_16x16x32_bf16 v[24:27], v[80:83], a[16:19], v[24:27]
    ds_read_b128 v[120:123], v3 offset:22528
    v_mfma_f32_16x16x32_bf16 v[44:47], v[80:83], a[20:23], v[44:47]
    buffer_load_dwordx4 a[52:55], v2, s[4:7], s81 offen offset:2048 sc1
    v_mfma_f32_16x16x32_bf16 v[28:31], v[84:87], a[16:19], v[28:31]
    ds_read_b128 v[124:127], v3 offset:23552
    v_mfma_f32_16x16x32_bf16 v[48:51], v[84:87], a[20:23], v[48:51]
    v_mfma_f32_16x16x32_bf16 v[32:35], v[88:91], a[16:19], v[32:35]
    ds_read_b128 v[80:83], v3 offset:24576
    v_mfma_f32_16x16x32_bf16 v[52:55], v[88:91], a[20:23], v[52:55]
    s_waitcnt vmcnt(7) lgkmcnt(5)
    v_mfma_f32_16x16x32_bf16 v[16:19], v[92:95], a[24:27], v[16:19]
    ds_read_b128 v[84:87], v3 offset:25600
    v_mfma_f32_16x16x32_bf16 v[36:39], v[92:95], a[28:31], v[36:39]
    buffer_load_dwordx4 a[56:59], v2, s[4:7], s80 offen offset:3072 sc1
    v_mfma_f32_16x16x32_bf16 v[20:23], v[96:99], a[24:27], v[20:23]
    ds_read_b128 v[88:91], v3 offset:26624
    v_mfma_f32_16x16x32_bf16 v[40:43], v[96:99], a[28:31], v[40:43]
    v_mfma_f32_16x16x32_bf16 v[24:27], v[100:103], a[24:27], v[24:27]
    ds_read_b128 v[92:95], v3 offset:27648
    v_mfma_f32_16x16x32_bf16 v[44:47], v[100:103], a[28:31], v[44:47]
    buffer_load_dwordx4 a[60:63], v2, s[4:7], s81 offen offset:3072 sc1
    v_mfma_f32_16x16x32_bf16 v[28:31], v[104:107], a[24:27], v[28:31]
    ds_read_b128 v[96:99], v3 offset:28672
    v_mfma_f32_16x16x32_bf16 v[48:51], v[104:107], a[28:31], v[48:51]
    v_mfma_f32_16x16x32_bf16 v[32:35], v[108:111], a[24:27], v[32:35]
    ds_read_b128 v[100:103], v3 offset:29696
    v_mfma_f32_16x16x32_bf16 v[52:55], v[108:111], a[28:31], v[52:55]
    s_waitcnt vmcnt(6) lgkmcnt(5)
    v_mfma_f32_16x16x32_bf16 v[16:19], v[112:115], a[32:35], v[16:19]
    ds_read_b128 v[104:107], v3 offset:30720
    s_add_u32 s80, s80, 4096
    v_mfma_f32_16x16x32_bf16 v[36:39], v[112:115], a[36:39], v[36:39]
    buffer_load_dwordx4 a[64:67], v2, s[4:7], s80 offen sc1
    v_mfma_f32_16x16x32_bf16 v[20:23], v[116:119], a[32:35], v[20:23]
    ds_read_b128 v[108:111], v3 offset:31744
    v_mfma_f32_16x16x32_bf16 v[40:43], v[116:119], a[36:39], v[40:43]
    v_mfma_f32_16x16x32_bf16 v[24:27], v[120:123], a[32:35], v[24:27]
    ds_read_b128 v[112:115], v3 offset:32768
    v_mfma_f32_16x16x32_bf16 v[44:47], v[120:123], a[36:39], v[44:47]
    s_add_u32 s81, s81, 4096
    v_mfma_f32_16x16x32_bf16 v[28:31], v[124:127], a[32:35], v[28:31]
    ds_read_b128 v[116:119], v3 offset:33792
    v_mfma_f32_16x16x32_bf16 v[48:51], v[124:127], a[36:39], v[48:51]
    buffer_load_dwordx4 a[68:71], v2, s[4:7], s81 offen sc1
    v_mfma_f32_16x16x32_bf16 v[32:35], v[80:83], a[32:35], v[32:35]
    ds_read_b128 v[120:123], v3 offset:34816
    v_mfma_f32_16x16x32_bf16 v[52:55], v[80:83], a[36:39], v[52:55]
    s_waitcnt vmcnt(6) lgkmcnt(5)
    v_mfma_f32_16x16x32_bf16 v[16:19], v[84:87], a[40:43], v[16:19]
    ds_read_b128 v[124:127], v3 offset:35840
    v_mfma_f32_16x16x32_bf16 v[36:39], v[84:87], a[44:47], v[36:39]
    buffer_load_dwordx4 a[72:75], v2, s[4:7], s80 offen offset:1024 sc1
    v_mfma_f32_16x16x32_bf16 v[20:23], v[88:91], a[40:43], v[20:23]
    ds_read_b128 v[80:83], v3 offset:36864
    v_mfma_f32_16x16x32_bf16 v[40:43], v[88:91], a[44:47], v[40:43]
    v_mfma_f32_16x16x32_bf16 v[24:27], v[92:95], a[40:43], v[24:27]
    ds_read_b128 v[84:87], v3 offset:37888
    v_mfma_f32_16x16x32_bf16 v[44:47], v[92:95], a[44:47], v[44:47]
    buffer_load_dwordx4 a[76:79], v2, s[4:7], s81 offen offset:1024 sc1
    v_mfma_f32_16x16x32_bf16 v[28:31], v[96:99], a[40:43], v[28:31]
    ds_read_b128 v[88:91], v3 offset:38912
    v_mfma_f32_16x16x32_bf16 v[48:51], v[96:99], a[44:47], v[48:51]
    v_mfma_f32_16x16x32_bf16 v[32:35], v[100:103], a[40:43], v[32:35]
    ds_read_b128 v[92:95], v3 offset:39936
    v_mfma_f32_16x16x32_bf16 v[52:55], v[100:103], a[44:47], v[52:55]
    s_waitcnt vmcnt(6) lgkmcnt(5)
    v_mfma_f32_16x16x32_bf16 v[16:19], v[104:107], a[48:51], v[16:19]
    ds_read_b128 v[96:99], v3 offset:40960
    v_mfma_f32_16x16x32_bf16 v[36:39], v[104:107], a[52:55], v[36:39]
    buffer_load_dwordx4 a[80:83], v2, s[4:7], s80 offen offset:2048 sc1
    v_mfma_f32_16x16x32_bf16 v[20:23], v[108:111], a[48:51], v[20:23]
    ds_read_b128 v[100:103], v3 offset:41984
    v_mfma_f32_16x16x32_bf16 v[40:43], v[108:111], a[52:55], v[40:43]
    v_mfma_f32_16x16x32_bf16 v[24:27], v[112:115], a[48:51], v[24:27]
    ds_read_b128 v[104:107], v3 offset:43008
    v_mfma_f32_16x16x32_bf16 v[44:47], v[112:115], a[52:55], v[44:47]
    buffer_load_dwordx4 a[84:87], v2, s[4:7], s81 offen offset:2048 sc1
    v_mfma_f32_16x16x32_bf16 v[28:31], v[116:119], a[48:51], v[28:31]
    ds_read_b128 v[108:111], v3 offset:44032
    v_mfma_f32_16x16x32_bf16 v[48:51], v[116:119], a[52:55], v[48:51]
    v_mfma_f32_16x16x32_bf16 v[32:35], v[120:123], a[48:51], v[32:35]
    ds_read_b128 v[112:115], v3 offset:45056
    v_mfma_f32_16x16x32_bf16 v[52:55], v[120:123], a[52:55], v[52:55]
    s_waitcnt vmcnt(6) lgkmcnt(5)
    v_mfma_f32_16x16x32_bf16 v[16:19], v[124:127], a[56:59], v[16:19]
    ds_read_b128 v[116:119], v3 offset:46080
    v_mfma_f32_16x16x32_bf16 v[36:39], v[124:127], a[60:63], v[36:39]
    buffer_load_dwordx4 a[88:91], v2, s[4:7], s80 offen offset:3072 sc1
    v_mfma_f32_16x16x32_bf16 v[20:23], v[80:83], a[56:59], v[20:23]
    ds_read_b128 v[120:123], v3 offset:47104
    v_mfma_f32_16x16x32_bf16 v[40:43], v[80:83], a[60:63], v[40:43]
    v_mfma_f32_16x16x32_bf16 v[24:27], v[84:87], a[56:59], v[24:27]
    ds_read_b128 v[124:127], v3 offset:48128
    v_mfma_f32_16x16x32_bf16 v[44:47], v[84:87], a[60:63], v[44:47]
    buffer_load_dwordx4 a[92:95], v2, s[4:7], s81 offen offset:3072 sc1
    v_mfma_f32_16x16x32_bf16 v[28:31], v[88:91], a[56:59], v[28:31]
    ds_read_b128 v[80:83], v3 offset:49152
    v_mfma_f32_16x16x32_bf16 v[48:51], v[88:91], a[60:63], v[48:51]
    v_mfma_f32_16x16x32_bf16 v[32:35], v[92:95], a[56:59], v[32:35]
    ds_read_b128 v[84:87], v3 offset:50176
    v_mfma_f32_16x16x32_bf16 v[52:55], v[92:95], a[60:63], v[52:55]
    s_waitcnt vmcnt(6) lgkmcnt(5)
    v_mfma_f32_16x16x32_bf16 v[16:19], v[96:99], a[64:67], v[16:19]
    ds_read_b128 v[88:91], v3 offset:51200
    s_add_u32 s80, s80, 4096
    v_mfma_f32_16x16x32_bf16 v[36:39], v[96:99], a[68:71], v[36:39]
    buffer_load_dwordx4 a[96:99], v2, s[4:7], s80 offen sc1
    v_mfma_f32_16x16x32_bf16 v[20:23], v[100:103], a[64:67], v[20:23]
    ds_read_b128 v[92:95], v3 offset:52224
    v_mfma_f32_16x16x32_bf16 v[40:43], v[100:103], a[68:71], v[40:43]
    v_mfma_f32_16x16x32_bf16 v[24:27], v[104:107], a[64:67], v[24:27]
    ds_read_b128 v[96:99], v3 offset:53248
    v_mfma_f32_16x16x32_bf16 v[44:47], v[104:107], a[68:71], v[44:47]
    s_add_u32 s81, s81, 4096
    v_mfma_f32_16x16x32_bf16 v[28:31], v[108:111], a[64:67], v[28:31]
    ds_read_b128 v[100:103], v3 offset:54272
    v_mfma_f32_16x16x32_bf16 v[48:51], v[108:111], a[68:71], v[48:51]
    buffer_load_dwordx4 a[100:103], v2, s[4:7], s81 offen sc1
    v_mfma_f32_16x16x32_bf16 v[32:35], v[112:115], a[64:67], v[32:35]
    ds_read_b128 v[104:107], v3 offset:55296
    v_mfma_f32_16x16x32_bf16 v[52:55], v[112:115], a[68:71], v[52:55]
    s_waitcnt vmcnt(6) lgkmcnt(5)
    v_mfma_f32_16x16x32_bf16 v[16:19], v[116:119], a[72:75], v[16:19]
    ds_read_b128 v[108:111], v3 offset:56320
    v_mfma_f32_16x16x32_bf16 v[36:39], v[116:119], a[76:79], v[36:39]
    buffer_load_dwordx4 a[104:107], v2, s[4:7], s80 offen offset:1024 sc1
    v_mfma_f32_16x16x32_bf16 v[20:23], v[120:123], a[72:75], v[20:23]
    ds_read_b128 v[112:115], v3 offset:57344
    v_mfma_f32_16x16x32_bf16 v[40:43], v[120:123], a[76:79], v[40:43]
    v_mfma_f32_16x16x32_bf16 v[24:27], v[124:127], a[72:75], v[24:27]
    ds_read_b128 v[116:119], v3 offset:58368
    v_mfma_f32_16x16x32_bf16 v[44:47], v[124:127], a[76:79], v[44:47]
    buffer_load_dwordx4 a[108:111], v2, s[4:7], s81 offen offset:1024 sc1
    v_mfma_f32_16x16x32_bf16 v[28:31], v[80:83], a[72:75], v[28:31]
    ds_read_b128 v[120:123], v3 offset:59392
    v_mfma_f32_16x16x32_bf16 v[48:51], v[80:83], a[76:79], v[48:51]
    v_mfma_f32_16x16x32_bf16 v[32:35], v[84:87], a[72:75], v[32:35]
    ds_read_b128 v[124:127], v3 offset:60416
    v_mfma_f32_16x16x32_bf16 v[52:55], v[84:87], a[76:79], v[52:55]
    s_barrier
    s_waitcnt vmcnt(6) lgkmcnt(5)
    v_mfma_f32_16x16x32_bf16 v[16:19], v[88:91], a[80:83], v[16:19]
    ds_read_b128 v[80:83], v3 offset:61440
    v_mfma_f32_16x16x32_bf16 v[36:39], v[88:91], a[84:87], v[36:39]
    buffer_load_dwordx4 a[112:115], v2, s[4:7], s80 offen offset:2048 sc1
    v_mfma_f32_16x16x32_bf16 v[20:23], v[92:95], a[80:83], v[20:23]
    ds_read_b128 v[84:87], v3 offset:62464
    v_mfma_f32_16x16x32_bf16 v[40:43], v[92:95], a[84:87], v[40:43]
    v_mfma_f32_16x16x32_bf16 v[24:27], v[96:99], a[80:83], v[24:27]
    ds_read_b128 v[88:91], v3 offset:63488
    v_mfma_f32_16x16x32_bf16 v[44:47], v[96:99], a[84:87], v[44:47]
    buffer_load_dwordx4 a[116:119], v2, s[4:7], s81 offen offset:2048 sc1
    v_mfma_f32_16x16x32_bf16 v[28:31], v[100:103], a[80:83], v[28:31]
    ds_read_b128 v[92:95], v3 offset:64512
    v_mfma_f32_16x16x32_bf16 v[48:51], v[100:103], a[84:87], v[48:51]
    v_mfma_f32_16x16x32_bf16 v[32:35], v[104:107], a[80:83], v[32:35]
    ds_read_b128 v[96:99], v14
    v_mfma_f32_16x16x32_bf16 v[52:55], v[104:107], a[84:87], v[52:55]
    s_waitcnt vmcnt(6) lgkmcnt(5)
    v_mfma_f32_16x16x32_bf16 v[16:19], v[108:111], a[88:91], v[16:19]
    ds_read_b128 v[100:103], v14 offset:1024
    v_mfma_f32_16x16x32_bf16 v[36:39], v[108:111], a[92:95], v[36:39]
    buffer_load_dwordx4 a[120:123], v2, s[4:7], s80 offen offset:3072 sc1
    v_mfma_f32_16x16x32_bf16 v[20:23], v[112:115], a[88:91], v[20:23]
    ds_read_b128 v[104:107], v14 offset:2048
    v_mfma_f32_16x16x32_bf16 v[40:43], v[112:115], a[92:95], v[40:43]
    v_mfma_f32_16x16x32_bf16 v[24:27], v[116:119], a[88:91], v[24:27]
    ds_read_b128 v[108:111], v14 offset:3072
    v_mfma_f32_16x16x32_bf16 v[44:47], v[116:119], a[92:95], v[44:47]
    buffer_load_dwordx4 a[124:127], v2, s[4:7], s81 offen offset:3072 sc1
    v_mfma_f32_16x16x32_bf16 v[28:31], v[120:123], a[88:91], v[28:31]
    ds_read_b128 v[112:115], v14 offset:4096
    v_mfma_f32_16x16x32_bf16 v[48:51], v[120:123], a[92:95], v[48:51]
    v_mfma_f32_16x16x32_bf16 v[32:35], v[124:127], a[88:91], v[32:35]
    ds_read_b128 v[116:119], v14 offset:5120
    v_mfma_f32_16x16x32_bf16 v[52:55], v[124:127], a[92:95], v[52:55]
    s_waitcnt vmcnt(6) lgkmcnt(5)
    v_mfma_f32_16x16x32_bf16 v[16:19], v[80:83], a[96:99], v[16:19]
    ds_read_b128 v[120:123], v14 offset:6144
    s_add_u32 s80, s80, 4096
    v_mfma_f32_16x16x32_bf16 v[36:39], v[80:83], a[100:103], v[36:39]
    buffer_load_dwordx4 a[128:131], v2, s[4:7], s80 offen sc1
    v_mfma_f32_16x16x32_bf16 v[20:23], v[84:87], a[96:99], v[20:23]
    ds_read_b128 v[124:127], v14 offset:7168
    v_mfma_f32_16x16x32_bf16 v[40:43], v[84:87], a[100:103], v[40:43]
    v_mfma_f32_16x16x32_bf16 v[24:27], v[88:91], a[96:99], v[24:27]
    ds_read_b128 v[80:83], v14 offset:8192
    v_mfma_f32_16x16x32_bf16 v[44:47], v[88:91], a[100:103], v[44:47]
    s_add_u32 s81, s81, 4096
    v_mfma_f32_16x16x32_bf16 v[28:31], v[92:95], a[96:99], v[28:31]
    ds_read_b128 v[84:87], v14 offset:9216
    v_mfma_f32_16x16x32_bf16 v[48:51], v[92:95], a[100:103], v[48:51]
    buffer_load_dwordx4 a[132:135], v2, s[4:7], s81 offen sc1
    v_mfma_f32_16x16x32_bf16 v[32:35], v[96:99], a[96:99], v[32:35]
    ds_read_b128 v[88:91], v14 offset:10240
    v_mfma_f32_16x16x32_bf16 v[52:55], v[96:99], a[100:103], v[52:55]
    s_waitcnt vmcnt(6) lgkmcnt(5)
    v_mfma_f32_16x16x32_bf16 v[16:19], v[100:103], a[104:107], v[16:19]
    ds_read_b128 v[92:95], v14 offset:11264
    v_mfma_f32_16x16x32_bf16 v[36:39], v[100:103], a[108:111], v[36:39]
    buffer_load_dwordx4 a[136:139], v2, s[4:7], s80 offen offset:1024 sc1
    v_mfma_f32_16x16x32_bf16 v[20:23], v[104:107], a[104:107], v[20:23]
    ds_read_b128 v[96:99], v14 offset:12288
    v_mfma_f32_16x16x32_bf16 v[40:43], v[104:107], a[108:111], v[40:43]
    v_mfma_f32_16x16x32_bf16 v[24:27], v[108:111], a[104:107], v[24:27]
    ds_read_b128 v[100:103], v14 offset:13312
    v_mfma_f32_16x16x32_bf16 v[44:47], v[108:111], a[108:111], v[44:47]
    buffer_load_dwordx4 a[140:143], v2, s[4:7], s81 offen offset:1024 sc1
    v_mfma_f32_16x16x32_bf16 v[28:31], v[112:115], a[104:107], v[28:31]
    ds_read_b128 v[104:107], v14 offset:14336
    v_mfma_f32_16x16x32_bf16 v[48:51], v[112:115], a[108:111], v[48:51]
    v_mfma_f32_16x16x32_bf16 v[32:35], v[116:119], a[104:107], v[32:35]
    ds_read_b128 v[108:111], v14 offset:15360
    v_mfma_f32_16x16x32_bf16 v[52:55], v[116:119], a[108:111], v[52:55]
    s_waitcnt vmcnt(6) lgkmcnt(5)
    v_mfma_f32_16x16x32_bf16 v[16:19], v[120:123], a[112:115], v[16:19]
    ds_read_b128 v[112:115], v14 offset:16384
    v_mfma_f32_16x16x32_bf16 v[36:39], v[120:123], a[116:119], v[36:39]
    buffer_load_dwordx4 a[144:147], v2, s[4:7], s80 offen offset:2048 sc1
    v_mfma_f32_16x16x32_bf16 v[20:23], v[124:127], a[112:115], v[20:23]
    ds_read_b128 v[116:119], v14 offset:17408
    v_mfma_f32_16x16x32_bf16 v[40:43], v[124:127], a[116:119], v[40:43]
    v_mfma_f32_16x16x32_bf16 v[24:27], v[80:83], a[112:115], v[24:27]
    ds_read_b128 v[120:123], v14 offset:18432
    v_mfma_f32_16x16x32_bf16 v[44:47], v[80:83], a[116:119], v[44:47]
    buffer_load_dwordx4 a[148:151], v2, s[4:7], s81 offen offset:2048 sc1
    v_mfma_f32_16x16x32_bf16 v[28:31], v[84:87], a[112:115], v[28:31]
    ds_read_b128 v[124:127], v14 offset:19456
    v_mfma_f32_16x16x32_bf16 v[48:51], v[84:87], a[116:119], v[48:51]
    v_mfma_f32_16x16x32_bf16 v[32:35], v[88:91], a[112:115], v[32:35]
    ds_read_b128 v[80:83], v14 offset:20480
    v_mfma_f32_16x16x32_bf16 v[52:55], v[88:91], a[116:119], v[52:55]
    s_waitcnt vmcnt(6) lgkmcnt(5)
    v_mfma_f32_16x16x32_bf16 v[16:19], v[92:95], a[120:123], v[16:19]
    ds_read_b128 v[84:87], v14 offset:21504
    v_mfma_f32_16x16x32_bf16 v[36:39], v[92:95], a[124:127], v[36:39]
    buffer_load_dwordx4 a[152:155], v2, s[4:7], s80 offen offset:3072 sc1
    v_mfma_f32_16x16x32_bf16 v[20:23], v[96:99], a[120:123], v[20:23]
    ds_read_b128 v[88:91], v14 offset:22528
    v_mfma_f32_16x16x32_bf16 v[40:43], v[96:99], a[124:127], v[40:43]
    v_mfma_f32_16x16x32_bf16 v[24:27], v[100:103], a[120:123], v[24:27]
    ds_read_b128 v[92:95], v14 offset:23552
    v_mfma_f32_16x16x32_bf16 v[44:47], v[100:103], a[124:127], v[44:47]
    buffer_load_dwordx4 a[156:159], v2, s[4:7], s81 offen offset:3072 sc1
    v_mfma_f32_16x16x32_bf16 v[28:31], v[104:107], a[120:123], v[28:31]
    ds_read_b128 v[96:99], v14 offset:24576
    v_mfma_f32_16x16x32_bf16 v[48:51], v[104:107], a[124:127], v[48:51]
    v_mfma_f32_16x16x32_bf16 v[32:35], v[108:111], a[120:123], v[32:35]
    ds_read_b128 v[100:103], v14 offset:25600
    v_mfma_f32_16x16x32_bf16 v[52:55], v[108:111], a[124:127], v[52:55]
    s_waitcnt vmcnt(6) lgkmcnt(5)
    v_mfma_f32_16x16x32_bf16 v[16:19], v[112:115], a[128:131], v[16:19]
    ds_read_b128 v[104:107], v14 offset:26624
    v_mfma_f32_16x16x32_bf16 v[36:39], v[112:115], a[132:135], v[36:39]
    v_mfma_f32_16x16x32_bf16 v[20:23], v[116:119], a[128:131], v[20:23]
    ds_read_b128 v[108:111], v14 offset:27648
    s_mov_b32 m0, s82
    v_mfma_f32_16x16x32_bf16 v[40:43], v[116:119], a[132:135], v[40:43]
    buffer_load_dwordx4 v2, s[4:7], s83 offen sc1 lds
    v_mfma_f32_16x16x32_bf16 v[24:27], v[120:123], a[128:131], v[24:27]
    ds_read_b128 v[112:115], v14 offset:28672
    v_mfma_f32_16x16x32_bf16 v[44:47], v[120:123], a[132:135], v[44:47]
    v_mfma_f32_16x16x32_bf16 v[28:31], v[124:127], a[128:131], v[28:31]
    ds_read_b128 v[116:119], v14 offset:29696
    v_mfma_f32_16x16x32_bf16 v[48:51], v[124:127], a[132:135], v[48:51]
    buffer_load_dwordx4 v2, s[4:7], s83 offen offset:1024 sc1 lds
    v_mfma_f32_16x16x32_bf16 v[32:35], v[80:83], a[128:131], v[32:35]
    ds_read_b128 v[120:123], v14 offset:30720
    v_mfma_f32_16x16x32_bf16 v[52:55], v[80:83], a[132:135], v[52:55]
    s_waitcnt vmcnt(6) lgkmcnt(5)
    v_mfma_f32_16x16x32_bf16 v[16:19], v[84:87], a[136:139], v[16:19]
    ds_read_b128 v[124:127], v14 offset:31744
    v_mfma_f32_16x16x32_bf16 v[36:39], v[84:87], a[140:143], v[36:39]
    v_mfma_f32_16x16x32_bf16 v[20:23], v[88:91], a[136:139], v[20:23]
    ds_read_b128 v[80:83], v14 offset:32768
    v_mfma_f32_16x16x32_bf16 v[40:43], v[88:91], a[140:143], v[40:43]
    buffer_load_dwordx4 v2, s[4:7], s83 offen offset:2048 sc1 lds
    v_mfma_f32_16x16x32_bf16 v[24:27], v[92:95], a[136:139], v[24:27]
    ds_read_b128 v[84:87], v14 offset:33792
    v_mfma_f32_16x16x32_bf16 v[44:47], v[92:95], a[140:143], v[44:47]
    v_mfma_f32_16x16x32_bf16 v[28:31], v[96:99], a[136:139], v[28:31]
    ds_read_b128 v[88:91], v14 offset:34816
    v_mfma_f32_16x16x32_bf16 v[48:51], v[96:99], a[140:143], v[48:51]
    buffer_load_dwordx4 v2, s[4:7], s83 offen offset:3072 sc1 lds
    v_mfma_f32_16x16x32_bf16 v[32:35], v[100:103], a[136:139], v[32:35]
    ds_read_b128 v[92:95], v14 offset:35840
    v_mfma_f32_16x16x32_bf16 v[52:55], v[100:103], a[140:143], v[52:55]
    s_waitcnt vmcnt(6) lgkmcnt(5)
    v_mfma_f32_16x16x32_bf16 v[16:19], v[104:107], a[144:147], v[16:19]
    v_mfma_f32_16x16x32_bf16 v[36:39], v[104:107], a[148:151], v[36:39]
    v_mfma_f32_16x16x32_bf16 v[20:23], v[108:111], a[144:147], v[20:23]
    s_add_u32 s83, s83, 4096
    s_add_u32 s82, s82, 4096
    v_mfma_f32_16x16x32_bf16 v[40:43], v[108:111], a[148:151], v[40:43]
    s_mov_b32 m0, s82
    v_mfma_f32_16x16x32_bf16 v[24:27], v[112:115], a[144:147], v[24:27]
    buffer_load_dwordx4 v2, s[4:7], s83 offen sc1 lds
    v_mfma_f32_16x16x32_bf16 v[44:47], v[112:115], a[148:151], v[44:47]
    v_mfma_f32_16x16x32_bf16 v[28:31], v[116:119], a[144:147], v[28:31]
    v_mfma_f32_16x16x32_bf16 v[48:51], v[116:119], a[148:151], v[48:51]
    buffer_load_dwordx4 v2, s[4:7], s83 offen offset:1024 sc1 lds
    v_mfma_f32_16x16x32_bf16 v[32:35], v[120:123], a[144:147], v[32:35]
    v_mfma_f32_16x16x32_bf16 v[52:55], v[120:123], a[148:151], v[52:55]
    s_waitcnt vmcnt(6) lgkmcnt(0)
    v_mfma_f32_16x16x32_bf16 v[16:19], v[124:127], a[152:155], v[16:19]
    v_mfma_f32_16x16x32_bf16 v[36:39], v[124:127], a[156:159], v[36:39]
    v_mfma_f32_16x16x32_bf16 v[20:23], v[80:83], a[152:155], v[20:23]
    buffer_load_dwordx4 v2, s[4:7], s83 offen offset:2048 sc1 lds
    v_mfma_f32_16x16x32_bf16 v[40:43], v[80:83], a[156:159], v[40:43]
    v_mfma_f32_16x16x32_bf16 v[24:27], v[84:87], a[152:155], v[24:27]
    v_mfma_f32_16x16x32_bf16 v[44:47], v[84:87], a[156:159], v[44:47]
    v_mfma_f32_16x16x32_bf16 v[28:31], v[88:91], a[152:155], v[28:31]
    v_mfma_f32_16x16x32_bf16 v[48:51], v[88:91], a[156:159], v[48:51]
    buffer_load_dwordx4 v2, s[4:7], s83 offen offset:3072 sc1 lds
    v_mfma_f32_16x16x32_bf16 v[32:35], v[92:95], a[152:155], v[32:35]
    v_mfma_f32_16x16x32_bf16 v[52:55], v[92:95], a[156:159], v[52:55]
    s_barrier
    v_permlane16_swap_b32 v16, v36
    v_permlane16_swap_b32 v17, v37
    v_permlane16_swap_b32 v18, v38
    v_permlane16_swap_b32 v19, v39
    v_permlane16_swap_b32 v20, v40
    v_permlane16_swap_b32 v21, v41
    v_permlane16_swap_b32 v22, v42
    v_permlane16_swap_b32 v23, v43
    v_permlane16_swap_b32 v24, v44
    s_add_u32 s83, s83, 4096
    s_add_u32 s82, s82, 4096
    s_mov_b32 m0, s82
    s_nop 0
    buffer_load_dwordx4 v2, s[4:7], s83 offen sc1 lds
    v_permlane16_swap_b32 v25, v45
    v_permlane16_swap_b32 v26, v46
    v_permlane16_swap_b32 v27, v47
    v_permlane16_swap_b32 v28, v48
    v_permlane16_swap_b32 v29, v49
    v_permlane16_swap_b32 v30, v50
    v_permlane16_swap_b32 v31, v51
    v_permlane16_swap_b32 v32, v52
    v_permlane16_swap_b32 v33, v53
    v_permlane16_swap_b32 v34, v54
    v_permlane16_swap_b32 v35, v55
    v_max3_f32 v240, v16, v17, v18
    v_min3_f32 v242, v16, v17, v18
    v_max3_f32 v240, v240, v19, v20
    v_min3_f32 v242, v242, v19, v20
    v_max3_f32 v240, v240, v21, v22
    buffer_load_dwordx4 v2, s[4:7], s83 offen offset:1024 sc1 lds
    v_min3_f32 v242, v242, v21, v22
    v_max3_f32 v240, v240, v23, v24
    v_min3_f32 v242, v242, v23, v24
    v_max3_f32 v240, v240, v25, v26
    v_min3_f32 v242, v242, v25, v26
    v_max3_f32 v240, v240, v27, v28
    v_min3_f32 v242, v242, v27, v28
    v_max3_f32 v240, v240, v29, v30
    v_min3_f32 v242, v242, v29, v30
    v_max3_f32 v240, v240, v31, v32
    v_min3_f32 v242, v242, v31, v32
    v_max3_f32 v240, v240, v33, v34
    v_min3_f32 v242, v242, v33, v34
    v_max_f32 v240, v240, v35
    v_min_f32 v242, v242, v35
    v_mul_f32 v240, s62, v240
    buffer_load_dwordx4 v2, s[4:7], s83 offen offset:2048 sc1 lds
    v_mul_f32 v242, s62, v242
    v_pk_fma_f32 v[112:113], v[16:17], s[62:63], v[240:241] op_sel_hi:[1,1,0] neg_lo:[0,0,1] neg_hi:[0,0,1]
    v_pk_fma_f32 v[132:133], v[16:17], s[62:63], v[242:243] op_sel_hi:[1,1,0] neg_lo:[1,0,0] neg_hi:[1,0,0]
    v_pk_fma_f32 v[114:115], v[18:19], s[62:63], v[240:241] op_sel_hi:[1,1,0] neg_lo:[0,0,1] neg_hi:[0,0,1]
    v_pk_fma_f32 v[134:135], v[18:19], s[62:63], v[242:243] op_sel_hi:[1,1,0] neg_lo:[1,0,0] neg_hi:[1,0,0]
    v_pk_fma_f32 v[116:117], v[20:21], s[62:63], v[240:241] op_sel_hi:[1,1,0] neg_lo:[0,0,1] neg_hi:[0,0,1]
    v_pk_fma_f32 v[136:137], v[20:21], s[62:63], v[242:243] op_sel_hi:[1,1,0] neg_lo:[1,0,0] neg_hi:[1,0,0]
    v_pk_fma_f32 v[118:119], v[22:23], s[62:63], v[240:241] op_sel_hi:[1,1,0] neg_lo:[0,0,1] neg_hi:[0,0,1]
    v_pk_fma_f32 v[138:139], v[22:23], s[62:63], v[242:243] op_sel_hi:[1,1,0] neg_lo:[1,0,0] neg_hi:[1,0,0]
    v_pk_fma_f32 v[120:121], v[24:25], s[62:63], v[240:241] op_sel_hi:[1,1,0] neg_lo:[0,0,1] neg_hi:[0,0,1]
    v_pk_fma_f32 v[140:141], v[24:25], s[62:63], v[242:243] op_sel_hi:[1,1,0] neg_lo:[1,0,0] neg_hi:[1,0,0]
    v_pk_fma_f32 v[122:123], v[26:27], s[62:63], v[240:241] op_sel_hi:[1,1,0] neg_lo:[0,0,1] neg_hi:[0,0,1]
    v_pk_fma_f32 v[142:143], v[26:27], s[62:63], v[242:243] op_sel_hi:[1,1,0] neg_lo:[1,0,0] neg_hi:[1,0,0]
    v_pk_fma_f32 v[124:125], v[28:29], s[62:63], v[240:241] op_sel_hi:[1,1,0] neg_lo:[0,0,1] neg_hi:[0,0,1]
    v_pk_fma_f32 v[144:145], v[28:29], s[62:63], v[242:243] op_sel_hi:[1,1,0] neg_lo:[1,0,0] neg_hi:[1,0,0]
    v_pk_fma_f32 v[126:127], v[30:31], s[62:63], v[240:241] op_sel_hi:[1,1,0] neg_lo:[0,0,1] neg_hi:[0,0,1]
    buffer_load_dwordx4 v2, s[4:7], s83 offen offset:3072 sc1 lds
    v_pk_fma_f32 v[146:147], v[30:31], s[62:63], v[242:243] op_sel_hi:[1,1,0] neg_lo:[1,0,0] neg_hi:[1,0,0]
    v_pk_fma_f32 v[128:129], v[32:33], s[62:63], v[240:241] op_sel_hi:[1,1,0] neg_lo:[0,0,1] neg_hi:[0,0,1]
    v_pk_fma_f32 v[148:149], v[32:33], s[62:63], v[242:243] op_sel_hi:[1,1,0] neg_lo:[1,0,0] neg_hi:[1,0,0]
    v_pk_fma_f32 v[130:131], v[34:35], s[62:63], v[240:241] op_sel_hi:[1,1,0] neg_lo:[0,0,1] neg_hi:[0,0,1]
    v_pk_fma_f32 v[150:151], v[34:35], s[62:63], v[242:243] op_sel_hi:[1,1,0] neg_lo:[1,0,0] neg_hi:[1,0,0]
    v_exp_f32 v112, v112
    v_exp_f32 v113, v113
    v_exp_f32 v114, v114
    v_exp_f32 v115, v115
    v_exp_f32 v116, v116
    v_exp_f32 v117, v117
    v_exp_f32 v118, v118
    v_exp_f32 v119, v119
    v_exp_f32 v120, v120
    v_exp_f32 v121, v121
    v_exp_f32 v122, v122
    s_add_u32 s83, s83, 4096
    s_add_u32 s82, s82, 4096
    s_mov_b32 m0, s82
    s_nop 0
    buffer_load_dwordx4 v2, s[4:7], s83 offen sc1 lds
    v_exp_f32 v123, v123
    v_exp_f32 v124, v124
    v_exp_f32 v125, v125
    v_exp_f32 v126, v126
    v_exp_f32 v127, v127
    v_exp_f32 v128, v128
    v_exp_f32 v129, v129
    v_exp_f32 v130, v130
    v_exp_f32 v131, v131
    v_exp_f32 v132, v132
    v_exp_f32 v133, v133
    v_exp_f32 v134, v134
    v_exp_f32 v135, v135
    v_exp_f32 v136, v136
    v_exp_f32 v137, v137
    v_exp_f32 v138, v138
    buffer_load_dwordx4 v2, s[4:7], s83 offen offset:1024 sc1 lds
    v_exp_f32 v139, v139
    v_exp_f32 v140, v140
    v_exp_f32 v141, v141
    v_exp_f32 v142, v142
    v_exp_f32 v143, v143
    v_exp_f32 v144, v144
    v_exp_f32 v145, v145
    v_exp_f32 v146, v146
    v_exp_f32 v147, v147
    v_exp_f32 v148, v148
    v_exp_f32 v149, v149
    v_exp_f32 v150, v150
    v_exp_f32 v151, v151
    v_pk_add_f32 v[244:245], v[112:113], v[114:115]
    v_pk_add_f32 v[246:247], v[132:133], v[134:135]
    v_pk_add_f32 v[244:245], v[244:245], v[116:117]
    buffer_load_dwordx4 v2, s[4:7], s83 offen offset:2048 sc1 lds
    v_pk_add_f32 v[246:247], v[246:247], v[136:137]
    v_pk_add_f32 v[244:245], v[244:245], v[118:119]
    v_pk_add_f32 v[246:247], v[246:247], v[138:139]
    v_pk_add_f32 v[244:245], v[244:245], v[120:121]
    v_pk_add_f32 v[246:247], v[246:247], v[140:141]
    v_pk_add_f32 v[244:245], v[244:245], v[122:123]
    v_pk_add_f32 v[246:247], v[246:247], v[142:143]
    v_pk_add_f32 v[244:245], v[244:245], v[124:125]
    v_pk_add_f32 v[246:247], v[246:247], v[144:145]
    v_pk_add_f32 v[244:245], v[244:245], v[126:127]
    v_pk_add_f32 v[246:247], v[246:247], v[146:147]
    v_pk_add_f32 v[244:245], v[244:245], v[128:129]
    v_pk_add_f32 v[246:247], v[246:247], v[148:149]
    v_pk_add_f32 v[244:245], v[244:245], v[130:131]
    v_pk_add_f32 v[246:247], v[246:247], v[150:151]
    v_add_f32 v244, v244, v245
    s_add_u32 m0, s3, 61440
    s_nop 0
    buffer_load_dwordx4 v206, s[36:39], s91 offen lds
    v_add_f32 v246, v246, v247
    v_rcp_f32 v246, v246
    v_rcp_f32 v244, v244
    s_nop 0
    v_pk_mul_f32 v[112:113], v[112:113], v[244:245] op_sel_hi:[1,0]
    v_pk_mul_f32 v[114:115], v[114:115], v[244:245] op_sel_hi:[1,0]
    v_pk_mul_f32 v[116:117], v[116:117], v[244:245] op_sel_hi:[1,0]
    v_pk_mul_f32 v[118:119], v[118:119], v[244:245] op_sel_hi:[1,0]
    v_pk_mul_f32 v[120:121], v[120:121], v[244:245] op_sel_hi:[1,0]
    v_pk_mul_f32 v[122:123], v[122:123], v[244:245] op_sel_hi:[1,0]
    v_pk_mul_f32 v[124:125], v[124:125], v[244:245] op_sel_hi:[1,0]
    v_pk_mul_f32 v[126:127], v[126:127], v[244:245] op_sel_hi:[1,0]
    v_pk_mul_f32 v[128:129], v[128:129], v[244:245] op_sel_hi:[1,0]
    v_pk_mul_f32 v[130:131], v[130:131], v[244:245] op_sel_hi:[1,0]
    v_pk_mul_f32 v[132:133], v[132:133], v[246:247] op_sel_hi:[1,0]
    v_pk_mul_f32 v[134:135], v[134:135], v[246:247] op_sel_hi:[1,0]
    v_pk_mul_f32 v[136:137], v[136:137], v[246:247] op_sel_hi:[1,0]
    s_add_u32 s91, s91, 27648
    s_add_u32 m0, s3, 62464
    s_nop 0
    buffer_load_dwordx4 v207, s[36:39], s91 offen lds
    v_pk_mul_f32 v[138:139], v[138:139], v[246:247] op_sel_hi:[1,0]
    v_pk_mul_f32 v[140:141], v[140:141], v[246:247] op_sel_hi:[1,0]
    v_pk_mul_f32 v[142:143], v[142:143], v[246:247] op_sel_hi:[1,0]
    v_pk_mul_f32 v[144:145], v[144:145], v[246:247] op_sel_hi:[1,0]
    v_pk_mul_f32 v[146:147], v[146:147], v[246:247] op_sel_hi:[1,0]
    v_pk_mul_f32 v[148:149], v[148:149], v[246:247] op_sel_hi:[1,0]
    v_pk_mul_f32 v[150:151], v[150:151], v[246:247] op_sel_hi:[1,0]
    v_cvt_pk_bf16_f32 v152, v112, v113
    v_cvt_pk_bf16_f32 v153, v114, v115
    v_cvt_pk_bf16_f32 v154, v116, v117
    v_cvt_pk_bf16_f32 v155, v118, v119
    v_cvt_pk_bf16_f32 v156, v120, v121
    v_cvt_pk_bf16_f32 v157, v122, v123
    v_cvt_pk_bf16_f32 v158, v124, v125
    v_cvt_pk_bf16_f32 v159, v126, v127
    v_cvt_pk_bf16_f32 v160, v128, v129
    s_add_u32 s91, s91, 27648
    s_add_u32 m0, s3, 63488
    s_nop 0
    buffer_load_dwordx4 v206, s[36:39], s91 offen lds
    v_cvt_pk_bf16_f32 v161, v130, v131
    v_cvt_pk_bf16_f32 v162, v132, v133
    v_cvt_pk_bf16_f32 v163, v134, v135
    v_cvt_pk_bf16_f32 v164, v136, v137
    v_cvt_pk_bf16_f32 v165, v138, v139
    v_cvt_pk_bf16_f32 v166, v140, v141
    v_cvt_pk_bf16_f32 v167, v142, v143
    v_cvt_pk_bf16_f32 v168, v144, v145
    v_cvt_pk_bf16_f32 v169, v146, v147
    v_cvt_pk_bf16_f32 v170, v148, v149
    v_cvt_pk_bf16_f32 v171, v150, v151
    v_cvt_pk_bf16_f32 v172, v36, v37
    v_cvt_pk_bf16_f32 v173, v38, v39
    v_cvt_pk_bf16_f32 v174, v40, v41
    v_cvt_pk_bf16_f32 v175, v42, v43
    v_cvt_pk_bf16_f32 v176, v44, v45
    s_add_u32 s91, s91, 27648
    s_add_u32 m0, s3, 64512
    s_nop 0
    buffer_load_dwordx4 v207, s[36:39], s91 offen lds
    v_cvt_pk_bf16_f32 v177, v46, v47
    v_cvt_pk_bf16_f32 v178, v48, v49
    v_cvt_pk_bf16_f32 v179, v50, v51
    v_cvt_pk_bf16_f32 v180, v52, v53
    v_cvt_pk_bf16_f32 v181, v54, v55
    s_add_u32 s91, s91, 27648
    s_add_u32 m0, s3, 65536
    s_nop 0
    buffer_load_dwordx4 v206, s[36:39], s91 offen lds
    s_add_u32 m0, s3, 81920
    s_nop 0
    buffer_load_dwordx4 v210, s[20:23], s90 offen lds
    s_add_u32 s90, s90, 61440
    s_add_u32 m0, s3, 82944
    s_nop 0
    buffer_load_dwordx4 v211, s[20:23], s90 offen lds
    s_add_u32 s90, s90, 61440
    s_add_u32 m0, s3, 83968
    s_nop 0
    buffer_load_dwordx4 v210, s[20:23], s90 offen lds
    s_add_u32 s90, s90, 61440
    s_add_u32 m0, s3, 84992
    s_nop 0
    buffer_load_dwordx4 v211, s[20:23], s90 offen lds
    s_add_u32 s90, s90, 61440
    s_add_u32 m0, s3, 86016
    s_nop 0
    buffer_load_dwordx4 v210, s[20:23], s90 offen lds
    buffer_load_dword v251, v250, s[4:7], 0 offen sc1
    v_mov_b32 v182, 0x3f80
    v_mov_b32 v183, 0
    ds_write_b128 v200, v[152:155]
    ds_write_b128 v200, v[156:159] offset:16
    ds_write_b128 v200, v[160:163] offset:32
    ds_write_b128 v200, v[164:167] offset:48
    ds_write_b128 v200, v[168:171] offset:64
    ds_write_b128 v200, v[172:175] offset:80
    ds_write_b128 v200, v[176:179] offset:96
    ds_write_b128 v200, v[180:183] offset:112
    s_waitcnt vmcnt(11)
    s_waitcnt lgkmcnt(0)
    s_barrier
    ds_read_b64_tr_b16 v[112:113], v201
    ds_read_b64_tr_b16 v[114:115], v201 offset:2304
    ds_read_b64_tr_b16 v[116:117], v201 offset:32
    ds_read_b64_tr_b16 v[118:119], v201 offset:2336
    ds_read_b64_tr_b16 v[120:121], v201 offset:64
    ds_read_b64_tr_b16 v[122:123], v201 offset:2368
    ds_read_b64_tr_b16 v[124:125], v202 offset:64
    ds_read_b64_tr_b16 v[126:127], v202 offset:2368
    ds_read_b64_tr_b16 v[128:129], v201 offset:4608
    ds_read_b64_tr_b16 v[130:131], v201 offset:6912
    ds_read_b64_tr_b16 v[132:133], v201 offset:4640
    ds_read_b64_tr_b16 v[134:135], v201 offset:6944
    ds_read_b64_tr_b16 v[136:137], v201 offset:4672
    ds_read_b64_tr_b16 v[138:139], v201 offset:6976
    ds_read_b64_tr_b16 v[140:141], v202 offset:4672
    ds_read_b64_tr_b16 v[142:143], v202 offset:6976
    ds_read_b64_tr_b16 v[144:145], v201 offset:9216
    ds_read_b64_tr_b16 v[146:147], v201 offset:11520
    ds_read_b64_tr_b16 v[148:149], v201 offset:9248
    ds_read_b64_tr_b16 v[150:151], v201 offset:11552
    ds_read_b64_tr_b16 v[152:153], v201 offset:9280
    ds_read_b64_tr_b16 v[154:155], v201 offset:11584
    ds_read_b64_tr_b16 v[156:157], v202 offset:9280
    ds_read_b64_tr_b16 v[158:159], v202 offset:11584
    ds_read_b64_tr_b16 v[160:161], v201 offset:13824
    ds_read_b64_tr_b16 v[162:163], v201 offset:16128
    ds_read_b64_tr_b16 v[164:165], v201 offset:13856
    ds_read_b64_tr_b16 v[166:167], v201 offset:16160
    ds_read_b64_tr_b16 v[168:169], v201 offset:13888
    ds_read_b64_tr_b16 v[170:171], v201 offset:16192
    ds_read_b64_tr_b16 v[172:173], v202 offset:13888
    ds_read_b64_tr_b16 v[174:175], v202 offset:16192
    s_waitcnt lgkmcnt(15)
    v_mfma_f32_16x16x32_bf16 v[24:27], v[112:115], v[124:127], 0
    v_mfma_f32_16x16x32_bf16 v[28:31], v[116:119], v[124:127], 0
    v_mfma_f32_16x16x32_bf16 v[32:35], v[120:123], v[124:127], 0
    v_mfma_f32_16x16x32_bf16 v[24:27], v[128:131], v[140:143], v[24:27]
    v_mfma_f32_16x16x32_bf16 v[28:31], v[132:135], v[140:143], v[28:31]
    v_mfma_f32_16x16x32_bf16 v[32:35], v[136:139], v[140:143], v[32:35]
    s_waitcnt lgkmcnt(8)
    v_mfma_f32_16x16x32_bf16 v[24:27], v[144:147], v[156:159], v[24:27]
    v_mfma_f32_16x16x32_bf16 v[28:31], v[148:151], v[156:159], v[28:31]
    v_mfma_f32_16x16x32_bf16 v[32:35], v[152:155], v[156:159], v[32:35]
    s_waitcnt lgkmcnt(0)
    v_mfma_f32_16x16x32_bf16 v[24:27], v[160:163], v[172:175], v[24:27]
    v_mfma_f32_16x16x32_bf16 v[28:31], v[164:167], v[172:175], v[28:31]
    v_mfma_f32_16x16x32_bf16 v[32:35], v[168:171], v[172:175], v[32:35]
    s_nop 5
    v_cvt_pk_bf16_f32 v36, v24, v25
    v_cvt_pk_bf16_f32 v37, v26, v27
    v_cvt_pk_bf16_f32 v38, v28, v29
    v_cvt_pk_bf16_f32 v39, v30, v31
    v_cvt_pk_bf16_f32 v40, v32, v33
    v_cvt_pk_bf16_f32 v41, v34, v35
    buffer_store_dwordx4 v[36:39], v213, s[4:7], s16 offen sc1
    buffer_store_dwordx2 v[40:41], v214, s[4:7], s16 offen offset:1344 sc1
    ds_read_b128 v[80:83], v2
    ds_read_b128 v[84:87], v2 offset:1024
    ds_read_b128 v[88:91], v2 offset:2048
    ds_read_b128 v[92:95], v2 offset:3072
    ds_read_b128 v[96:99], v2 offset:4096
    ds_read_b128 v[100:103], v2 offset:5120
    ds_read_b128 v[104:107], v2 offset:6144
    s_waitcnt lgkmcnt(4)
    v_mfma_f32_16x16x32_bf16 v[56:59], v[80:83], a[0:3], 0
    ds_read_b128 v[108:111], v2 offset:7168
    v_mfma_f32_16x16x32_bf16 v[68:71], v[80:83], a[4:7], 0
    v_mfma_f32_16x16x32_bf16 v[60:63], v[84:87], a[0:3], 0
    ds_read_b128 v[80:83], v2 offset:8192
    v_mfma_f32_16x16x32_bf16 v[72:75], v[84:87], a[4:7], 0
    v_mfma_f32_16x16x32_bf16 v[64:67], v[88:91], a[0:3], 0
    ds_read_b128 v[84:87], v2 offset:9216
    v_mfma_f32_16x16x32_bf16 v[76:79], v[88:91], a[4:7], 0
    s_waitcnt lgkmcnt(4)
    v_mfma_f32_16x16x32_bf16 v[56:59], v[92:95], a[8:11], v[56:59]
    ds_read_b128 v[88:91], v2 offset:10240
    v_mfma_f32_16x16x32_bf16 v[68:71], v[92:95], a[12:15], v[68:71]
    v_mfma_f32_16x16x32_bf16 v[60:63], v[96:99], a[8:11], v[60:63]
    ds_read_b128 v[92:95], v2 offset:11264
    v_mfma_f32_16x16x32_bf16 v[72:75], v[96:99], a[12:15], v[72:75]
    v_mfma_f32_16x16x32_bf16 v[64:67], v[100:103], a[8:11], v[64:67]
    ds_read_b128 v[96:99], v2 offset:12288
    v_mfma_f32_16x16x32_bf16 v[76:79], v[100:103], a[12:15], v[76:79]
    s_waitcnt lgkmcnt(4)
    v_mfma_f32_16x16x32_bf16 v[56:59], v[104:107], a[16:19], v[56:59]
    ds_read_b128 v[100:103], v2 offset:13312
    v_mfma_f32_16x16x32_bf16 v[68:71], v[104:107], a[20:23], v[68:71]
    v_mfma_f32_16x16x32_bf16 v[60:63], v[108:111], a[16:19], v[60:63]
    ds_read_b128 v[104:107], v2 offset:14336
    v_mfma_f32_16x16x32_bf16 v[72:75], v[108:111], a[20:23], v[72:75]
    v_mfma_f32_16x16x32_bf16 v[64:67], v[80:83], a[16:19], v[64:67]
    ds_read_b128 v[108:111], v2 offset:15360
    v_mfma_f32_16x16x32_bf16 v[76:79], v[80:83], a[20:23], v[76:79]
    s_waitcnt lgkmcnt(4)
    v_mfma_f32_16x16x32_bf16 v[56:59], v[84:87], a[24:27], v[56:59]
    ds_read_b128 v[80:83], v2 offset:16384
    v_mfma_f32_16x16x32_bf16 v[68:71], v[84:87], a[28:31], v[68:71]
    v_mfma_f32_16x16x32_bf16 v[60:63], v[88:91], a[24:27], v[60:63]
    ds_read_b128 v[84:87], v2 offset:17408
    v_mfma_f32_16x16x32_bf16 v[72:75], v[88:91], a[28:31], v[72:75]
    v_mfma_f32_16x16x32_bf16 v[64:67], v[92:95], a[24:27], v[64:67]
    ds_read_b128 v[88:91], v2 offset:18432
    v_mfma_f32_16x16x32_bf16 v[76:79], v[92:95], a[28:31], v[76:79]
    s_waitcnt lgkmcnt(4)
    v_mfma_f32_16x16x32_bf16 v[56:59], v[96:99], a[32:35], v[56:59]
    ds_read_b128 v[92:95], v2 offset:19456
    v_mfma_f32_16x16x32_bf16 v[68:71], v[96:99], a[36:39], v[68:71]
    v_mfma_f32_16x16x32_bf16 v[60:63], v[100:103], a[32:35], v[60:63]
    ds_read_b128 v[96:99], v2 offset:20480
    v_mfma_f32_16x16x32_bf16 v[72:75], v[100:103], a[36:39], v[72:75]
    v_mfma_f32_16x16x32_bf16 v[64:67], v[104:107], a[32:35], v[64:67]
    ds_read_b128 v[100:103], v2 offset:21504
    v_mfma_f32_16x16x32_bf16 v[76:79], v[104:107], a[36:39], v[76:79]
    s_waitcnt lgkmcnt(4)
    v_mfma_f32_16x16x32_bf16 v[56:59], v[108:111], a[40:43], v[56:59]
    ds_read_b128 v[104:107], v2 offset:22528
    v_mfma_f32_16x16x32_bf16 v[68:71], v[108:111], a[44:47], v[68:71]
    s_waitcnt vmcnt(0)
    s_barrier
    v_mov_b32 v50, s40
    s_mov_b64 exec, 1
    buffer_store_dword v50, off, s[4:7], s17 sc1
    s_mov_b64 exec, -1
    s_mov_b32 s96, 400000
L_spin_7:
    v_cmp_ne_u32 vcc, s40, v251
    s_nop 0
    s_cmp_eq_u64 vcc, 0
    s_cbranch_scc1 L_seen_8
    s_sleep 1
    buffer_load_dword v251, v250, s[4:7], 0 offen sc1
    s_waitcnt vmcnt(0)
    s_sub_u32 s96, s96, 1
    s_cbranch_scc0 L_spin_7
L_seen_8:
    v_mfma_f32_16x16x32_bf16 v[60:63], v[80:83], a[40:43], v[60:63]
    ds_read_b128 v[108:111], v2 offset:23552
    ds_read_b64_tr_b16 v[176:177], v208
    v_mfma_f32_16x16x32_bf16 v[72:75], v[80:83], a[44:47], v[72:75]
    ds_read_b64_tr_b16 v[178:179], v208 offset:512
    ds_read_b64_tr_b16 v[180:181], v208 offset:4096
    v_mfma_f32_16x16x32_bf16 v[64:67], v[84:87], a[40:43], v[64:67]
    ds_read_b128 v[80:83], v2 offset:24576
    ds_read_b64_tr_b16 v[182:183], v208 offset:4608
    v_mfma_f32_16x16x32_bf16 v[76:79], v[84:87], a[44:47], v[76:79]
    ds_read_b64_tr_b16 v[184:185], v208 offset:8192
    s_waitcnt lgkmcnt(9)
    v_mfma_f32_16x16x32_bf16 v[56:59], v[88:91], a[48:51], v[56:59]
    ds_read_b128 v[84:87], v2 offset:25600
    ds_read_b64_tr_b16 v[186:187], v208 offset:8704
    v_mfma_f32_16x16x32_bf16 v[68:71], v[88:91], a[52:55], v[68:71]
    ds_read_b64_tr_b16 v[188:189], v208 offset:12288
    ds_read_b64_tr_b16 v[190:191], v208 offset:12800
    v_mfma_f32_16x16x32_bf16 v[60:63], v[92:95], a[48:51], v[60:63]
    ds_read_b128 v[88:91], v2 offset:26624
    ds_read_b64_tr_b16 v[192:193], v208 offset:16384
    v_mfma_f32_16x16x32_bf16 v[72:75], v[92:95], a[52:55], v[72:75]
    ds_read_b64_tr_b16 v[194:195], v208 offset:16896
    v_and_b32 v44, 48, v1
    v_mfma_f32_16x16x32_bf16 v[64:67], v[96:99], a[48:51], v[64:67]
    ds_read_b128 v[92:95], v2 offset:27648
    ds_read_b64_tr_b16 v[132:133], v208 offset:20480
    v_mfma_f32_16x16x32_bf16 v[76:79], v[96:99], a[52:55], v[76:79]
    ds_read_b64_tr_b16 v[134:135], v208 offset:20992
    s_waitcnt lgkmcnt(15)
    v_mfma_f32_16x16x32_bf16 v[56:59], v[100:103], a[56:59], v[56:59]
    ds_read_b128 v[96:99], v2 offset:28672
    ds_read_b64_tr_b16 v[136:137], v208 offset:24576
    v_mfma_f32_16x16x32_bf16 v[68:71], v[100:103], a[60:63], v[68:71]
    ds_read_b64_tr_b16 v[138:139], v208 offset:25088
    ds_read_b64_tr_b16 v[140:141], v208 offset:28672
    v_mfma_f32_16x16x32_bf16 v[60:63], v[104:107], a[56:59], v[60:63]
    ds_read_b128 v[100:103], v2 offset:29696
    ds_read_b64_tr_b16 v[142:143], v208 offset:29184
    v_mfma_f32_16x16x32_bf16 v[72:75], v[104:107], a[60:63], v[72:75]
    ds_read_b64_tr_b16 v[144:145], v208 offset:32768
    ds_read_b64_tr_b16 v[146:147], v208 offset:33280
    v_mfma_f32_16x16x32_bf16 v[64:67], v[108:111], a[56:59], v[64:67]
    ds_read_b128 v[104:107], v2 offset:30720
    ds_read_b64_tr_b16 v[148:149], v208 offset:36864
    v_mfma_f32_16x16x32_bf16 v[76:79], v[108:111], a[60:63], v[76:79]
    ds_read_b64_tr_b16 v[150:151], v208 offset:37376
    s_waitcnt lgkmcnt(15)
    v_mfma_f32_16x16x32_bf16 v[56:59], v[80:83], a[64:67], v[56:59]
    ds_read_b128 v[108:111], v2 offset:31744
    s_mov_b32 m0, s25
    v_mfma_f32_16x16x32_bf16 v[68:71], v[80:83], a[68:71], v[68:71]
    buffer_load_dwordx4 v2, s[4:7], s26 offen sc1 lds
    v_mfma_f32_16x16x32_bf16 v[60:63], v[84:87], a[64:67], v[60:63]
    ds_read_b128 v[80:83], v2 offset:32768
    buffer_load_dwordx4 v2, s[4:7], s26 offen offset:1024 sc1 lds
    v_mfma_f32_16x16x32_bf16 v[72:75], v[84:87], a[68:71], v[72:75]
    s_waitcnt lgkmcnt(13)
    v_mfma_f32_16x16x32_bf16 v[46:49], v[132:135], v[216:219], 0
    s_waitcnt lgkmcnt(10)
    v_mfma_f32_16x16x32_bf16 v[46:49], v[136:139], v[220:223], v[46:49]
    v_mfma_f32_16x16x32_bf16 v[64:67], v[88:91], a[64:67], v[64:67]
    ds_read_b128 v[84:87], v2 offset:33792
    s_waitcnt lgkmcnt(8)
    v_mfma_f32_16x16x32_bf16 v[46:49], v[140:143], v[224:227], v[46:49]
    v_mfma_f32_16x16x32_bf16 v[76:79], v[88:91], a[68:71], v[76:79]
    s_waitcnt lgkmcnt(6)
    v_mfma_f32_16x16x32_bf16 v[46:49], v[144:147], v[228:231], v[46:49]
    s_waitcnt lgkmcnt(3)
    v_mfma_f32_16x16x32_bf16 v[46:49], v[148:151], v[232:235], v[46:49]
    v_mfma_f32_16x16x32_bf16 v[56:59], v[92:95], a[72:75], v[56:59]
    ds_read_b128 v[88:91], v2 offset:34816
    buffer_load_dwordx4 v2, s[4:7], s26 offen offset:2048 sc1 lds
    v_mfma_f32_16x16x32_bf16 v[68:71], v[92:95], a[76:79], v[68:71]
    buffer_load_dwordx4 v2, s[4:7], s26 offen offset:3072 sc1 lds
    v_mfma_f32_16x16x32_bf16 v[60:63], v[96:99], a[72:75], v[60:63]
    ds_read_b128 v[92:95], v2 offset:35840
    s_add_u32 s26, s26, 4096
    v_mfma_f32_16x16x32_bf16 v[72:75], v[96:99], a[76:79], v[72:75]
    s_add_u32 s25, s25, 4096
    s_mov_b32 m0, s25
    v_mfma_f32_16x16x32_bf16 v[64:67], v[100:103], a[72:75], v[64:67]
    ds_read_b128 v[96:99], v2 offset:36864
    v_add_u32 v46, 0x80, v46
    v_mfma_f32_16x16x32_bf16 v[76:79], v[100:103], a[76:79], v[76:79]
    v_add_u32 v47, 0x80, v47
    s_waitcnt lgkmcnt(4)
    v_mfma_f32_16x16x32_bf16 v[56:59], v[104:107], a[80:83], v[56:59]
    ds_read_b128 v[100:103], v2 offset:37888
    v_add_u32 v48, 0x80, v48
    v_mfma_f32_16x16x32_bf16 v[68:71], v[104:107], a[84:87], v[68:71]
    v_add_u32 v49, 0x80, v49
    v_and_b32 v46, 0xffffff00, v46
    v_mfma_f32_16x16x32_bf16 v[60:63], v[108:111], a[80:83], v[60:63]
    ds_read_b128 v[104:107], v2 offset:38912
    v_and_b32 v47, 0xffffff00, v47
    v_mfma_f32_16x16x32_bf16 v[72:75], v[108:111], a[84:87], v[72:75]
    v_and_b32 v48, 0xffffff00, v48
    v_and_b32 v49, 0xffffff00, v49
    v_mfma_f32_16x16x32_bf16 v[64:67], v[80:83], a[80:83], v[64:67]
    ds_read_b128 v[108:111], v2 offset:39936
    v_or_b32 v46, s76, v46
    v_mfma_f32_16x16x32_bf16 v[76:79], v[80:83], a[84:87], v[76:79]
    v_or_b32 v47, s77, v47
    s_waitcnt lgkmcnt(4)
    v_mfma_f32_16x16x32_bf16 v[56:59], v[84:87], a[88:91], v[56:59]
    ds_read_b128 v[80:83], v2 offset:40960
    v_or_b32 v48, s78, v48
    v_mfma_f32_16x16x32_bf16 v[68:71], v[84:87], a[92:95], v[68:71]
    v_or_b32 v49, s79, v49
    buffer_load_dwordx4 v2, s[4:7], s26 offen sc1 lds
    v_mfma_f32_16x16x32_bf16 v[60:63], v[88:91], a[88:91], v[60:63]
    ds_read_b128 v[84:87], v2 offset:41984
    buffer_load_dwordx4 v2, s[4:7], s26 offen offset:1024 sc1 lds
    v_mfma_f32_16x16x32_bf16 v[72:75], v[88:91], a[92:95], v[72:75]
    s_mov_b32 exec_lo, 0x00010001
    s_mov_b32 exec_hi, 0x00010001
    buffer_store_dwordx4 v[46:49], v44, s[4:7], s97 offen sc1
    s_mov_b64 exec, -1
    v_mfma_f32_16x16x32_bf16 v[64:67], v[92:95], a[88:91], v[64:67]
    ds_read_b128 v[88:91], v2 offset:43008
    buffer_store_dwordx4 v[176:179], v2, s[4:7], s92 offen sc1
    v_mfma_f32_16x16x32_bf16 v[76:79], v[92:95], a[92:95], v[76:79]
    s_add_u32 s92, s92, s93
    s_waitcnt lgkmcnt(4)
    v_mfma_f32_16x16x32_bf16 v[56:59], v[96:99], a[96:99], v[56:59]
    ds_read_b128 v[92:95], v2 offset:44032
    buffer_store_dwordx4 v[180:183], v2, s[4:7], s92 offen sc1
    v_mfma_f32_16x16x32_bf16 v[68:71], v[96:99], a[100:103], v[68:71]
    s_add_u32 s92, s92, s93
    v_mfma_f32_16x16x32_bf16 v[60:63], v[100:103], a[96:99], v[60:63]
    ds_read_b128 v[96:99], v2 offset:45056
    v_mfma_f32_16x16x32_bf16 v[72:75], v[100:103], a[100:103], v[72:75]
    buffer_store_dwordx4 v[184:187], v2, s[4:7], s92 offen sc1
    v_mfma_f32_16x16x32_bf16 v[64:67], v[104:107], a[96:99], v[64:67]
    ds_read_b128 v[100:103], v2 offset:46080
    v_mfma_f32_16x16x32_bf16 v[76:79], v[104:107], a[100:103], v[76:79]
    s_add_u32 s92, s92, s93
    s_waitcnt lgkmcnt(4)
    v_mfma_f32_16x16x32_bf16 v[56:59], v[108:111], a[104:107], v[56:59]
    ds_read_b128 v[104:107], v2 offset:47104
    v_mfma_f32_16x16x32_bf16 v[68:71], v[108:111], a[108:111], v[68:71]
    s_waitcnt lgkmcnt(0)
    s_barrier
    v_mfma_f32_16x16x32_bf16 v[60:63], v[80:83], a[104:107], v[60:63]
    ds_read_b128 v[108:111], v2 offset:48128
    buffer_store_dwordx4 v[188:191], v2, s[4:7], s92 offen sc1
    v_mfma_f32_16x16x32_bf16 v[72:75], v[80:83], a[108:111], v[72:75]
    v_mfma_f32_16x16x32_bf16 v[64:67], v[84:87], a[104:107], v[64:67]
    ds_read_b128 v[80:83], v2 offset:49152
    s_add_u32 s92, s92, s93
    v_mfma_f32_16x16x32_bf16 v[76:79], v[84:87], a[108:111], v[76:79]
    buffer_store_dwordx4 v[192:195], v2, s[4:7], s92 offen sc1
    v_mfma_f32_16x16x32_bf16 v[56:59], v[88:91], a[112:115], v[56:59]
    ds_read_b128 v[84:87], v2 offset:50176
    v_mfma_f32_16x16x32_bf16 v[68:71], v[88:91], a[116:119], v[68:71]
    v_mfma_f32_16x16x32_bf16 v[60:63], v[92:95], a[112:115], v[60:63]
    ds_read_b128 v[88:91], v2 offset:51200
    v_mfma_f32_16x16x32_bf16 v[72:75], v[92:95], a[116:119], v[72:75]
    buffer_store_dwordx4 v[216:219], v203, s[4:7], s95 offen sc1
    v_mfma_f32_16x16x32_bf16 v[64:67], v[96:99], a[112:115], v[64:67]
    ds_read_b128 v[92:95], v2 offset:52224
    v_mfma_f32_16x16x32_bf16 v[76:79], v[96:99], a[116:119], v[76:79]
    s_waitcnt lgkmcnt(4)
    v_mfma_f32_16x16x32_bf16 v[56:59], v[100:103], a[120:123], v[56:59]
    ds_read_b128 v[96:99], v2 offset:53248
    v_mfma_f32_16x16x32_bf16 v[68:71], v[100:103], a[124:127], v[68:71]
    v_mfma_f32_16x16x32_bf16 v[60:63], v[104:107], a[120:123], v[60:63]
    ds_read_b128 v[100:103], v2 offset:54272
    v_mfma_f32_16x16x32_bf16 v[72:75], v[104:107], a[124:127], v[72:75]
    buffer_store_dwordx4 v[220:223], v203, s[4:7], s95 offen offset:1024 sc1
    v_mfma_f32_16x16x32_bf16 v[64:67], v[108:111], a[120:123], v[64:67]
    ds_read_b128 v[104:107], v2 offset:55296
    v_mfma_f32_16x16x32_bf16 v[76:79], v[108:111], a[124:127], v[76:79]
    s_waitcnt lgkmcnt(4)
    v_mfma_f32_16x16x32_bf16 v[56:59], v[80:83], a[128:131], v[56:59]
    ds_read_b128 v[108:111], v2 offset:56320
    v_mfma_f32_16x16x32_bf16 v[68:71], v[80:83], a[132:135], v[68:71]
    buffer_store_dwordx4 v[224:227], v203, s[4:7], s95 offen offset:2048 sc1
    v_mfma_f32_16x16x32_bf16 v[60:63], v[84:87], a[128:131], v[60:63]
    ds_read_b128 v[80:83], v2 offset:57344
    v_mfma_f32_16x16x32_bf16 v[72:75], v[84:87], a[132:135], v[72:75]
    v_mfma_f32_16x16x32_bf16 v[64:67], v[88:91], a[128:131], v[64:67]
    ds_read_b128 v[84:87], v2 offset:58368
    v_mfma_f32_16x16x32_bf16 v[76:79], v[88:91], a[132:135], v[76:79]
    s_waitcnt lgkmcnt(4)
    v_mfma_f32_16x16x32_bf16 v[56:59], v[92:95], a[136:139], v[56:59]
    ds_read_b128 v[88:91], v2 offset:59392
    v_mfma_f32_16x16x32_bf16 v[68:71], v[92:95], a[140:143], v[68:71]
    buffer_store_dwordx4 v[228:231], v203, s[4:7], s95 offen offset:3072 sc1
    v_mfma_f32_16x16x32_bf16 v[60:63], v[96:99], a[136:139], v[60:63]
    ds_read_b128 v[92:95], v2 offset:60416
    v_mfma_f32_16x16x32_bf16 v[72:75], v[96:99], a[140:143], v[72:75]
    v_mfma_f32_16x16x32_bf16 v[64:67], v[100:103], a[136:139], v[64:67]
    v_mfma_f32_16x16x32_bf16 v[76:79], v[100:103], a[140:143], v[76:79]
    s_add_u32 s95, s95, 4096
    s_waitcnt lgkmcnt(3)
    v_mfma_f32_16x16x32_bf16 v[56:59], v[104:107], a[144:147], v[56:59]
    buffer_store_dwordx4 v[232:235], v203, s[4:7], s95 offen sc1
    v_mfma_f32_16x16x32_bf16 v[68:71], v[104:107], a[148:151], v[68:71]
    v_mfma_f32_16x16x32_bf16 v[60:63], v[108:111], a[144:147], v[60:63]
    v_mfma_f32_16x16x32_bf16 v[72:75], v[108:111], a[148:151], v[72:75]
    v_mfma_f32_16x16x32_bf16 v[64:67], v[80:83], a[144:147], v[64:67]
    s_mov_b32 m0, s51
    v_mfma_f32_16x16x32_bf16 v[76:79], v[80:83], a[148:151], v[76:79]
    s_waitcnt lgkmcnt(0)
    v_mfma_f32_16x16x32_bf16 v[56:59], v[84:87], a[152:155], v[56:59]
    buffer_load_dwordx4 v2, s[4:7], s52 offen sc1 lds
    v_mfma_f32_16x16x32_bf16 v[68:71], v[84:87], a[156:159], v[68:71]
    v_mfma_f32_16x16x32_bf16 v[60:63], v[88:91], a[152:155], v[60:63]
    v_mfma_f32_16x16x32_bf16 v[72:75], v[88:91], a[156:159], v[72:75]
    buffer_load_dwordx4 v2, s[4:7], s52 offen offset:1024 sc1 lds
    v_mfma_f32_16x16x32_bf16 v[64:67], v[92:95], a[152:155], v[64:67]
    v_mfma_f32_16x16x32_bf16 v[76:79], v[92:95], a[156:159], v[76:79]
    buffer_load_dword v253, v252, s[4:7], 0 offen sc1
    s_nop 1
    v_permlane16_swap_b32 v56, v68
    v_permlane16_swap_b32 v57, v69
    v_permlane16_swap_b32 v58, v70
    v_permlane16_swap_b32 v59, v71
    v_permlane16_swap_b32 v60, v72
    v_permlane16_swap_b32 v61, v73
    v_permlane16_swap_b32 v62, v74
    v_permlane16_swap_b32 v63, v75
    v_permlane16_swap_b32 v64, v76
    v_permlane16_swap_b32 v65, v77
    v_permlane16_swap_b32 v66, v78
    v_permlane16_swap_b32 v67, v79
    v_max3_f32 v240, v56, v57, v58
    v_min3_f32 v242, v56, v57, v58
    v_max3_f32 v240, v240, v59, v60
    v_min3_f32 v242, v242, v59, v60
    v_max3_f32 v240, v240, v61, v62
    v_min3_f32 v242, v242, v61, v62
    v_max3_f32 v240, v240, v63, v64
    v_min3_f32 v242, v242, v63, v64
    v_max3_f32 v240, v240, v65, v66
    v_min3_f32 v242, v242, v65, v66
    v_max3_f32 v240, v240, v67, v68
    v_min3_f32 v242, v242, v67, v68
    v_max3_f32 v240, v240, v69, v70
    v_min3_f32 v242, v242, v69, v70
    v_max3_f32 v240, v240, v71, v72
    v_min3_f32 v242, v242, v71, v72
    v_max3_f32 v240, v240, v73, v74
    v_min3_f32 v242, v242, v73, v74
    v_max_f32 v240, v240, v75
    v_min_f32 v242, v242, v75
    v_mul_f32 v240, s62, v240
    v_mul_f32 v242, s62, v242
    v_pk_fma_f32 v[112:113], v[56:57], s[62:63], v[240:241] op_sel_hi:[1,1,0] neg_lo:[0,0,1] neg_hi:[0,0,1]
    v_pk_fma_f32 v[132:133], v[56:57], s[62:63], v[242:243] op_sel_hi:[1,1,0] neg_lo:[1,0,0] neg_hi:[1,0,0]
    v_pk_fma_f32 v[114:115], v[58:59], s[62:63], v[240:241] op_sel_hi:[1,1,0] neg_lo:[0,0,1] neg_hi:[0,0,1]
    v_pk_fma_f32 v[134:135], v[58:59], s[62:63], v[242:243] op_sel_hi:[1,1,0] neg_lo:[1,0,0] neg_hi:[1,0,0]
    v_pk_fma_f32 v[116:117], v[60:61], s[62:63], v[240:241] op_sel_hi:[1,1,0] neg_lo:[0,0,1] neg_hi:[0,0,1]
    v_pk_fma_f32 v[136:137], v[60:61], s[62:63], v[242:243] op_sel_hi:[1,1,0] neg_lo:[1,0,0] neg_hi:[1,0,0]
    v_pk_fma_f32 v[118:119], v[62:63], s[62:63], v[240:241] op_sel_hi:[1,1,0] neg_lo:[0,0,1] neg_hi:[0,0,1]
    v_pk_fma_f32 v[138:139], v[62:63], s[62:63], v[242:243] op_sel_hi:[1,1,0] neg_lo:[1,0,0] neg_hi:[1,0,0]
    v_pk_fma_f32 v[120:121], v[64:65], s[62:63], v[240:241] op_sel_hi:[1,1,0] neg_lo:[0,0,1] neg_hi:[0,0,1]
    v_pk_fma_f32 v[140:141], v[64:65], s[62:63], v[242:243] op_sel_hi:[1,1,0] neg_lo:[1,0,0] neg_hi:[1,0,0]
    v_pk_fma_f32 v[122:123], v[66:67], s[62:63], v[240:241] op_sel_hi:[1,1,0] neg_lo:[0,0,1] neg_hi:[0,0,1]
    v_pk_fma_f32 v[142:143], v[66:67], s[62:63], v[242:243] op_sel_hi:[1,1,0] neg_lo:[1,0,0] neg_hi:[1,0,0]
    v_pk_fma_f32 v[124:125], v[68:69], s[62:63], v[240:241] op_sel_hi:[1,1,0] neg_lo:[0,0,1] neg_hi:[0,0,1]
    v_pk_fma_f32 v[144:145], v[68:69], s[62:63], v[242:243] op_sel_hi:[1,1,0] neg_lo:[1,0,0] neg_hi:[1,0,0]
    v_pk_fma_f32 v[126:127], v[70:71], s[62:63], v[240:241] op_sel_hi:[1,1,0] neg_lo:[0,0,1] neg_hi:[0,0,1]
    v_pk_fma_f32 v[146:147], v[70:71], s[62:63], v[242:243] op_sel_hi:[1,1,0] neg_lo:[1,0,0] neg_hi:[1,0,0]
    v_pk_fma_f32 v[128:129], v[72:73], s[62:63], v[240:241] op_sel_hi:[1,1,0] neg_lo:[0,0,1] neg_hi:[0,0,1]
    s_waitcnt vmcnt(0)
    v_cmp_ne_u32 vcc, s40, v253
    s_nop 0
    s_cmp_eq_u64 vcc, 0
    s_cbranch_scc1 L_seen_10
    s_mov_b32 s96, 400000
    buffer_load_dword v253, v252, s[4:7], 0 offen sc1
L_spin_9:
    s_sleep 3
    buffer_load_dword v255, v252, s[4:7], 0 offen sc1
    s_waitcnt vmcnt(1)
    v_cmp_ne_u32 vcc, s40, v253
    s_nop 0
    s_cmp_eq_u64 vcc, 0
    s_cbranch_scc1 L_seen_10
    s_sleep 3
    buffer_load_dword v253, v252, s[4:7], 0 offen sc1
    s_waitcnt vmcnt(1)
    v_cmp_ne_u32 vcc, s40, v255
    s_nop 0
    s_cmp_eq_u64 vcc, 0
    s_cbranch_scc1 L_seen_10
    s_sub_u32 s96, s96, 1
    s_cbranch_scc0 L_spin_9
L_seen_10:
    v_pk_fma_f32 v[148:149], v[72:73], s[62:63], v[242:243] op_sel_hi:[1,1,0] neg_lo:[1,0,0] neg_hi:[1,0,0]
    buffer_load_dwordx4 v[16:19], v215, s[4:7], s18 offen sc1
    v_pk_fma_f32 v[130:131], v[74:75], s[62:63], v[240:241] op_sel_hi:[1,1,0] neg_lo:[0,0,1] neg_hi:[0,0,1]
    v_pk_fma_f32 v[150:151], v[74:75], s[62:63], v[242:243] op_sel_hi:[1,1,0] neg_lo:[1,0,0] neg_hi:[1,0,0]
    v_exp_f32 v112, v112
    v_exp_f32 v113, v113
    v_exp_f32 v114, v114
    buffer_load_dwordx4 v[20:23], v215, s[4:7], s18 offen offset:3584 sc1
    v_exp_f32 v115, v115
    v_exp_f32 v116, v116
    v_exp_f32 v117, v117
    v_exp_f32 v118, v118
    v_exp_f32 v119, v119
    s_add_u32 s18, s18, 7168
    buffer_load_dwordx4 v[24:27], v215, s[4:7], s18 offen sc1
    v_exp_f32 v120, v120
    v_exp_f32 v121, v121
    v_exp_f32 v122, v122
    v_exp_f32 v123, v123
    v_exp_f32 v124, v124
    buffer_load_dwordx4 v[28:31], v215, s[4:7], s18 offen offset:3584 sc1
    v_exp_f32 v125, v125
    v_exp_f32 v126, v126
    v_exp_f32 v127, v127
    v_exp_f32 v128, v128
    v_exp_f32 v129, v129
    s_add_u32 s18, s18, 7168
    buffer_load_dwordx4 v[32:35], v215, s[4:7], s18 offen sc1
    v_exp_f32 v130, v130
    v_exp_f32 v131, v131
    v_exp_f32 v132, v132
    v_exp_f32 v133, v133
    v_exp_f32 v134, v134
    buffer_load_dwordx4 v[36:39], v215, s[4:7], s18 offen offset:3584 sc1
    v_exp_f32 v135, v135
    v_exp_f32 v136, v136
    v_exp_f32 v137, v137
    v_exp_f32 v138, v138
    v_exp_f32 v139, v139
    s_add_u32 s18, s18, 7168
    buffer_load_dwordx4 v[40:43], v215, s[4:7], s18 offen sc1
    v_exp_f32 v140, v140
    v_exp_f32 v141, v141
    v_exp_f32 v142, v142
    v_exp_f32 v143, v143
    v_exp_f32 v144, v144
    buffer_load_dwordx4 v[44:47], v215, s[4:7], s18 offen offset:3584 sc1
    v_exp_f32 v145, v145
    v_exp_f32 v146, v146
    v_exp_f32 v147, v147
    v_exp_f32 v148, v148
    v_exp_f32 v149, v149
    s_add_u32 s18, s18, 7168
    buffer_load_dwordx4 v[48:51], v215, s[4:7], s18 offen sc1
    v_exp_f32 v150, v150
    v_exp_f32 v151, v151
    v_pk_add_f32 v[244:245], v[112:113], v[114:115]
    v_pk_add_f32 v[246:247], v[132:133], v[134:135]
    v_pk_add_f32 v[244:245], v[244:245], v[116:117]
    buffer_load_dwordx4 v[52:55], v215, s[4:7], s18 offen offset:3584 sc1
    v_pk_add_f32 v[246:247], v[246:247], v[136:137]
    v_pk_add_f32 v[244:245], v[244:245], v[118:119]
    v_pk_add_f32 v[246:247], v[246:247], v[138:139]
    v_pk_add_f32 v[244:245], v[244:245], v[120:121]
    v_pk_add_f32 v[246:247], v[246:247], v[140:141]
    s_add_u32 s18, s18, 7168
    buffer_load_dwordx4 v[80:83], v215, s[4:7], s18 offen sc1
    v_pk_add_f32 v[244:245], v[244:245], v[122:123]
    v_pk_add_f32 v[246:247], v[246:247], v[142:143]
    v_pk_add_f32 v[244:245], v[244:245], v[124:125]
    v_pk_add_f32 v[246:247], v[246:247], v[144:145]
    v_pk_add_f32 v[244:245], v[244:245], v[126:127]
    buffer_load_dwordx4 v[84:87], v215, s[4:7], s18 offen offset:3584 sc1
    v_pk_add_f32 v[246:247], v[246:247], v[146:147]
    v_pk_add_f32 v[244:245], v[244:245], v[128:129]
    v_pk_add_f32 v[246:247], v[246:247], v[148:149]
    v_pk_add_f32 v[244:245], v[244:245], v[130:131]
    v_pk_add_f32 v[246:247], v[246:247], v[150:151]
    s_add_u32 s18, s18, 7168
    buffer_load_dwordx4 v[88:91], v215, s[4:7], s18 offen sc1
    v_add_f32 v244, v244, v245
    v_add_f32 v246, v246, v247
    v_rcp_f32 v246, v246
    v_cvt_pk_bf16_f32 v152, v112, v113
    v_cvt_pk_bf16_f32 v153, v114, v115
    buffer_load_dwordx4 v[92:95], v215, s[4:7], s18 offen offset:3584 sc1
    v_cvt_pk_bf16_f32 v154, v116, v117
    v_cvt_pk_bf16_f32 v155, v118, v119
    v_cvt_pk_bf16_f32 v156, v120, v121
    v_cvt_pk_bf16_f32 v157, v122, v123
    v_cvt_pk_bf16_f32 v158, v124, v125
    s_add_u32 s18, s18, 7168
    buffer_load_dwordx4 v[96:99], v215, s[4:7], s18 offen sc1
    v_cvt_pk_bf16_f32 v159, v126, v127
    v_cvt_pk_bf16_f32 v160, v128, v129
    v_cvt_pk_bf16_f32 v161, v130, v131
    v_mul_f32 v246, v246, v244
    v_pk_mul_f32 v[132:133], v[132:133], v[246:247] op_sel_hi:[1,0]
    buffer_load_dwordx4 v[100:103], v215, s[4:7], s18 offen offset:3584 sc1
    v_pk_mul_f32 v[134:135], v[134:135], v[246:247] op_sel_hi:[1,0]
    v_pk_mul_f32 v[136:137], v[136:137], v[246:247] op_sel_hi:[1,0]
    v_pk_mul_f32 v[138:139], v[138:139], v[246:247] op_sel_hi:[1,0]
    v_pk_mul_f32 v[140:141], v[140:141], v[246:247] op_sel_hi:[1,0]
    v_pk_mul_f32 v[142:143], v[142:143], v[246:247] op_sel_hi:[1,0]
    v_pk_mul_f32 v[144:145], v[144:145], v[246:247] op_sel_hi:[1,0]
    v_pk_mul_f32 v[146:147], v[146:147], v[246:247] op_sel_hi:[1,0]
    v_pk_mul_f32 v[148:149], v[148:149], v[246:247] op_sel_hi:[1,0]
    v_pk_mul_f32 v[150:151], v[150:151], v[246:247] op_sel_hi:[1,0]
    v_cvt_pk_bf16_f32 v162, v132, v133
    v_cvt_pk_bf16_f32 v163, v134, v135
    v_cvt_pk_bf16_f32 v164, v136, v137
    v_cvt_pk_bf16_f32 v165, v138, v139
    v_cvt_pk_bf16_f32 v166, v140, v141
    v_cvt_pk_bf16_f32 v167, v142, v143
    v_cvt_pk_bf16_f32 v168, v144, v145
    v_cvt_pk_bf16_f32 v169, v146, v147
    v_cvt_pk_bf16_f32 v170, v148, v149
    v_cvt_pk_bf16_f32 v171, v150, v151
    buffer_load_dwordx4 v[116:119], v196, s[4:7], s68 offen sc1
    buffer_load_dwordx4 v[120:123], v196, s[4:7], s69 offen sc1
    buffer_load_dwordx4 v[124:127], v196, s[4:7], s70 offen sc1
    buffer_load_dwordx4 v[128:131], v196, s[4:7], s71 offen sc1
    v_mov_b32 v136, 0
    s_barrier
    ds_write_b32 v254, v136 offset:59392
    s_waitcnt vmcnt(19)
    v_dot2_f32_bf16 v104, v16, s48, 0
    v_dot2_f32_bf16 v105, v16, s49, 0
    v_dot2_f32_bf16 v106, v17, s48, 0
    v_dot2_f32_bf16 v107, v17, s49, 0
    v_dot2_f32_bf16 v108, v18, s48, 0
    v_dot2_f32_bf16 v109, v18, s49, 0
    v_dot2_f32_bf16 v110, v19, s48, 0
    v_dot2_f32_bf16 v111, v19, s49, 0
    s_waitcnt vmcnt(18)
    v_dot2_f32_bf16 v104, v20, s48, v104
    v_dot2_f32_bf16 v105, v20, s49, v105
    v_dot2_f32_bf16 v106, v21, s48, v106
    v_dot2_f32_bf16 v107, v21, s49, v107
    v_dot2_f32_bf16 v108, v22, s48, v108
    v_dot2_f32_bf16 v109, v22, s49, v109
    v_dot2_f32_bf16 v110, v23, s48, v110
    v_dot2_f32_bf16 v111, v23, s49, v111
    s_waitcnt vmcnt(17)
    v_dot2_f32_bf16 v104, v24, s48, v104
    v_dot2_f32_bf16 v105, v24, s49, v105
    v_dot2_f32_bf16 v106, v25, s48, v106
    v_dot2_f32_bf16 v107, v25, s49, v107
    v_dot2_f32_bf16 v108, v26, s48, v108
    v_dot2_f32_bf16 v109, v26, s49, v109
    v_dot2_f32_bf16 v110, v27, s48, v110
    v_dot2_f32_bf16 v111, v27, s49, v111
    s_waitcnt vmcnt(16)
    v_dot2_f32_bf16 v104, v28, s48, v104
    v_dot2_f32_bf16 v105, v28, s49, v105
    v_dot2_f32_bf16 v106, v29, s48, v106
    v_dot2_f32_bf16 v107, v29, s49, v107
    v_dot2_f32_bf16 v108, v30, s48, v108
    v_dot2_f32_bf16 v109, v30, s49, v109
    v_dot2_f32_bf16 v110, v31, s48, v110
    v_dot2_f32_bf16 v111, v31, s49, v111
    s_waitcnt vmcnt(15)
    v_dot2_f32_bf16 v104, v32, s48, v104
    v_dot2_f32_bf16 v105, v32, s49, v105
    v_dot2_f32_bf16 v106, v33, s48, v106
    v_dot2_f32_bf16 v107, v33, s49, v107
    v_dot2_f32_bf16 v108, v34, s48, v108
    v_dot2_f32_bf16 v109, v34, s49, v109
    v_dot2_f32_bf16 v110, v35, s48, v110
    v_dot2_f32_bf16 v111, v35, s49, v111
    s_waitcnt vmcnt(14)
    v_dot2_f32_bf16 v104, v36, s48, v104
    v_dot2_f32_bf16 v105, v36, s49, v105
    v_dot2_f32_bf16 v106, v37, s48, v106
    v_dot2_f32_bf16 v107, v37, s49, v107
    v_dot2_f32_bf16 v108, v38, s48, v108
    v_dot2_f32_bf16 v109, v38, s49, v109
    v_dot2_f32_bf16 v110, v39, s48, v110
    v_dot2_f32_bf16 v111, v39, s49, v111
    s_waitcnt vmcnt(13)
    v_dot2_f32_bf16 v104, v40, s48, v104
    v_dot2_f32_bf16 v105, v40, s49, v105
    v_dot2_f32_bf16 v106, v41, s48, v106
    v_dot2_f32_bf16 v107, v41, s49, v107
    v_dot2_f32_bf16 v108, v42, s48, v108
    v_dot2_f32_bf16 v109, v42, s49, v109
    v_dot2_f32_bf16 v110, v43, s48, v110
    v_dot2_f32_bf16 v111, v43, s49, v111
    buffer_load_dwordx4 v2, s[4:7], s52 offen offset:2048 sc1 lds
    s_waitcnt vmcnt(13)
    v_dot2_f32_bf16 v104, v44, s48, v104
    v_dot2_f32_bf16 v105, v44, s49, v105
    v_dot2_f32_bf16 v106, v45, s48, v106
    v_dot2_f32_bf16 v107, v45, s49, v107
    v_dot2_f32_bf16 v108, v46, s48, v108
    v_dot2_f32_bf16 v109, v46, s49, v109
    v_dot2_f32_bf16 v110, v47, s48, v110
    v_dot2_f32_bf16 v111, v47, s49, v111
    buffer_load_dwordx4 v2, s[4:7], s52 offen offset:3072 sc1 lds
    s_waitcnt vmcnt(13)
    v_dot2_f32_bf16 v104, v48, s48, v104
    v_dot2_f32_bf16 v105, v48, s49, v105
    v_dot2_f32_bf16 v106, v49, s48, v106
    v_dot2_f32_bf16 v107, v49, s49, v107
    v_dot2_f32_bf16 v108, v50, s48, v108
    v_dot2_f32_bf16 v109, v50, s49, v109
    v_dot2_f32_bf16 v110, v51, s48, v110
    v_dot2_f32_bf16 v111, v51, s49, v111
    s_add_u32 s52, s52, 4096
    s_add_u32 s51, s51, 4096
    s_mov_b32 m0, s51
    s_nop 0
    buffer_load_dwordx4 v2, s[4:7], s52 offen sc1 lds
    s_waitcnt vmcnt(13)
    v_dot2_f32_bf16 v104, v52, s48, v104
    v_dot2_f32_bf16 v105, v52, s49, v105
    v_dot2_f32_bf16 v106, v53, s48, v106
    v_dot2_f32_bf16 v107, v53, s49, v107
    v_dot2_f32_bf16 v108, v54, s48, v108
    v_dot2_f32_bf16 v109, v54, s49, v109
    v_dot2_f32_bf16 v110, v55, s48, v110
    v_dot2_f32_bf16 v111, v55, s49, v111
    buffer_load_dwordx4 v2, s[4:7], s52 offen offset:1024 sc1 lds
    s_waitcnt vmcnt(13)
    v_dot2_f32_bf16 v104, v80, s48, v104
    v_dot2_f32_bf16 v105, v80, s49, v105
    v_dot2_f32_bf16 v106, v81, s48, v106
    v_dot2_f32_bf16 v107, v81, s49, v107
    v_dot2_f32_bf16 v108, v82, s48, v108
    v_dot2_f32_bf16 v109, v82, s49, v109
    v_dot2_f32_bf16 v110, v83, s48, v110
    v_dot2_f32_bf16 v111, v83, s49, v111
    buffer_load_dwordx4 v2, s[4:7], s52 offen offset:2048 sc1 lds
    s_waitcnt vmcnt(13)
    v_dot2_f32_bf16 v104, v84, s48, v104
    v_dot2_f32_bf16 v105, v84, s49, v105
    v_dot2_f32_bf16 v106, v85, s48, v106
    v_dot2_f32_bf16 v107, v85, s49, v107
    v_dot2_f32_bf16 v108, v86, s48, v108
    v_dot2_f32_bf16 v109, v86, s49, v109
    v_dot2_f32_bf16 v110, v87, s48, v110
    v_dot2_f32_bf16 v111, v87, s49, v111
    buffer_load_dwordx4 v2, s[4:7], s52 offen offset:3072 sc1 lds
    s_waitcnt vmcnt(13)
    v_dot2_f32_bf16 v104, v88, s48, v104
    v_dot2_f32_bf16 v105, v88, s49, v105
    v_dot2_f32_bf16 v106, v89, s48, v106
    v_dot2_f32_bf16 v107, v89, s49, v107
    v_dot2_f32_bf16 v108, v90, s48, v108
    v_dot2_f32_bf16 v109, v90, s49, v109
    v_dot2_f32_bf16 v110, v91, s48, v110
    v_dot2_f32_bf16 v111, v91, s49, v111
    s_add_u32 s52, s52, 4096
    s_add_u32 s51, s51, 4096
    s_mov_b32 m0, s51
    s_nop 0
    buffer_load_dwordx4 v2, s[4:7], s52 offen sc1 lds
    s_waitcnt vmcnt(13)
    v_dot2_f32_bf16 v104, v92, s48, v104
    v_dot2_f32_bf16 v105, v92, s49, v105
    v_dot2_f32_bf16 v106, v93, s48, v106
    v_dot2_f32_bf16 v107, v93, s49, v107
    v_dot2_f32_bf16 v108, v94, s48, v108
    v_dot2_f32_bf16 v109, v94, s49, v109
    v_dot2_f32_bf16 v110, v95, s48, v110
    v_dot2_f32_bf16 v111, v95, s49, v111
    s_mov_b32 m0, s53
    s_nop 0
    buffer_load_dwordx4 v2, s[4:7], s54 offen sc1 lds
    s_waitcnt vmcnt(13)
    v_dot2_f32_bf16 v104, v96, s48, v104
    v_dot2_f32_bf16 v105, v96, s49, v105
    v_dot2_f32_bf16 v106, v97, s48, v106
    v_dot2_f32_bf16 v107, v97, s49, v107
    v_dot2_f32_bf16 v108, v98, s48, v108
    v_dot2_f32_bf16 v109, v98, s49, v109
    v_dot2_f32_bf16 v110, v99, s48, v110
    v_dot2_f32_bf16 v111, v99, s49, v111
    buffer_load_dwordx4 v2, s[4:7], s54 offen offset:1024 sc1 lds
    s_waitcnt vmcnt(13)
    v_dot2_f32_bf16 v104, v100, s48, v104
    v_dot2_f32_bf16 v105, v100, s49, v105
    v_dot2_f32_bf16 v106, v101, s48, v106
    v_dot2_f32_bf16 v107, v101, s49, v107
    v_dot2_f32_bf16 v108, v102, s48, v108
    v_dot2_f32_bf16 v109, v102, s49, v109
    v_dot2_f32_bf16 v110, v103, s48, v110
    v_dot2_f32_bf16 v111, v103, s49, v111
    buffer_load_dwordx4 v2, s[4:7], s54 offen offset:2048 sc1 lds
    v_cvt_pk_bf16_f32 v132, v104, v105
    v_cvt_pk_bf16_f32 v133, v106, v107
    v_cvt_pk_bf16_f32 v134, v108, v109
    v_cvt_pk_bf16_f32 v135, v110, v111
    ds_write_b64 v236, v[132:133]
    ds_write_b64 v237, v[134:135]
    s_waitcnt lgkmcnt(0)
    s_barrier
    ds_read_b128 v[48:51], v238
    ds_read_b128 v[52:55], v239
    ds_read_b128 v[80:83], v238 offset:16
    ds_read_b128 v[84:87], v239 offset:16
    ds_read_b128 v[88:91], v238 offset:32
    ds_read_b128 v[92:95], v239 offset:32
    ds_read_b128 v[96:99], v238 offset:48
    ds_read_b128 v[100:103], v239 offset:48
    ds_read_b128 v[104:107], v238 offset:64
    ds_read_b128 v[108:111], v239 offset:64
    v_mov_b32 v137, s40
    s_mov_b64 exec, 1
    buffer_store_dword v137, off, s[4:7], s86 sc1
    s_mov_b64 exec, -1
    s_waitcnt lgkmcnt(8)
    v_mfma_f32_32x32x16_bf16 v[32:47], v[52:55], v[152:155], 0
    v_mfma_f32_32x32x16_bf16 v[16:31], v[48:51], v[152:155], 0
    s_waitcnt lgkmcnt(6)
    v_mfma_f32_32x32x16_bf16 v[32:47], v[84:87], v[156:159], v[32:47]
    v_mfma_f32_32x32x16_bf16 v[16:31], v[80:83], v[156:159], v[16:31]
    s_waitcnt lgkmcnt(4)
    v_mfma_f32_32x32x16_bf16 v[32:47], v[92:95], v[160:163], v[32:47]
    v_mfma_f32_32x32x16_bf16 v[16:31], v[88:91], v[160:163], v[16:31]
    s_waitcnt lgkmcnt(2)
    v_mfma_f32_32x32x16_bf16 v[32:47], v[100:103], v[164:167], v[32:47]
    v_mfma_f32_32x32x16_bf16 v[16:31], v[96:99], v[164:167], v[16:31]
    s_waitcnt lgkmcnt(0)
    v_mfma_f32_32x32x16_bf16 v[32:47], v[108:111], v[168:171], v[32:47]
    v_mfma_f32_32x32x16_bf16 v[16:31], v[104:107], v[168:171], v[16:31]
    s_nop 10
    v_fmac_f32 v36, 0x358637bd, v244
    v_rcp_f32 v36, v36
    s_nop 0
    v_pk_mul_f32 v[16:17], v[16:17], v[36:37] op_sel_hi:[1,0]
    v_pk_mul_f32 v[18:19], v[18:19], v[36:37] op_sel_hi:[1,0]
    v_pk_mul_f32 v[20:21], v[20:21], v[36:37] op_sel_hi:[1,0]
    v_pk_mul_f32 v[22:23], v[22:23], v[36:37] op_sel_hi:[1,0]
    v_pk_mul_f32 v[24:25], v[24:25], v[36:37] op_sel_hi:[1,0]
    v_pk_mul_f32 v[26:27], v[26:27], v[36:37] op_sel_hi:[1,0]
    v_pk_mul_f32 v[28:29], v[28:29], v[36:37] op_sel_hi:[1,0]
    v_pk_mul_f32 v[30:31], v[30:31], v[36:37] op_sel_hi:[1,0]
    v_pk_mul_f32 v[32:33], v[32:33], v[36:37] op_sel_hi:[1,0]
    v_pk_mul_f32 v[34:35], v[34:35], v[36:37] op_sel_hi:[1,0]
    v_cvt_pk_bf16_f32 v48, v16, v17
    v_cvt_pk_bf16_f32 v49, v18, v19
    v_cvt_pk_bf16_f32 v50, v20, v21
    v_cvt_pk_bf16_f32 v51, v22, v23
    v_cvt_pk_bf16_f32 v52, v24, v25
    v_cvt_pk_bf16_f32 v53, v26, v27
    v_cvt_pk_bf16_f32 v54, v28, v29
    v_cvt_pk_bf16_f32 v55, v30, v31
    v_cvt_pk_bf16_f32 v56, v32, v33
    v_cvt_pk_bf16_f32 v57, v34, v35
    buffer_store_dwordx4 v[48:51], v248, s[4:7], s19 offen sc1
    buffer_store_dwordx4 v[52:55], v248, s[4:7], s19 offen offset:256 sc1
    buffer_store_dwordx2 v[56:57], v249, s[4:7], s19 offen offset:512 sc1
    s_mov_b32 s96, 400000
    s_waitcnt vmcnt(14)
L_spin_11:
    v_xor_b32 v116, s76, v116
    v_xor_b32 v117, s77, v117
    v_or_b32 v136, v116, v117
    v_xor_b32 v118, s78, v118
    v_xor_b32 v119, s79, v119
    v_or3_b32 v136, v118, v119, v136
    v_xor_b32 v120, s76, v120
    v_xor_b32 v121, s77, v121
    v_or3_b32 v136, v120, v121, v136
    v_xor_b32 v122, s78, v122
    v_xor_b32 v123, s79, v123
    v_or3_b32 v136, v122, v123, v136
    v_xor_b32 v124, s76, v124
    v_xor_b32 v125, s77, v125
    v_or3_b32 v136, v124, v125, v136
    v_xor_b32 v126, s78, v126
    v_xor_b32 v127, s79, v127
    v_or3_b32 v136, v126, v127, v136
    v_xor_b32 v128, s76, v128
    v_xor_b32 v129, s77, v129
    v_or3_b32 v136, v128, v129, v136
    v_xor_b32 v130, s78, v130
    v_xor_b32 v131, s79, v131
    v_or3_b32 v136, v130, v131, v136
    v_and_b32 v136, 0xff, v136
    v_cmp_ne_u32 vcc, 0, v136
    s_nop 0
    s_cmp_eq_u64 vcc, 0
    s_cbranch_scc1 L_seen_12
    s_sleep 1
    buffer_load_dwordx4 v[116:119], v196, s[4:7], s68 offen sc1
    buffer_load_dwordx4 v[120:123], v196, s[4:7], s69 offen sc1
    buffer_load_dwordx4 v[124:127], v196, s[4:7], s70 offen sc1
    buffer_load_dwordx4 v[128:131], v196, s[4:7], s71 offen sc1
    s_waitcnt vmcnt(0)
    s_sub_u32 s96, s96, 1
    s_cbranch_scc0 L_spin_11
L_seen_12:
    v_pk_add_f32 v[116:117], v[116:117], v[120:121]
    v_pk_add_f32 v[124:125], v[124:125], v[128:129]
    v_pk_add_f32 v[118:119], v[118:119], v[122:123]
    v_pk_add_f32 v[126:127], v[126:127], v[130:131]
    v_pk_add_f32 v[116:117], v[116:117], v[124:125]
    v_pk_add_f32 v[118:119], v[118:119], v[126:127]
    v_cvt_pk_bf16_f32 v120, v116, v117
    v_cvt_pk_bf16_f32 v121, v118, v119
    v_lshlrev_b32 v116, 16, v120
    v_and_b32 v117, 0xffff0000, v120
    v_lshlrev_b32 v118, 16, v121
    v_and_b32 v119, 0xffff0000, v121
    v_pk_add_f32 v[116:117], v[116:117], v[198:199] op_sel_hi:[1,0]
    v_pk_add_f32 v[118:119], v[118:119], v[198:199] op_sel_hi:[1,0]
    v_cvt_pk_bf16_f32 v120, v116, v117
    v_cvt_pk_bf16_f32 v121, v118, v119
    v_lshlrev_b32 v132, 16, v120
    v_and_b32 v133, 0xffff0000, v120
    v_lshlrev_b32 v134, 16, v121
    v_and_b32 v135, 0xffff0000, v121
    ds_write_b128 v197, v[132:135]
    ds_write_b64 v199, v[120:121]
    s_lshr_b32 s43, s47, 2
    s_and_b32 s56, s2, 7
    s_lshr_b32 s56, s56, 2
    s_lshl3_add_u32 s43, s56, s43
    s_and_b32 s44, s47, 3
    s_and_b32 s56, s2, 3
    s_lshl2_add_u32 s44, s56, s44
    s_lshl2_add_u32 s80, s45, s42
    s_mul_i32 s80, s80, 0x5000
    s_add_u32 s80, s80, 0x720000
    s_lshr_b32 s56, s42, 1
    s_lshl1_add_u32 s56, s45, s56
    s_lshl_b32 s56, s56, 11
    s_add_u32 s56, s56, 0x50000
    v_and_b32 v68, 15, v1
    v_lshl_add_u32 v68, v68, 7, s56
    s_waitcnt vmcnt(0)
    v_mov_b32 v113, s40
    s_mov_b64 exec, 1
    buffer_store_dword v113, off, s[4:7], s24 sc1
    s_mov_b64 exec, -1
    buffer_load_dwordx4 v2, s[4:7], s54 offen offset:3072 sc1 lds
    s_add_u32 s54, s54, 4096
    s_add_u32 s53, s53, 4096
    s_mov_b32 m0, s53
    s_nop 0
    buffer_load_dwordx4 v2, s[4:7], s54 offen sc1 lds
    buffer_load_dwordx4 v2, s[4:7], s54 offen offset:1024 sc1 lds
    buffer_load_dwordx4 v2, s[4:7], s54 offen offset:2048 sc1 lds
    buffer_load_dwordx4 v2, s[4:7], s54 offen offset:3072 sc1 lds
    s_add_u32 s54, s54, 4096
    s_add_u32 s53, s53, 4096
    s_mov_b32 m0, s53
    s_nop 0
    buffer_load_dwordx4 v2, s[4:7], s54 offen sc1 lds
    buffer_load_dwordx4 v2, s[4:7], s54 offen offset:1024 sc1 lds
    buffer_load_dwordx4 a[160:163], v2, s[4:7], s84 offen sc1
    buffer_load_dwordx4 a[164:167], v2, s[4:7], s84 offen offset:1024 sc1
    buffer_load_dwordx4 a[168:171], v2, s[4:7], s84 offen offset:2048 sc1
    buffer_load_dwordx4 a[172:175], v2, s[4:7], s84 offen offset:3072 sc1
    s_add_u32 s84, s84, 4096
    buffer_load_dwordx4 a[176:179], v2, s[4:7], s84 offen sc1
    buffer_load_dwordx4 a[180:183], v2, s[4:7], s84 offen offset:1024 sc1
    buffer_load_dwordx4 a[184:187], v2, s[4:7], s84 offen offset:2048 sc1
    buffer_load_dwordx4 a[188:191], v2, s[4:7], s84 offen offset:3072 sc1
    s_add_u32 s84, s84, 4096
    buffer_load_dwordx4 a[192:195], v2, s[4:7], s84 offen sc1
    buffer_load_dwordx4 a[196:199], v2, s[4:7], s84 offen offset:1024 sc1
    buffer_load_dwordx4 a[200:203], v2, s[4:7], s84 offen offset:2048 sc1
    buffer_load_dwordx4 a[204:207], v2, s[4:7], s84 offen offset:3072 sc1
    s_add_u32 s84, s84, 4096
    buffer_load_dwordx4 a[208:211], v2, s[4:7], s84 offen sc1
    buffer_load_dwordx4 a[212:215], v2, s[4:7], s84 offen offset:1024 sc1
    buffer_load_dwordx4 a[216:219], v2, s[4:7], s84 offen offset:2048 sc1
    buffer_load_dwordx4 a[220:223], v2, s[4:7], s84 offen offset:3072 sc1
    s_add_u32 s84, s84, 4096
    buffer_load_dwordx4 a[224:227], v2, s[4:7], s84 offen sc1
    buffer_load_dwordx4 a[228:231], v2, s[4:7], s84 offen offset:1024 sc1
    buffer_load_dwordx4 a[232:235], v2, s[4:7], s84 offen offset:2048 sc1
    buffer_load_dwordx4 a[236:239], v2, s[4:7], s84 offen offset:3072 sc1
    buffer_load_dword v69, v68, s[4:7], 0 offen sc1
    s_mul_i32 s0, s44, 11
    s_lshr_b32 s0, s0, 2
    s_lshl_b32 s56, s44, 3
    v_add_u32 v112, s56, v1
    s_lshr_b32 s56, s0, 2
    s_min_u32 s56, s56, 9
    s_lshl_b32 s56, s56, 3
    s_add_u32 s56, s56, 0x78
    v_add_u32 v113, s56, v1
    v_cmp_gt_u32 vcc, 8, v1
    s_nop 1
    v_cndmask_b32 v196, v113, v112, vcc
    v_lshlrev_b32 v196, 7, v196
    v_add_u32 v196, 0x110000, v196
    s_lshr_b32 s56, s46, 2
    s_mul_i32 s56, s56, 26
    v_mov_b32 v112, s42
    s_add_u32 s57, s1, 0xffffffcb
    v_min_u32 v113, 30, v1
    v_add_u32 v113, s57, v113
    v_min_u32 v113, 25, v113
    v_cmp_eq_u32 vcc, 24, v1
    s_nop 1
    v_cndmask_b32 v197, v113, v112, vcc
    v_add_u32 v197, s56, v197
    v_lshlrev_b32 v197, 7, v197
    v_add_u32 v197, 0x117000, v197
    v_cmp_gt_u32 vcc, 24, v1
    s_nop 1
    v_cndmask_b32 v196, v197, v196, vcc
    v_and_b32 v141, 1, v1
    v_mul_u32_u24 v141, 0x140, v141
    v_add_u32 v141, 0xed80, v141
    v_lshrrev_b32 v136, 4, v1
    v_lshl_add_u32 v141, v136, 4, v141
    v_and_b32 v142, 1, v1
    v_mul_u32_u24 v142, 0x3600, v142
    v_lshrrev_b32 v136, 4, v1
    v_lshl_add_u32 v142, v136, 4, v142
    s_mul_i32 s86, s44, 0x28000
    s_lshl_b32 s56, s42, 12
    s_add_u32 s86, s86, s56
    s_add_u32 s86, s86, 0xcf0000
    s_lshr_b32 s87, s42, 1
    s_mul_i32 s87, s87, 0x58
    s_and_b32 s56, s42, 1
    s_mul_i32 s56, s56, 3
    s_add_u32 s87, s87, s56
    s_lshl1_add_u32 s87, s0, s87
    s_lshl_b32 s87, s87, 10
    s_add_u32 s87, s87, 0xf70000
    s_lshl_b32 s94, s42, 12
    s_mul_i32 s95, s42, 0xc00
    v_add_u32 v3, 61440, v2
    v_add_u32 v14, 126976, v2
    v_lshrrev_b32 v137, 4, v1
    v_mul_u32_u24 v47, 80, v137
    v_add_u32 v47, 59520, v47
    v_and_b32 v137, 1, v137
    v_lshl_add_u32 v46, v137, 4, v47
    v_xor_b32 v137, 1, v137
    v_lshl_add_u32 v47, v137, 6, v47
    s_mul_i32 s56, s42, 28
    v_min_u32 v198, 27, v1
    v_add_u32 v198, s56, v198
    s_lshl_b32 s56, s44, 2
    v_lshrrev_b32 v112, 4, v198
    v_add_u32 v112, s56, v112
    s_add_u32 s56, s0, 60
    v_lshrrev_b32 v113, 4, v198
    v_add_u32 v113, s56, v113
    v_cmp_gt_u32 vcc, 64, v198
    s_nop 1
    v_cndmask_b32 v199, v113, v112, vcc
    v_lshlrev_b32 v199, 6, v199
    v_bfe_u32 v112, v198, 2, 1
    v_mul_u32_u24 v112, 0x3600, v112
    v_add_u32 v199, v199, v112
    v_bfe_u32 v112, v198, 3, 1
    v_mul_u32_u24 v112, 0x1b00, v112
    v_add_u32 v199, v199, v112
    v_and_b32 v112, 3, v198
    v_lshl_add_u32 v199, v112, 4, v199
    v_lshlrev_b32 v112, 4, v198
    v_add_u32 v198, 0xd800, v112
    s_mov_b32 s68, 983040
    s_mov_b32 s69, 1010688
    s_mov_b32 s70, 1038336
    s_mov_b32 s71, 1065984
    v_lshlrev_b32 v48, 16, v4
    v_and_b32 v49, 0xffff0000, v4
    v_lshlrev_b32 v50, 16, v5
    v_and_b32 v51, 0xffff0000, v5
    v_lshlrev_b32 v52, 16, v6
    v_and_b32 v53, 0xffff0000, v6
    v_lshlrev_b32 v54, 16, v7
    v_and_b32 v55, 0xffff0000, v7
    v_lshlrev_b32 v56, 16, v8
    v_and_b32 v57, 0xffff0000, v8
    v_lshlrev_b32 v58, 16, v9
    v_and_b32 v59, 0xffff0000, v9
    v_lshlrev_b32 v60, 16, v10
    v_and_b32 v61, 0xffff0000, v10
    v_lshlrev_b32 v62, 16, v11
    v_and_b32 v63, 0xffff0000, v11
    v_lshlrev_b32 v64, 16, v12
    v_and_b32 v65, 0xffff0000, v12
    v_lshlrev_b32 v66, 16, v13
    v_and_b32 v67, 0xffff0000, v13
    v_and_b32 v172, 15, v1
    v_lshlrev_b32 v172, 4, v172
    v_lshrrev_b32 v173, 5, v1
    v_mul_u32_u24 v173, 0x500, v173
    v_add_u32 v173, v172, v173
    v_bfe_u32 v175, v1, 4, 1
    v_mul_u32_u24 v175, 0x300, v175
    v_add_u32 v173, v173, v175
    v_lshrrev_b32 v174, 5, v1
    v_mul_u32_u24 v174, 0x500, v174
    v_add_u32 v174, v172, v174
    v_bfe_u32 v175, v1, 4, 1
    v_lshl_add_u32 v174, v175, 3, v174
    v_and_b32 v172, 15, v1
    v_lshlrev_b32 v172, 3, v172
    s_lshl2_add_u32 s50, s45, s42
    s_mul_i32 s50, s50, 0x5000
    s_mul_i32 s56, s46, 0xa00
    s_add_u32 s50, s50, s56
    s_add_u32 s50, s50, 0x9a0000
    s_lshl2_add_u32 s53, s45, s42
    s_lshl_b32 s53, s53, 10
    s_lshl_b32 s56, s46, 7
    s_add_u32 s53, s53, s56
    s_add_u32 s53, s53, 0xd0000
    s_lshl2_add_u32 s56, s45, s42
    s_lshl3_add_u32 s88, s56, s46
    s_lshl_b32 s88, s88, 7
    s_add_u32 s88, s88, 0x70000
    s_waitcnt lgkmcnt(0)
    s_barrier
    ds_read_b128 v[152:155], v141
    ds_read_b128 v[156:159], v141 offset:64
    ds_read_b128 v[160:163], v141 offset:128
    ds_read_b128 v[164:167], v141 offset:192
    ds_read_b128 v[168:171], v141 offset:256
    ds_read_b128 v[112:115], v46
    ds_read_b128 v[116:119], v46 offset:16
    ds_read_b128 v[120:123], v46 offset:32
    ds_read_b128 v[124:127], v46 offset:48
    ds_read_b128 v[128:131], v47
    s_waitcnt lgkmcnt(9)
    v_mfma_f32_16x16x32_bf16 v[36:39], v[176:179], v[152:155], 0
    s_waitcnt lgkmcnt(8)
    v_mfma_f32_16x16x32_bf16 v[36:39], v[180:183], v[156:159], v[36:39]
    s_waitcnt lgkmcnt(7)
    v_mfma_f32_16x16x32_bf16 v[36:39], v[184:187], v[160:163], v[36:39]
    s_waitcnt lgkmcnt(6)
    v_mfma_f32_16x16x32_bf16 v[36:39], v[188:191], v[164:167], v[36:39]
    s_waitcnt lgkmcnt(5)
    v_mfma_f32_16x16x32_bf16 v[36:39], v[192:195], v[168:171], v[36:39]
    s_nop 7
    v_add_u32 v36, 0x80, v36
    v_and_b32 v36, 0xffffff00, v36
    v_or_b32 v36, s76, v36
    v_add_u32 v37, 0x80, v37
    v_and_b32 v37, 0xffffff00, v37
    v_or_b32 v37, s77, v37
    v_add_u32 v38, 0x80, v38
    v_and_b32 v38, 0xffffff00, v38
    v_or_b32 v38, s78, v38
    v_add_u32 v39, 0x80, v39
    v_and_b32 v39, 0xffffff00, v39
    v_or_b32 v39, s79, v39
    s_mov_b32 exec_lo, 0x00030003
    s_mov_b32 exec_hi, 0x00030003
    buffer_store_dwordx4 v[36:39], v142, s[4:7], s28 offen sc1
    s_mov_b64 exec, -1
    ds_read_b128 v[132:135], v46 offset:640
    ds_read_b128 v[136:139], v46 offset:656
    ds_read_b128 v[140:143], v46 offset:672
    ds_read_b128 v[144:147], v46 offset:688
    ds_read_b128 v[148:151], v47 offset:640
    s_waitcnt vmcnt(1)
    v_cmp_ne_u32 vcc, s40, v69
    s_nop 0
    s_cmp_eq_u64 vcc, 0
    s_cbranch_scc1 L_seen_14
    s_mov_b32 s96, 400000
    buffer_load_dword v69, v68, s[4:7], 0 offen sc1
L_spin_13:
    s_sleep 3
    buffer_load_dword v71, v68, s[4:7], 0 offen sc1
    s_waitcnt vmcnt(1)
    v_cmp_ne_u32 vcc, s40, v69
    s_nop 0
    s_cmp_eq_u64 vcc, 0
    s_cbranch_scc1 L_seen_14
    s_sleep 3
    buffer_load_dword v69, v68, s[4:7], 0 offen sc1
    s_waitcnt vmcnt(1)
    v_cmp_ne_u32 vcc, s40, v71
    s_nop 0
    s_cmp_eq_u64 vcc, 0
    s_cbranch_scc1 L_seen_14
    s_sub_u32 s96, s96, 1
    s_cbranch_scc0 L_spin_13
L_seen_14:
    buffer_load_dwordx4 a[0:3], v2, s[4:7], s80 offen sc1
    buffer_load_dwordx4 a[4:7], v2, s[4:7], s80 offen offset:1024 sc1
    buffer_load_dwordx4 a[8:11], v2, s[4:7], s80 offen offset:2048 sc1
    buffer_load_dwordx4 a[12:15], v2, s[4:7], s80 offen offset:3072 sc1
    s_add_u32 s80, s80, 4096
    buffer_load_dwordx4 a[16:19], v2, s[4:7], s80 offen sc1
    buffer_load_dwordx4 a[20:23], v2, s[4:7], s80 offen offset:1024 sc1
    buffer_load_dwordx4 a[24:27], v2, s[4:7], s80 offen offset:2048 sc1
    buffer_load_dwordx4 a[28:31], v2, s[4:7], s80 offen offset:3072 sc1
    s_add_u32 s80, s80, 4096
    buffer_load_dwordx4 a[32:35], v2, s[4:7], s80 offen sc1
    s_barrier
    buffer_load_dword v197, v196, s[4:7], 0 offen sc1
    ds_read_b128 v[80:83], v3
    ds_read_b128 v[84:87], v3 offset:1024
    ds_read_b128 v[88:91], v3 offset:2048
    ds_read_b128 v[92:95], v3 offset:3072
    ds_read_b128 v[96:99], v3 offset:4096
    ds_read_b128 v[100:103], v3 offset:5120
    s_waitcnt vmcnt(9) lgkmcnt(4)
    v_mfma_f32_16x16x32_bf16 v[16:19], v[80:83], a[0:3], 0
    ds_read_b128 v[104:107], v3 offset:6144
    v_mfma_f32_16x16x32_bf16 v[20:23], v[84:87], a[0:3], 0
    ds_read_b128 v[108:111], v3 offset:7168
    s_waitcnt lgkmcnt(4)
    v_mfma_f32_16x16x32_bf16 v[24:27], v[88:91], a[0:3], 0
    ds_read_b128 v[80:83], v3 offset:8192
    buffer_load_dwordx4 a[36:39], v2, s[4:7], s80 offen offset:1024 sc1
    v_mfma_f32_16x16x32_bf16 v[28:31], v[92:95], a[0:3], 0
    ds_read_b128 v[84:87], v3 offset:9216
    s_waitcnt lgkmcnt(4)
    v_mfma_f32_16x16x32_bf16 v[32:35], v[96:99], a[0:3], 0
    ds_read_b128 v[88:91], v3 offset:10240
    s_waitcnt vmcnt(9)
    v_mfma_f32_16x16x32_bf16 v[16:19], v[100:103], a[4:7], v[16:19]
    ds_read_b128 v[92:95], v3 offset:11264
    s_waitcnt lgkmcnt(4)
    v_mfma_f32_16x16x32_bf16 v[20:23], v[104:107], a[4:7], v[20:23]
    ds_read_b128 v[96:99], v3 offset:12288
    v_mfma_f32_16x16x32_bf16 v[24:27], v[108:111], a[4:7], v[24:27]
    ds_read_b128 v[100:103], v3 offset:13312
    buffer_load_dwordx4 a[40:43], v2, s[4:7], s80 offen offset:2048 sc1
    s_waitcnt lgkmcnt(4)
    v_mfma_f32_16x16x32_bf16 v[28:31], v[80:83], a[4:7], v[28:31]
    ds_read_b128 v[104:107], v3 offset:14336
    v_mfma_f32_16x16x32_bf16 v[32:35], v[84:87], a[4:7], v[32:35]
    ds_read_b128 v[108:111], v3 offset:15360
    s_waitcnt vmcnt(9) lgkmcnt(4)
    v_mfma_f32_16x16x32_bf16 v[16:19], v[88:91], a[8:11], v[16:19]
    ds_read_b128 v[80:83], v3 offset:16384
    v_mfma_f32_16x16x32_bf16 v[20:23], v[92:95], a[8:11], v[20:23]
    ds_read_b128 v[84:87], v3 offset:17408
    s_waitcnt lgkmcnt(4)
    v_mfma_f32_16x16x32_bf16 v[24:27], v[96:99], a[8:11], v[24:27]
    ds_read_b128 v[88:91], v3 offset:18432
    buffer_load_dwordx4 a[44:47], v2, s[4:7], s80 offen offset:3072 sc1
    v_mfma_f32_16x16x32_bf16 v[28:31], v[100:103], a[8:11], v[28:31]
    ds_read_b128 v[92:95], v3 offset:19456
    s_waitcnt lgkmcnt(4)
    v_mfma_f32_16x16x32_bf16 v[32:35], v[104:107], a[8:11], v[32:35]
    ds_read_b128 v[96:99], v3 offset:20480
    s_waitcnt vmcnt(9)
    v_mfma_f32_16x16x32_bf16 v[16:19], v[108:111], a[12:15], v[16:19]
    ds_read_b128 v[100:103], v3 offset:21504
    s_waitcnt lgkmcnt(4)
    v_mfma_f32_16x16x32_bf16 v[20:23], v[80:83], a[12:15], v[20:23]
    ds_read_b128 v[104:107], v3 offset:22528
    v_mfma_f32_16x16x32_bf16 v[24:27], v[84:87], a[12:15], v[24:27]
    ds_read_b128 v[108:111], v3 offset:23552
    s_add_u32 s80, s80, 4096
    buffer_load_dwordx4 a[48:51], v2, s[4:7], s80 offen sc1
    s_waitcnt lgkmcnt(4)
    v_mfma_f32_16x16x32_bf16 v[28:31], v[88:91], a[12:15], v[28:31]
    ds_read_b128 v[80:83], v3 offset:24576
    v_mfma_f32_16x16x32_bf16 v[32:35], v[92:95], a[12:15], v[32:35]
    ds_read_b128 v[84:87], v3 offset:25600
    s_waitcnt vmcnt(9) lgkmcnt(4)
    v_mfma_f32_16x16x32_bf16 v[16:19], v[96:99], a[16:19], v[16:19]
    ds_read_b128 v[88:91], v3 offset:26624
    v_mfma_f32_16x16x32_bf16 v[20:23], v[100:103], a[16:19], v[20:23]
    ds_read_b128 v[92:95], v3 offset:27648
    s_waitcnt lgkmcnt(4)
    v_mfma_f32_16x16x32_bf16 v[24:27], v[104:107], a[16:19], v[24:27]
    ds_read_b128 v[96:99], v3 offset:28672
    buffer_load_dwordx4 a[52:55], v2, s[4:7], s80 offen offset:1024 sc1
    v_mfma_f32_16x16x32_bf16 v[28:31], v[108:111], a[16:19], v[28:31]
    ds_read_b128 v[100:103], v3 offset:29696
    s_waitcnt lgkmcnt(4)
    v_mfma_f32_16x16x32_bf16 v[32:35], v[80:83], a[16:19], v[32:35]
    ds_read_b128 v[104:107], v3 offset:30720
    s_waitcnt vmcnt(9)
    v_mfma_f32_16x16x32_bf16 v[16:19], v[84:87], a[20:23], v[16:19]
    ds_read_b128 v[108:111], v3 offset:31744
    s_waitcnt lgkmcnt(4)
    v_mfma_f32_16x16x32_bf16 v[20:23], v[88:91], a[20:23], v[20:23]
    ds_read_b128 v[80:83], v3 offset:32768
    v_mfma_f32_16x16x32_bf16 v[24:27], v[92:95], a[20:23], v[24:27]
    ds_read_b128 v[84:87], v3 offset:33792
    buffer_load_dwordx4 a[56:59], v2, s[4:7], s80 offen offset:2048 sc1
    s_waitcnt lgkmcnt(4)
    v_mfma_f32_16x16x32_bf16 v[28:31], v[96:99], a[20:23], v[28:31]
    ds_read_b128 v[88:91], v3 offset:34816
    v_mfma_f32_16x16x32_bf16 v[32:35], v[100:103], a[20:23], v[32:35]
    ds_read_b128 v[92:95], v3 offset:35840
    s_waitcnt vmcnt(9) lgkmcnt(4)
    v_mfma_f32_16x16x32_bf16 v[16:19], v[104:107], a[24:27], v[16:19]
    ds_read_b128 v[96:99], v3 offset:36864
    v_mfma_f32_16x16x32_bf16 v[20:23], v[108:111], a[24:27], v[20:23]
    ds_read_b128 v[100:103], v3 offset:37888
    s_waitcnt lgkmcnt(4)
    v_mfma_f32_16x16x32_bf16 v[24:27], v[80:83], a[24:27], v[24:27]
    ds_read_b128 v[104:107], v3 offset:38912
    buffer_load_dwordx4 a[60:63], v2, s[4:7], s80 offen offset:3072 sc1
    v_mfma_f32_16x16x32_bf16 v[28:31], v[84:87], a[24:27], v[28:31]
    ds_read_b128 v[108:111], v3 offset:39936
    s_waitcnt lgkmcnt(4)
    v_mfma_f32_16x16x32_bf16 v[32:35], v[88:91], a[24:27], v[32:35]
    ds_read_b128 v[80:83], v3 offset:40960
    s_waitcnt vmcnt(9)
    v_mfma_f32_16x16x32_bf16 v[16:19], v[92:95], a[28:31], v[16:19]
    ds_read_b128 v[84:87], v3 offset:41984
    s_waitcnt lgkmcnt(4)
    v_mfma_f32_16x16x32_bf16 v[20:23], v[96:99], a[28:31], v[20:23]
    ds_read_b128 v[88:91], v3 offset:43008
    v_mfma_f32_16x16x32_bf16 v[24:27], v[100:103], a[28:31], v[24:27]
    ds_read_b128 v[92:95], v3 offset:44032
    s_add_u32 s80, s80, 4096
    buffer_load_dwordx4 a[64:67], v2, s[4:7], s80 offen sc1
    s_waitcnt lgkmcnt(4)
    v_mfma_f32_16x16x32_bf16 v[28:31], v[104:107], a[28:31], v[28:31]
    ds_read_b128 v[96:99], v3 offset:45056
    v_mfma_f32_16x16x32_bf16 v[32:35], v[108:111], a[28:31], v[32:35]
    ds_read_b128 v[100:103], v3 offset:46080
    s_waitcnt vmcnt(9) lgkmcnt(4)
    v_mfma_f32_16x16x32_bf16 v[16:19], v[80:83], a[32:35], v[16:19]
    ds_read_b128 v[104:107], v3 offset:47104
    v_mfma_f32_16x16x32_bf16 v[20:23], v[84:87], a[32:35], v[20:23]
    ds_read_b128 v[108:111], v3 offset:48128
    s_waitcnt lgkmcnt(4)
    v_mfma_f32_16x16x32_bf16 v[24:27], v[88:91], a[32:35], v[24:27]
    ds_read_b128 v[80:83], v3 offset:49152
    buffer_load_dwordx4 a[68:71], v2, s[4:7], s80 offen offset:1024 sc1
    v_mfma_f32_16x16x32_bf16 v[28:31], v[92:95], a[32:35], v[28:31]
    ds_read_b128 v[84:87], v3 offset:50176
    s_waitcnt lgkmcnt(4)
    v_mfma_f32_16x16x32_bf16 v[32:35], v[96:99], a[32:35], v[32:35]
    ds_read_b128 v[88:91], v3 offset:51200
    s_waitcnt vmcnt(8)
    v_mfma_f32_16x16x32_bf16 v[16:19], v[100:103], a[36:39], v[16:19]
    ds_read_b128 v[92:95], v3 offset:52224
    s_waitcnt lgkmcnt(4)
    v_mfma_f32_16x16x32_bf16 v[20:23], v[104:107], a[36:39], v[20:23]
    ds_read_b128 v[96:99], v3 offset:53248
    v_mfma_f32_16x16x32_bf16 v[24:27], v[108:111], a[36:39], v[24:27]
    ds_read_b128 v[100:103], v3 offset:54272
    buffer_load_dwordx4 a[72:75], v2, s[4:7], s80 offen offset:2048 sc1
    s_waitcnt lgkmcnt(4)
    v_mfma_f32_16x16x32_bf16 v[28:31], v[80:83], a[36:39], v[28:31]
    ds_read_b128 v[104:107], v3 offset:55296
    v_mfma_f32_16x16x32_bf16 v[32:35], v[84:87], a[36:39], v[32:35]
    ds_read_b128 v[108:111], v3 offset:56320
    s_waitcnt vmcnt(8) lgkmcnt(4)
    v_mfma_f32_16x16x32_bf16 v[16:19], v[88:91], a[40:43], v[16:19]
    ds_read_b128 v[80:83], v3 offset:57344
    v_mfma_f32_16x16x32_bf16 v[20:23], v[92:95], a[40:43], v[20:23]
    ds_read_b128 v[84:87], v3 offset:58368
    s_waitcnt lgkmcnt(4)
    v_mfma_f32_16x16x32_bf16 v[24:27], v[96:99], a[40:43], v[24:27]
    ds_read_b128 v[88:91], v3 offset:59392
    buffer_load_dwordx4 a[76:79], v2, s[4:7], s80 offen offset:3072 sc1
    v_mfma_f32_16x16x32_bf16 v[28:31], v[100:103], a[40:43], v[28:31]
    ds_read_b128 v[92:95], v3 offset:60416
    s_waitcnt lgkmcnt(4)
    v_mfma_f32_16x16x32_bf16 v[32:35], v[104:107], a[40:43], v[32:35]
    ds_read_b128 v[96:99], v3 offset:61440
    s_waitcnt vmcnt(8)
    v_mfma_f32_16x16x32_bf16 v[16:19], v[108:111], a[44:47], v[16:19]
    ds_read_b128 v[100:103], v3 offset:62464
    s_waitcnt lgkmcnt(4)
    v_mfma_f32_16x16x32_bf16 v[20:23], v[80:83], a[44:47], v[20:23]
    ds_read_b128 v[104:107], v3 offset:63488
    v_mfma_f32_16x16x32_bf16 v[24:27], v[84:87], a[44:47], v[24:27]
    ds_read_b128 v[108:111], v3 offset:64512
    s_waitcnt lgkmcnt(4)
    v_mfma_f32_16x16x32_bf16 v[28:31], v[88:91], a[44:47], v[28:31]
    ds_read_b128 v[80:83], v14
    s_mov_b32 s96, 400000
L_spin_15:
    v_cmp_ne_u32 vcc, s40, v197
    s_nop 0
    s_cmp_eq_u64 vcc, 0
    s_cbranch_scc1 L_seen_16
    s_sleep 1
    buffer_load_dword v197, v196, s[4:7], 0 offen sc1
    s_waitcnt vmcnt(0)
    s_sub_u32 s96, s96, 1
    s_cbranch_scc0 L_spin_15
L_seen_16:
    v_mfma_f32_16x16x32_bf16 v[32:35], v[92:95], a[44:47], v[32:35]
    ds_read_b128 v[84:87], v14 offset:1024
    s_waitcnt vmcnt(7) lgkmcnt(4)
    v_mfma_f32_16x16x32_bf16 v[16:19], v[96:99], a[48:51], v[16:19]
    ds_read_b128 v[88:91], v14 offset:2048
    s_add_u32 s83, s86, 0
    s_add_u32 m0, s94, 0
    s_nop 0
    buffer_load_dwordx4 v2, s[4:7], s83 offen sc1 lds
    v_mfma_f32_16x16x32_bf16 v[20:23], v[100:103], a[48:51], v[20:23]
    ds_read_b128 v[92:95], v14 offset:3072
    s_waitcnt lgkmcnt(4)
    v_mfma_f32_16x16x32_bf16 v[24:27], v[104:107], a[48:51], v[24:27]
    ds_read_b128 v[96:99], v14 offset:4096
    v_mfma_f32_16x16x32_bf16 v[28:31], v[108:111], a[48:51], v[28:31]
    ds_read_b128 v[100:103], v14 offset:5120
    buffer_load_dwordx4 v2, s[4:7], s83 offen offset:1024 sc1 lds
    s_waitcnt lgkmcnt(4)
    v_mfma_f32_16x16x32_bf16 v[32:35], v[80:83], a[48:51], v[32:35]
    ds_read_b128 v[104:107], v14 offset:6144
    s_waitcnt vmcnt(8)
    v_mfma_f32_16x16x32_bf16 v[16:19], v[84:87], a[52:55], v[16:19]
    ds_read_b128 v[108:111], v14 offset:7168
    s_waitcnt lgkmcnt(4)
    v_mfma_f32_16x16x32_bf16 v[20:23], v[88:91], a[52:55], v[20:23]
    ds_read_b128 v[80:83], v14 offset:8192
    buffer_load_dwordx4 v2, s[4:7], s83 offen offset:2048 sc1 lds
    v_mfma_f32_16x16x32_bf16 v[24:27], v[92:95], a[52:55], v[24:27]
    ds_read_b128 v[84:87], v14 offset:9216
    s_waitcnt lgkmcnt(4)
    v_mfma_f32_16x16x32_bf16 v[28:31], v[96:99], a[52:55], v[28:31]
    ds_read_b128 v[88:91], v14 offset:10240
    v_mfma_f32_16x16x32_bf16 v[32:35], v[100:103], a[52:55], v[32:35]
    ds_read_b128 v[92:95], v14 offset:11264
    buffer_load_dwordx4 v2, s[4:7], s83 offen offset:3072 sc1 lds
    s_waitcnt vmcnt(9) lgkmcnt(4)
    v_mfma_f32_16x16x32_bf16 v[16:19], v[104:107], a[56:59], v[16:19]
    ds_read_b128 v[96:99], v14 offset:12288
    v_mfma_f32_16x16x32_bf16 v[20:23], v[108:111], a[56:59], v[20:23]
    ds_read_b128 v[100:103], v14 offset:13312
    s_waitcnt lgkmcnt(4)
    v_mfma_f32_16x16x32_bf16 v[24:27], v[80:83], a[56:59], v[24:27]
    ds_read_b128 v[104:107], v14 offset:14336
    s_add_u32 s83, s86, 16384
    s_add_u32 m0, s94, 16384
    s_nop 0
    buffer_load_dwordx4 v2, s[4:7], s83 offen sc1 lds
    v_mfma_f32_16x16x32_bf16 v[28:31], v[84:87], a[56:59], v[28:31]
    ds_read_b128 v[108:111], v14 offset:15360
    s_waitcnt lgkmcnt(4)
    v_mfma_f32_16x16x32_bf16 v[32:35], v[88:91], a[56:59], v[32:35]
    ds_read_b128 v[80:83], v14 offset:16384
    s_waitcnt vmcnt(9)
    v_mfma_f32_16x16x32_bf16 v[16:19], v[92:95], a[60:63], v[16:19]
    ds_read_b128 v[84:87], v14 offset:17408
    buffer_load_dwordx4 v2, s[4:7], s83 offen offset:1024 sc1 lds
    s_waitcnt lgkmcnt(4)
    v_mfma_f32_16x16x32_bf16 v[20:23], v[96:99], a[60:63], v[20:23]
    ds_read_b128 v[88:91], v14 offset:18432
    v_mfma_f32_16x16x32_bf16 v[24:27], v[100:103], a[60:63], v[24:27]
    ds_read_b128 v[92:95], v14 offset:19456
    s_waitcnt lgkmcnt(4)
    v_mfma_f32_16x16x32_bf16 v[28:31], v[104:107], a[60:63], v[28:31]
    ds_read_b128 v[96:99], v14 offset:20480
    buffer_load_dwordx4 v2, s[4:7], s83 offen offset:2048 sc1 lds
    v_mfma_f32_16x16x32_bf16 v[32:35], v[108:111], a[60:63], v[32:35]
    ds_read_b128 v[100:103], v14 offset:21504
    s_waitcnt vmcnt(10) lgkmcnt(4)
    v_mfma_f32_16x16x32_bf16 v[16:19], v[80:83], a[64:67], v[16:19]
    ds_read_b128 v[104:107], v14 offset:22528
    v_mfma_f32_16x16x32_bf16 v[20:23], v[84:87], a[64:67], v[20:23]
    ds_read_b128 v[108:111], v14 offset:23552
    buffer_load_dwordx4 v2, s[4:7], s83 offen offset:3072 sc1 lds
    s_waitcnt lgkmcnt(4)
    v_mfma_f32_16x16x32_bf16 v[24:27], v[88:91], a[64:67], v[24:27]
    ds_read_b128 v[80:83], v14 offset:24576
    v_mfma_f32_16x16x32_bf16 v[28:31], v[92:95], a[64:67], v[28:31]
    ds_read_b128 v[84:87], v14 offset:25600
    s_waitcnt lgkmcnt(4)
    v_mfma_f32_16x16x32_bf16 v[32:35], v[96:99], a[64:67], v[32:35]
    ds_read_b128 v[88:91], v14 offset:26624
    s_add_u32 s83, s86, 32768
    s_add_u32 m0, s94, 32768
    s_nop 0
    buffer_load_dwordx4 v2, s[4:7], s83 offen sc1 lds
    s_waitcnt vmcnt(11)
    v_mfma_f32_16x16x32_bf16 v[16:19], v[100:103], a[68:71], v[16:19]
    ds_read_b128 v[92:95], v14 offset:27648
    s_waitcnt lgkmcnt(4)
    v_mfma_f32_16x16x32_bf16 v[20:23], v[104:107], a[68:71], v[20:23]
    ds_read_b128 v[96:99], v14 offset:28672
    v_mfma_f32_16x16x32_bf16 v[24:27], v[108:111], a[68:71], v[24:27]
    ds_read_b128 v[100:103], v14 offset:29696
    buffer_load_dwordx4 v2, s[4:7], s83 offen offset:1024 sc1 lds
    s_waitcnt lgkmcnt(4)
    v_mfma_f32_16x16x32_bf16 v[28:31], v[80:83], a[68:71], v[28:31]
    ds_read_b128 v[104:107], v14 offset:30720
    v_mfma_f32_16x16x32_bf16 v[32:35], v[84:87], a[68:71], v[32:35]
    ds_read_b128 v[108:111], v14 offset:31744
    s_waitcnt vmcnt(11) lgkmcnt(4)
    v_mfma_f32_16x16x32_bf16 v[16:19], v[88:91], a[72:75], v[16:19]
    ds_read_b128 v[80:83], v14 offset:32768
    buffer_load_dwordx4 v2, s[4:7], s83 offen offset:2048 sc1 lds
    v_mfma_f32_16x16x32_bf16 v[20:23], v[92:95], a[72:75], v[20:23]
    ds_read_b128 v[84:87], v14 offset:33792
    s_waitcnt lgkmcnt(4)
    v_mfma_f32_16x16x32_bf16 v[24:27], v[96:99], a[72:75], v[24:27]
    ds_read_b128 v[88:91], v14 offset:34816
    v_mfma_f32_16x16x32_bf16 v[28:31], v[100:103], a[72:75], v[28:31]
    ds_read_b128 v[92:95], v14 offset:35840
    buffer_load_dwordx4 v2, s[4:7], s83 offen offset:3072 sc1 lds
    s_waitcnt lgkmcnt(4)
    v_mfma_f32_16x16x32_bf16 v[32:35], v[104:107], a[72:75], v[32:35]
    s_waitcnt vmcnt(12)
    v_mfma_f32_16x16x32_bf16 v[16:19], v[108:111], a[76:79], v[16:19]
    s_waitcnt lgkmcnt(2)
    v_mfma_f32_16x16x32_bf16 v[20:23], v[80:83], a[76:79], v[20:23]
    v_mfma_f32_16x16x32_bf16 v[24:27], v[84:87], a[76:79], v[24:27]
    s_waitcnt lgkmcnt(0)
    v_mfma_f32_16x16x32_bf16 v[28:31], v[88:91], a[76:79], v[28:31]
    buffer_load_dwordx4 v[152:155], v199, s[4:7], s68 offen sc1
    buffer_load_dwordx4 v[156:159], v199, s[4:7], s69 offen sc1
    buffer_load_dwordx4 v[160:163], v199, s[4:7], s70 offen sc1
    buffer_load_dwordx4 v[164:167], v199, s[4:7], s71 offen sc1
    v_mfma_f32_16x16x32_bf16 v[32:35], v[92:95], a[76:79], v[32:35]
    v_pk_fma_f32 v[48:49], v[16:17], v[112:113], v[48:49]
    v_pk_fma_f32 v[50:51], v[18:19], v[114:115], v[50:51]
    v_pk_fma_f32 v[52:53], v[20:21], v[116:117], v[52:53]
    v_pk_fma_f32 v[54:55], v[22:23], v[118:119], v[54:55]
    v_pk_fma_f32 v[56:57], v[24:25], v[120:121], v[56:57]
    v_pk_fma_f32 v[58:59], v[26:27], v[122:123], v[58:59]
    v_pk_fma_f32 v[60:61], v[28:29], v[124:125], v[60:61]
    v_pk_fma_f32 v[62:63], v[30:31], v[126:127], v[62:63]
    v_pk_fma_f32 v[64:65], v[32:33], v[128:129], v[64:65]
    v_pk_fma_f32 v[66:67], v[34:35], v[130:131], v[66:67]
    v_cvt_pk_bf16_f32 v4, v48, v49
    v_cvt_pk_bf16_f32 v5, v50, v51
    v_cvt_pk_bf16_f32 v6, v52, v53
    v_cvt_pk_bf16_f32 v7, v54, v55
    v_cvt_pk_bf16_f32 v8, v56, v57
    v_cvt_pk_bf16_f32 v9, v58, v59
    v_cvt_pk_bf16_f32 v10, v60, v61
    v_cvt_pk_bf16_f32 v11, v62, v63
    v_cvt_pk_bf16_f32 v12, v64, v65
    v_cvt_pk_bf16_f32 v13, v66, v67
    v_lshlrev_b32 v48, 16, v4
    v_and_b32 v49, 0xffff0000, v4
    v_lshlrev_b32 v50, 16, v5
    v_and_b32 v51, 0xffff0000, v5
    v_lshlrev_b32 v52, 16, v6
    v_and_b32 v53, 0xffff0000, v6
    v_lshlrev_b32 v54, 16, v7
    v_and_b32 v55, 0xffff0000, v7
    v_lshlrev_b32 v56, 16, v8
    v_and_b32 v57, 0xffff0000, v8
    v_lshlrev_b32 v58, 16, v9
    v_and_b32 v59, 0xffff0000, v9
    v_lshlrev_b32 v60, 16, v10
    v_and_b32 v61, 0xffff0000, v10
    v_lshlrev_b32 v62, 16, v11
    v_and_b32 v63, 0xffff0000, v11
    v_lshlrev_b32 v64, 16, v12
    v_and_b32 v65, 0xffff0000, v12
    v_lshlrev_b32 v66, 16, v13
    v_and_b32 v67, 0xffff0000, v13
    v_pk_mul_f32 v[132:133], v[48:49], v[132:133]
    v_pk_mul_f32 v[134:135], v[50:51], v[134:135]
    v_pk_mul_f32 v[136:137], v[52:53], v[136:137]
    v_pk_mul_f32 v[138:139], v[54:55], v[138:139]
    v_pk_mul_f32 v[140:141], v[56:57], v[140:141]
    v_pk_mul_f32 v[142:143], v[58:59], v[142:143]
    v_pk_mul_f32 v[144:145], v[60:61], v[144:145]
    v_pk_mul_f32 v[146:147], v[62:63], v[146:147]
    v_pk_mul_f32 v[148:149], v[64:65], v[148:149]
    v_pk_mul_f32 v[150:151], v[66:67], v[150:151]
    v_cvt_pk_bf16_f32 v36, v132, v133
    v_cvt_pk_bf16_f32 v37, v134, v135
    v_cvt_pk_bf16_f32 v38, v136, v137
    v_cvt_pk_bf16_f32 v39, v138, v139
    v_cvt_pk_bf16_f32 v40, v140, v141
    v_cvt_pk_bf16_f32 v41, v142, v143
    v_cvt_pk_bf16_f32 v42, v144, v145
    v_cvt_pk_bf16_f32 v43, v146, v147
    v_cvt_pk_bf16_f32 v44, v148, v149
    v_cvt_pk_bf16_f32 v45, v150, v151
    buffer_store_dwordx4 v[36:39], v173, s[4:7], s50 offen sc1
    buffer_store_dwordx4 v[40:43], v173, s[4:7], s50 offen offset:256 sc1
    buffer_store_dwordx2 v[44:45], v174, s[4:7], s50 offen offset:512 sc1
    v_pk_add_f32 v[68:69], v[48:49], v[50:51]
    v_pk_add_f32 v[68:69], v[68:69], v[52:53]
    v_pk_add_f32 v[68:69], v[68:69], v[54:55]
    v_pk_add_f32 v[68:69], v[68:69], v[56:57]
    v_pk_add_f32 v[68:69], v[68:69], v[58:59]
    v_pk_add_f32 v[68:69], v[68:69], v[60:61]
    v_pk_add_f32 v[68:69], v[68:69], v[62:63]
    v_pk_add_f32 v[68:69], v[68:69], v[64:65]
    v_pk_add_f32 v[68:69], v[68:69], v[66:67]
    v_add_f32 v68, v68, v69
    v_mov_b32 v70, v68
    s_nop 1
    v_permlane16_swap_b32 v68, v70
    v_add_f32 v68, v68, v70
    v_mov_b32 v70, v68
    s_nop 1
    v_permlane32_swap_b32 v68, v70
    v_add_f32 v68, v68, v70
    v_mul_f32 v72, 0x3c4ccccd, v68
    v_pk_add_f32 v[16:17], v[48:49], v[72:73] op_sel_hi:[1,0] neg_lo:[0,1] neg_hi:[0,1]
    v_pk_add_f32 v[18:19], v[50:51], v[72:73] op_sel_hi:[1,0] neg_lo:[0,1] neg_hi:[0,1]
    v_pk_add_f32 v[20:21], v[52:53], v[72:73] op_sel_hi:[1,0] neg_lo:[0,1] neg_hi:[0,1]
    v_pk_add_f32 v[22:23], v[54:55], v[72:73] op_sel_hi:[1,0] neg_lo:[0,1] neg_hi:[0,1]
    v_pk_add_f32 v[24:25], v[56:57], v[72:73] op_sel_hi:[1,0] neg_lo:[0,1] neg_hi:[0,1]
    v_pk_add_f32 v[26:27], v[58:59], v[72:73] op_sel_hi:[1,0] neg_lo:[0,1] neg_hi:[0,1]
    v_pk_add_f32 v[28:29], v[60:61], v[72:73] op_sel_hi:[1,0] neg_lo:[0,1] neg_hi:[0,1]
    v_pk_add_f32 v[30:31], v[62:63], v[72:73] op_sel_hi:[1,0] neg_lo:[0,1] neg_hi:[0,1]
    v_pk_add_f32 v[32:33], v[64:65], v[72:73] op_sel_hi:[1,0] neg_lo:[0,1] neg_hi:[0,1]
    v_pk_add_f32 v[34:35], v[66:67], v[72:73] op_sel_hi:[1,0] neg_lo:[0,1] neg_hi:[0,1]
    v_pk_mul_f32 v[68:69], v[16:17], v[16:17]
    v_pk_fma_f32 v[68:69], v[18:19], v[18:19], v[68:69]
    v_pk_fma_f32 v[68:69], v[20:21], v[20:21], v[68:69]
    v_pk_fma_f32 v[68:69], v[22:23], v[22:23], v[68:69]
    v_pk_fma_f32 v[68:69], v[24:25], v[24:25], v[68:69]
    v_pk_fma_f32 v[68:69], v[26:27], v[26:27], v[68:69]
    v_pk_fma_f32 v[68:69], v[28:29], v[28:29], v[68:69]
    v_pk_fma_f32 v[68:69], v[30:31], v[30:31], v[68:69]
    v_pk_fma_f32 v[68:69], v[32:33], v[32:33], v[68:69]
    v_pk_fma_f32 v[68:69], v[34:35], v[34:35], v[68:69]
    v_add_f32 v73, v68, v69
    v_mov_b32 v70, v73
    s_nop 1
    v_permlane16_swap_b32 v73, v70
    v_add_f32 v73, v73, v70
    v_mov_b32 v70, v73
    s_nop 1
    v_permlane32_swap_b32 v73, v70
    v_add_f32 v73, v73, v70
    s_mov_b64 exec, 0xffff
    buffer_store_dwordx2 v[72:73], v172, s[4:7], s53 offen sc1
    s_mov_b64 exec, -1
    s_mov_b32 s96, 400000
    s_waitcnt vmcnt(4)
L_spin_17:
    v_xor_b32 v152, s76, v152
    v_xor_b32 v153, s77, v153
    v_or_b32 v70, v152, v153
    v_xor_b32 v154, s78, v154
    v_xor_b32 v155, s79, v155
    v_or3_b32 v70, v154, v155, v70
    v_xor_b32 v156, s76, v156
    v_xor_b32 v157, s77, v157
    v_or3_b32 v70, v156, v157, v70
    v_xor_b32 v158, s78, v158
    v_xor_b32 v159, s79, v159
    v_or3_b32 v70, v158, v159, v70
    v_xor_b32 v160, s76, v160
    v_xor_b32 v161, s77, v161
    v_or3_b32 v70, v160, v161, v70
    v_xor_b32 v162, s78, v162
    v_xor_b32 v163, s79, v163
    v_or3_b32 v70, v162, v163, v70
    v_xor_b32 v164, s76, v164
    v_xor_b32 v165, s77, v165
    v_or3_b32 v70, v164, v165, v70
    v_xor_b32 v166, s78, v166
    v_xor_b32 v167, s79, v167
    v_or3_b32 v70, v166, v167, v70
    v_and_b32 v70, 0xff, v70
    v_cmp_ne_u32 vcc, 0, v70
    s_nop 0
    s_cmp_eq_u64 vcc, 0
    s_cbranch_scc1 L_seen_18
    s_sleep 1
    buffer_load_dwordx4 v[152:155], v199, s[4:7], s68 offen sc1
    buffer_load_dwordx4 v[156:159], v199, s[4:7], s69 offen sc1
    buffer_load_dwordx4 v[160:163], v199, s[4:7], s70 offen sc1
    buffer_load_dwordx4 v[164:167], v199, s[4:7], s71 offen sc1
    s_waitcnt vmcnt(0)
    s_sub_u32 s96, s96, 1
    s_cbranch_scc0 L_spin_17
L_seen_18:
    v_pk_add_f32 v[152:153], v[152:153], v[156:157]
    v_pk_add_f32 v[160:161], v[160:161], v[164:165]
    v_pk_add_f32 v[154:155], v[154:155], v[158:159]
    v_pk_add_f32 v[162:163], v[162:163], v[166:167]
    v_pk_add_f32 v[152:153], v[152:153], v[160:161]
    v_pk_add_f32 v[154:155], v[154:155], v[162:163]
    ds_write_b128 v198, v[152:155]
    s_lshl2_add_u32 s80, s43, s42
    s_mul_i32 s80, s80, 0xa000
    s_add_u32 s80, s80, 0x9a0000
    s_add_u32 s81, s80, 0x5000
    s_lshl2_add_u32 s56, s43, s42
    s_lshl_b32 s56, s56, 11
    s_add_u32 s56, s56, 0x70000
    v_and_b32 v178, 15, v1
    v_lshl_add_u32 v178, v178, 7, s56
    v_add_u32 v3, 61440, v2
    v_add_u32 v14, 126976, v2
    s_waitcnt vmcnt(0)
    v_mov_b32 v16, s40
    s_mov_b64 exec, 1
    buffer_store_dword v16, off, s[4:7], s88 sc1
    s_mov_b64 exec, -1
    s_barrier
    s_add_u32 s83, s86, 49152
    s_add_u32 m0, s94, 61440
    s_nop 0
    buffer_load_dwordx4 v2, s[4:7], s83 offen sc1 lds
    buffer_load_dwordx4 v2, s[4:7], s83 offen offset:1024 sc1 lds
    buffer_load_dwordx4 v2, s[4:7], s83 offen offset:2048 sc1 lds
    buffer_load_dwordx4 v2, s[4:7], s83 offen offset:3072 sc1 lds
    s_add_u32 s83, s86, 65536
    s_add_u32 m0, s94, 77824
    s_nop 0
    buffer_load_dwordx4 v2, s[4:7], s83 offen sc1 lds
    buffer_load_dwordx4 v2, s[4:7], s83 offen offset:1024 sc1 lds
    buffer_load_dwordx4 v2, s[4:7], s83 offen offset:2048 sc1 lds
    buffer_load_dwordx4 v2, s[4:7], s83 offen offset:3072 sc1 lds
    s_add_u32 s83, s86, 81920
    s_add_u32 m0, s94, 94208
    s_nop 0
    buffer_load_dwordx4 v2, s[4:7], s83 offen sc1 lds
    buffer_load_dwordx4 v2, s[4:7], s83 offen offset:1024 sc1 lds
    buffer_load_dwordx4 v2, s[4:7], s83 offen offset:2048 sc1 lds
    buffer_load_dwordx4 v2, s[4:7], s83 offen offset:3072 sc1 lds
    buffer_load_dword v179, v178, s[4:7], 0 offen sc1
    v_lshrrev_b32 v40, 4, v1
    v_lshlrev_b32 v40, 7, v40
    v_and_b32 v41, 15, v1
    v_lshl_add_u32 v40, v41, 3, v40
    s_lshl2_add_u32 s54, s43, s42
    s_lshl_b32 s54, s54, 11
    s_add_u32 s54, s54, 0xd0000
    v_bfe_u32 v176, v1, 4, 1
    v_mul_u32_u24 v176, 0xd800, v176
    v_and_b32 v177, 15, v1
    v_lshl_add_u32 v176, v177, 4, v176
    v_lshrrev_b32 v177, 5, v1
    v_lshl_add_u32 v176, v177, 8, v176
    s_lshl2_add_u32 s90, s43, s42
    s_mul_i32 s90, s90, 0x1b000
    s_lshl_b32 s56, s44, 11
    s_add_u32 s90, s90, s56
    s_add_u32 s90, s90, 0x1350000
    s_lshl2_add_u32 s91, s43, s42
    s_mul_i32 s91, s91, 0x1b000
    s_lshl_b32 s56, s0, 9
    s_add_u32 s91, s91, s56
    s_add_u32 s91, s91, 0x1358000
    s_lshr_b32 s50, s42, 1
    s_lshl1_add_u32 s50, s43, s50
    s_lshl_b32 s50, s50, 5
    s_and_b32 s56, s42, 1
    s_add_u32 s50, s50, s56
    s_lshl1_add_u32 s50, s44, s50
    s_lshl_b32 s50, s50, 7
    s_add_u32 s88, s50, 0x90000
    s_add_u32 s89, s50, 0xb0000
    s_lshl_b32 s56, s45, 12
    s_lshl_b32 s57, s42, 10
    s_add_u32 s56, s56, s57
    s_add_u32 s56, s56, 0x90000
    v_and_b32 v180, 7, v1
    v_lshl_add_u32 v180, v180, 7, s56
    s_lshl_b32 s56, s45, 12
    s_add_u32 s56, s56, 0xb0000
    v_and_b32 v182, 31, v1
    v_lshl_add_u32 v182, v182, 7, s56
    s_and_b32 s50, s42, 3
    s_lshl2_add_u32 s50, s45, s50
    s_mul_i32 s50, s50, 0xd800
    s_add_u32 s50, s50, 0x1350000
    s_lshl_b32 s68, s42, 13
    s_add_u32 s68, s68, s50
    s_lshl_b32 s72, s1, 10
    s_add_u32 s72, s72, s50
    s_add_u32 s50, s42, 1
    s_and_b32 s50, s50, 3
    s_lshl2_add_u32 s50, s45, s50
    s_mul_i32 s50, s50, 0xd800
    s_add_u32 s50, s50, 0x1350000
    s_lshl_b32 s69, s42, 13
    s_add_u32 s69, s69, s50
    s_lshl_b32 s73, s1, 10
    s_add_u32 s73, s73, s50
    s_add_u32 s50, s42, 2
    s_and_b32 s50, s50, 3
    s_lshl2_add_u32 s50, s45, s50
    s_mul_i32 s50, s50, 0xd800
    s_add_u32 s50, s50, 0x1350000
    s_lshl_b32 s70, s42, 13
    s_add_u32 s70, s70, s50
    s_lshl_b32 s74, s1, 10
    s_add_u32 s74, s74, s50
    s_add_u32 s50, s42, 3
    s_and_b32 s50, s50, 3
    s_lshl2_add_u32 s50, s45, s50
    s_mul_i32 s50, s50, 0xd800
    s_add_u32 s50, s50, 0x1350000
    s_lshl_b32 s71, s42, 13
    s_add_u32 s71, s71, s50
    s_lshl_b32 s75, s1, 10
    s_add_u32 s75, s75, s50
    s_waitcnt vmcnt(0)
    v_cmp_ne_u32 vcc, s40, v179
    s_nop 0
    s_cmp_eq_u64 vcc, 0
    s_cbranch_scc1 L_seen_20
    s_mov_b32 s96, 400000
    buffer_load_dword v179, v178, s[4:7], 0 offen sc1
L_spin_19:
    s_sleep 3
    buffer_load_dword v177, v178, s[4:7], 0 offen sc1
    s_waitcnt vmcnt(1)
    v_cmp_ne_u32 vcc, s40, v179
    s_nop 0
    s_cmp_eq_u64 vcc, 0
    s_cbranch_scc1 L_seen_20
    s_sleep 3
    buffer_load_dword v179, v178, s[4:7], 0 offen sc1
    s_waitcnt vmcnt(1)
    v_cmp_ne_u32 vcc, s40, v177
    s_nop 0
    s_cmp_eq_u64 vcc, 0
    s_cbranch_scc1 L_seen_20
    s_sub_u32 s96, s96, 1
    s_cbranch_scc0 L_spin_19
L_seen_20:
    buffer_load_dwordx4 a[0:3], v2, s[4:7], s80 offen sc1
    buffer_load_dwordx4 a[4:7], v2, s[4:7], s81 offen sc1
    buffer_load_dwordx4 a[8:11], v2, s[4:7], s80 offen offset:1024 sc1
    buffer_load_dwordx4 a[12:15], v2, s[4:7], s81 offen offset:1024 sc1
    buffer_load_dwordx4 a[16:19], v2, s[4:7], s80 offen offset:2048 sc1
    buffer_load_dwordx4 a[20:23], v2, s[4:7], s81 offen offset:2048 sc1
    buffer_load_dwordx4 a[24:27], v2, s[4:7], s80 offen offset:3072 sc1
    buffer_load_dwordx4 a[28:31], v2, s[4:7], s81 offen offset:3072 sc1
    buffer_load_dwordx2 v[160:161], v40, s[4:7], s54 offen sc1
    buffer_load_dwordx2 v[162:163], v40, s[4:7], s54 offen offset:512 sc1
    buffer_load_dwordx2 v[164:165], v40, s[4:7], s54 offen offset:1024 sc1
    buffer_load_dwordx2 v[166:167], v40, s[4:7], s54 offen offset:1536 sc1
    s_waitcnt lgkmcnt(0)
    s_barrier
    ds_read_b128 v[128:131], v2
    ds_read_b128 v[132:135], v2 offset:1024
    ds_read_b128 v[136:139], v2 offset:2048
    ds_read_b128 v[140:143], v2 offset:3072
    ds_read_b128 v[144:147], v2 offset:4096
    ds_read_b128 v[148:151], v2 offset:5120
    ds_read_b128 v[152:155], v2 offset:6144
    ds_read_b128 v[156:159], v2 offset:7168
    s_waitcnt vmcnt(10) lgkmcnt(4)
    v_mfma_f32_16x16x32_bf16 v[16:19], v[128:131], a[0:3], 0
    ds_read_b128 v[184:187], v2 offset:8192
    s_add_u32 s80, s80, 4096
    v_mfma_f32_16x16x32_bf16 v[20:23], v[128:131], a[4:7], 0
    buffer_load_dwordx4 a[32:35], v2, s[4:7], s80 offen sc1
    v_mfma_f32_16x16x32_bf16 v[24:27], v[132:135], a[0:3], 0
    ds_read_b128 v[128:131], v2 offset:9216
    v_mfma_f32_16x16x32_bf16 v[28:31], v[132:135], a[4:7], 0
    v_mfma_f32_16x16x32_bf16 v[32:35], v[136:139], a[0:3], 0
    ds_read_b128 v[132:135], v2 offset:10240
    s_add_u32 s83, s86, 98304
    v_mfma_f32_16x16x32_bf16 v[36:39], v[136:139], a[4:7], 0
    s_add_u32 m0, s94, 110592
    v_mfma_f32_16x16x32_bf16 v[40:43], v[140:143], a[0:3], 0
    ds_read_b128 v[136:139], v2 offset:11264
    v_mfma_f32_16x16x32_bf16 v[44:47], v[140:143], a[4:7], 0
    buffer_load_dwordx4 v2, s[4:7], s83 offen sc1 lds
    s_waitcnt lgkmcnt(4)
    v_mfma_f32_16x16x32_bf16 v[48:51], v[144:147], a[0:3], 0
    ds_read_b128 v[140:143], v2 offset:12288
    s_add_u32 s81, s81, 4096
    v_mfma_f32_16x16x32_bf16 v[52:55], v[144:147], a[4:7], 0
    buffer_load_dwordx4 a[36:39], v2, s[4:7], s81 offen sc1
    v_mfma_f32_16x16x32_bf16 v[56:59], v[148:151], a[0:3], 0
    ds_read_b128 v[144:147], v2 offset:13312
    v_mfma_f32_16x16x32_bf16 v[60:63], v[148:151], a[4:7], 0
    buffer_load_dwordx4 v2, s[4:7], s83 offen offset:1024 sc1 lds
    v_mfma_f32_16x16x32_bf16 v[64:67], v[152:155], a[0:3], 0
    ds_read_b128 v[148:151], v2 offset:14336
    v_mfma_f32_16x16x32_bf16 v[68:71], v[152:155], a[4:7], 0
    v_mfma_f32_16x16x32_bf16 v[72:75], v[156:159], a[0:3], 0
    ds_read_b128 v[152:155], v2 offset:15360
    v_mfma_f32_16x16x32_bf16 v[76:79], v[156:159], a[4:7], 0
    s_waitcnt vmcnt(12) lgkmcnt(4)
    v_mfma_f32_16x16x32_bf16 v[16:19], v[184:187], a[8:11], v[16:19]
    ds_read_b128 v[156:159], v2 offset:16384
    v_mfma_f32_16x16x32_bf16 v[20:23], v[184:187], a[12:15], v[20:23]
    buffer_load_dwordx4 a[40:43], v2, s[4:7], s80 offen offset:1024 sc1
    v_mfma_f32_16x16x32_bf16 v[24:27], v[128:131], a[8:11], v[24:27]
    ds_read_b128 v[184:187], v2 offset:17408
    v_mfma_f32_16x16x32_bf16 v[28:31], v[128:131], a[12:15], v[28:31]
    buffer_load_dwordx4 v2, s[4:7], s83 offen offset:2048 sc1 lds
    v_mfma_f32_16x16x32_bf16 v[32:35], v[132:135], a[8:11], v[32:35]
    ds_read_b128 v[128:131], v2 offset:18432
    v_mfma_f32_16x16x32_bf16 v[36:39], v[132:135], a[12:15], v[36:39]
    v_mfma_f32_16x16x32_bf16 v[40:43], v[136:139], a[8:11], v[40:43]
    ds_read_b128 v[132:135], v2 offset:19456
    v_mfma_f32_16x16x32_bf16 v[44:47], v[136:139], a[12:15], v[44:47]
    s_waitcnt lgkmcnt(4)
    v_mfma_f32_16x16x32_bf16 v[48:51], v[140:143], a[8:11], v[48:51]
    ds_read_b128 v[136:139], v2 offset:20480
    v_mfma_f32_16x16x32_bf16 v[52:55], v[140:143], a[12:15], v[52:55]
    buffer_load_dwordx4 a[44:47], v2, s[4:7], s81 offen offset:1024 sc1
    v_mfma_f32_16x16x32_bf16 v[56:59], v[144:147], a[8:11], v[56:59]
    ds_read_b128 v[140:143], v2 offset:21504
    buffer_load_dwordx4 v2, s[4:7], s83 offen offset:3072 sc1 lds
    v_mfma_f32_16x16x32_bf16 v[60:63], v[144:147], a[12:15], v[60:63]
    v_mfma_f32_16x16x32_bf16 v[64:67], v[148:151], a[8:11], v[64:67]
    ds_read_b128 v[144:147], v2 offset:22528
    s_add_u32 s83, s86, 114688
    v_mfma_f32_16x16x32_bf16 v[68:71], v[148:151], a[12:15], v[68:71]
    s_add_u32 m0, s94, 126976
    v_mfma_f32_16x16x32_bf16 v[72:75], v[152:155], a[8:11], v[72:75]
    ds_read_b128 v[148:151], v2 offset:23552
    v_mfma_f32_16x16x32_bf16 v[76:79], v[152:155], a[12:15], v[76:79]
    buffer_load_dwordx4 v2, s[4:7], s83 offen sc1 lds
    s_waitcnt vmcnt(15) lgkmcnt(4)
    v_mfma_f32_16x16x32_bf16 v[16:19], v[156:159], a[16:19], v[16:19]
    ds_read_b128 v[152:155], v2 offset:24576
    v_mfma_f32_16x16x32_bf16 v[20:23], v[156:159], a[20:23], v[20:23]
    buffer_load_dwordx4 a[48:51], v2, s[4:7], s80 offen offset:2048 sc1
    v_mfma_f32_16x16x32_bf16 v[24:27], v[184:187], a[16:19], v[24:27]
    ds_read_b128 v[156:159], v2 offset:25600
    v_mfma_f32_16x16x32_bf16 v[28:31], v[184:187], a[20:23], v[28:31]
    buffer_load_dwordx4 v2, s[4:7], s83 offen offset:1024 sc1 lds
    v_mfma_f32_16x16x32_bf16 v[32:35], v[128:131], a[16:19], v[32:35]
    ds_read_b128 v[184:187], v2 offset:26624
    v_mfma_f32_16x16x32_bf16 v[36:39], v[128:131], a[20:23], v[36:39]
    v_mfma_f32_16x16x32_bf16 v[40:43], v[132:135], a[16:19], v[40:43]
    ds_read_b128 v[128:131], v2 offset:27648
    v_mfma_f32_16x16x32_bf16 v[44:47], v[132:135], a[20:23], v[44:47]
    s_waitcnt lgkmcnt(4)
    v_mfma_f32_16x16x32_bf16 v[48:51], v[136:139], a[16:19], v[48:51]
    ds_read_b128 v[132:135], v2 offset:28672
    v_mfma_f32_16x16x32_bf16 v[52:55], v[136:139], a[20:23], v[52:55]
    buffer_load_dwordx4 a[52:55], v2, s[4:7], s81 offen offset:2048 sc1
    v_mfma_f32_16x16x32_bf16 v[56:59], v[140:143], a[16:19], v[56:59]
    ds_read_b128 v[136:139], v2 offset:29696
    v_mfma_f32_16x16x32_bf16 v[60:63], v[140:143], a[20:23], v[60:63]
    buffer_load_dwordx4 v2, s[4:7], s83 offen offset:2048 sc1 lds
    v_mfma_f32_16x16x32_bf16 v[64:67], v[144:147], a[16:19], v[64:67]
    ds_read_b128 v[140:143], v2 offset:30720
    v_mfma_f32_16x16x32_bf16 v[68:71], v[144:147], a[20:23], v[68:71]
    v_mfma_f32_16x16x32_bf16 v[72:75], v[148:151], a[16:19], v[72:75]
    ds_read_b128 v[144:147], v2 offset:31744
    v_mfma_f32_16x16x32_bf16 v[76:79], v[148:151], a[20:23], v[76:79]
    s_waitcnt vmcnt(17) lgkmcnt(4)
    v_mfma_f32_16x16x32_bf16 v[16:19], v[152:155], a[24:27], v[16:19]
    ds_read_b128 v[148:151], v2 offset:32768
    v_mfma_f32_16x16x32_bf16 v[20:23], v[152:155], a[28:31], v[20:23]
    buffer_load_dwordx4 a[56:59], v2, s[4:7], s80 offen offset:3072 sc1
    v_mfma_f32_16x16x32_bf16 v[24:27], v[156:159], a[24:27], v[24:27]
    ds_read_b128 v[152:155], v2 offset:33792
    buffer_load_dwordx4 v2, s[4:7], s83 offen offset:3072 sc1 lds
    v_mfma_f32_16x16x32_bf16 v[28:31], v[156:159], a[28:31], v[28:31]
    v_mfma_f32_16x16x32_bf16 v[32:35], v[184:187], a[24:27], v[32:35]
    ds_read_b128 v[156:159], v2 offset:34816
    s_add_u32 s83, s86, 131072
    v_mfma_f32_16x16x32_bf16 v[36:39], v[184:187], a[28:31], v[36:39]
    s_add_u32 m0, s94, 143360
    v_mfma_f32_16x16x32_bf16 v[40:43], v[128:131], a[24:27], v[40:43]
    ds_read_b128 v[184:187], v2 offset:35840
    v_mfma_f32_16x16x32_bf16 v[44:47], v[128:131], a[28:31], v[44:47]
    buffer_load_dwordx4 v2, s[4:7], s83 offen sc1 lds
    s_waitcnt lgkmcnt(4)
    v_mfma_f32_16x16x32_bf16 v[48:51], v[132:135], a[24:27], v[48:51]
    ds_read_b128 v[128:131], v2 offset:36864
    v_mfma_f32_16x16x32_bf16 v[52:55], v[132:135], a[28:31], v[52:55]
    buffer_load_dwordx4 a[60:63], v2, s[4:7], s81 offen offset:3072 sc1
    v_mfma_f32_16x16x32_bf16 v[56:59], v[136:139], a[24:27], v[56:59]
    ds_read_b128 v[132:135], v2 offset:37888
    v_mfma_f32_16x16x32_bf16 v[60:63], v[136:139], a[28:31], v[60:63]
    buffer_load_dwordx4 v2, s[4:7], s83 offen offset:1024 sc1 lds
    v_mfma_f32_16x16x32_bf16 v[64:67], v[140:143], a[24:27], v[64:67]
    ds_read_b128 v[136:139], v2 offset:38912
    v_mfma_f32_16x16x32_bf16 v[68:71], v[140:143], a[28:31], v[68:71]
    v_mfma_f32_16x16x32_bf16 v[72:75], v[144:147], a[24:27], v[72:75]
    ds_read_b128 v[140:143], v2 offset:39936
    v_mfma_f32_16x16x32_bf16 v[76:79], v[144:147], a[28:31], v[76:79]
    s_waitcnt vmcnt(15) lgkmcnt(4)
    v_mfma_f32_16x16x32_bf16 v[16:19], v[148:151], a[32:35], v[16:19]
    ds_read_b128 v[144:147], v2 offset:40960
    s_add_u32 s80, s80, 4096
    v_mfma_f32_16x16x32_bf16 v[20:23], v[148:151], a[36:39], v[20:23]
    buffer_load_dwordx4 a[64:67], v2, s[4:7], s80 offen sc1
    v_mfma_f32_16x16x32_bf16 v[24:27], v[152:155], a[32:35], v[24:27]
    ds_read_b128 v[148:151], v2 offset:41984
    v_mfma_f32_16x16x32_bf16 v[28:31], v[152:155], a[36:39], v[28:31]
    buffer_load_dwordx4 v2, s[4:7], s83 offen offset:2048 sc1 lds
    v_mfma_f32_16x16x32_bf16 v[32:35], v[156:159], a[32:35], v[32:35]
    ds_read_b128 v[152:155], v2 offset:43008
    v_mfma_f32_16x16x32_bf16 v[36:39], v[156:159], a[36:39], v[36:39]
    v_mfma_f32_16x16x32_bf16 v[40:43], v[184:187], a[32:35], v[40:43]
    ds_read_b128 v[156:159], v2 offset:44032
    v_mfma_f32_16x16x32_bf16 v[44:47], v[184:187], a[36:39], v[44:47]
    s_waitcnt lgkmcnt(4)
    v_mfma_f32_16x16x32_bf16 v[48:51], v[128:131], a[32:35], v[48:51]
    ds_read_b128 v[184:187], v2 offset:45056
    s_add_u32 s81, s81, 4096
    v_mfma_f32_16x16x32_bf16 v[52:55], v[128:131], a[36:39], v[52:55]
    buffer_load_dwordx4 a[68:71], v2, s[4:7], s81 offen sc1
    v_mfma_f32_16x16x32_bf16 v[56:59], v[132:135], a[32:35], v[56:59]
    ds_read_b128 v[128:131], v2 offset:46080
    buffer_load_dwordx4 v2, s[4:7], s83 offen offset:3072 sc1 lds
    v_mfma_f32_16x16x32_bf16 v[60:63], v[132:135], a[36:39], v[60:63]
    v_mfma_f32_16x16x32_bf16 v[64:67], v[136:139], a[32:35], v[64:67]
    ds_read_b128 v[132:135], v2 offset:47104
    v_mfma_f32_16x16x32_bf16 v[68:71], v[136:139], a[36:39], v[68:71]
    v_mfma_f32_16x16x32_bf16 v[72:75], v[140:143], a[32:35], v[72:75]
    ds_read_b128 v[136:139], v2 offset:48128
    v_mfma_f32_16x16x32_bf16 v[76:79], v[140:143], a[36:39], v[76:79]
    s_waitcnt vmcnt(15) lgkmcnt(4)
    v_mfma_f32_16x16x32_bf16 v[16:19], v[144:147], a[40:43], v[16:19]
    ds_read_b128 v[140:143], v3
    v_mfma_f32_16x16x32_bf16 v[20:23], v[144:147], a[44:47], v[20:23]
    buffer_load_dwordx4 a[72:75], v2, s[4:7], s80 offen offset:1024 sc1
    v_mfma_f32_16x16x32_bf16 v[24:27], v[148:151], a[40:43], v[24:27]
    ds_read_b128 v[144:147], v3 offset:1024
    v_lshrrev_b32 v179, 4, v1
    v_mfma_f32_16x16x32_bf16 v[28:31], v[148:151], a[44:47], v[28:31]
    v_mfma_f32_16x16x32_bf16 v[32:35], v[152:155], a[40:43], v[32:35]
    ds_read_b128 v[148:151], v3 offset:2048
    v_lshlrev_b32 v179, 4, v179
    v_mfma_f32_16x16x32_bf16 v[36:39], v[152:155], a[44:47], v[36:39]
    v_mfma_f32_16x16x32_bf16 v[40:43], v[156:159], a[40:43], v[40:43]
    ds_read_b128 v[152:155], v3 offset:3072
    v_add_u32 v179, 0xd800, v179
    v_mfma_f32_16x16x32_bf16 v[44:47], v[156:159], a[44:47], v[44:47]
    s_waitcnt lgkmcnt(4)
    v_mfma_f32_16x16x32_bf16 v[48:51], v[184:187], a[40:43], v[48:51]
    ds_read_b128 v[156:159], v3 offset:4096
    v_add_f32 v168, v160, v162
    v_mfma_f32_16x16x32_bf16 v[52:55], v[184:187], a[44:47], v[52:55]
    buffer_load_dwordx4 a[76:79], v2, s[4:7], s81 offen offset:1024 sc1
    v_mfma_f32_16x16x32_bf16 v[56:59], v[128:131], a[40:43], v[56:59]
    ds_read_b128 v[184:187], v3 offset:5120
    v_mov_b32 v169, v168
    v_mfma_f32_16x16x32_bf16 v[60:63], v[128:131], a[44:47], v[60:63]
    v_mfma_f32_16x16x32_bf16 v[64:67], v[132:135], a[40:43], v[64:67]
    ds_read_b128 v[128:131], v3 offset:6144
    v_permlane16_swap_b32 v168, v169
    v_mfma_f32_16x16x32_bf16 v[68:71], v[132:135], a[44:47], v[68:71]
    v_mfma_f32_16x16x32_bf16 v[72:75], v[136:139], a[40:43], v[72:75]
    ds_read_b128 v[132:135], v3 offset:7168
    v_add_f32 v168, v168, v169
    v_mfma_f32_16x16x32_bf16 v[76:79], v[136:139], a[44:47], v[76:79]
    s_waitcnt vmcnt(12) lgkmcnt(4)
    v_mfma_f32_16x16x32_bf16 v[16:19], v[140:143], a[48:51], v[16:19]
    ds_read_b128 v[136:139], v3 offset:8192
    v_mov_b32 v169, v168
    v_mfma_f32_16x16x32_bf16 v[20:23], v[140:143], a[52:55], v[20:23]
    buffer_load_dwordx4 a[80:83], v2, s[4:7], s80 offen offset:2048 sc1
    v_mfma_f32_16x16x32_bf16 v[24:27], v[144:147], a[48:51], v[24:27]
    ds_read_b128 v[140:143], v3 offset:9216
    v_permlane32_swap_b32 v168, v169
    v_mfma_f32_16x16x32_bf16 v[28:31], v[144:147], a[52:55], v[28:31]
    v_mfma_f32_16x16x32_bf16 v[32:35], v[148:151], a[48:51], v[32:35]
    ds_read_b128 v[144:147], v3 offset:10240
    v_add_f32 v168, v168, v169
    v_mfma_f32_16x16x32_bf16 v[36:39], v[148:151], a[52:55], v[36:39]
    v_mfma_f32_16x16x32_bf16 v[40:43], v[152:155], a[48:51], v[40:43]
    ds_read_b128 v[148:151], v3 offset:11264
    v_mul_f32 v168, 0xbe000000, v168
    v_mfma_f32_16x16x32_bf16 v[44:47], v[152:155], a[52:55], v[44:47]
    s_waitcnt lgkmcnt(4)
    v_mfma_f32_16x16x32_bf16 v[48:51], v[156:159], a[48:51], v[48:51]
    ds_read_b128 v[152:155], v3 offset:12288
    v_add_f32 v160, v160, v168
    v_mfma_f32_16x16x32_bf16 v[52:55], v[156:159], a[52:55], v[52:55]
    buffer_load_dwordx4 a[84:87], v2, s[4:7], s81 offen offset:2048 sc1
    v_mfma_f32_16x16x32_bf16 v[56:59], v[184:187], a[48:51], v[56:59]
    ds_read_b128 v[156:159], v3 offset:13312
    v_add_f32 v162, v162, v168
    v_mfma_f32_16x16x32_bf16 v[60:63], v[184:187], a[52:55], v[60:63]
    v_mfma_f32_16x16x32_bf16 v[64:67], v[128:131], a[48:51], v[64:67]
    ds_read_b128 v[184:187], v3 offset:14336
    v_mul_f32 v160, v160, v160
    v_mfma_f32_16x16x32_bf16 v[68:71], v[128:131], a[52:55], v[68:71]
    v_mfma_f32_16x16x32_bf16 v[72:75], v[132:135], a[48:51], v[72:75]
    ds_read_b128 v[128:131], v3 offset:15360
    v_fmac_f32 v160, v162, v162
    v_mfma_f32_16x16x32_bf16 v[76:79], v[132:135], a[52:55], v[76:79]
    s_waitcnt vmcnt(9) lgkmcnt(4)
    v_mfma_f32_16x16x32_bf16 v[16:19], v[136:139], a[56:59], v[16:19]
    ds_read_b128 v[132:135], v3 offset:16384
    v_add_f32 v161, v161, v163
    v_mfma_f32_16x16x32_bf16 v[20:23], v[136:139], a[60:63], v[20:23]
    buffer_load_dwordx4 a[88:91], v2, s[4:7], s80 offen offset:3072 sc1
    v_mfma_f32_16x16x32_bf16 v[24:27], v[140:143], a[56:59], v[24:27]
    ds_read_b128 v[136:139], v3 offset:17408
    v_fmac_f32 v161, 0x42a00000, v160
    v_mfma_f32_16x16x32_bf16 v[28:31], v[140:143], a[60:63], v[28:31]
    v_mfma_f32_16x16x32_bf16 v[32:35], v[144:147], a[56:59], v[32:35]
    ds_read_b128 v[140:143], v3 offset:18432
    v_mov_b32 v169, v161
    v_mfma_f32_16x16x32_bf16 v[36:39], v[144:147], a[60:63], v[36:39]
    v_mfma_f32_16x16x32_bf16 v[40:43], v[148:151], a[56:59], v[40:43]
    ds_read_b128 v[144:147], v3 offset:19456
    v_permlane16_swap_b32 v161, v169
    v_mfma_f32_16x16x32_bf16 v[44:47], v[148:151], a[60:63], v[44:47]
    s_waitcnt lgkmcnt(4)
    v_mfma_f32_16x16x32_bf16 v[48:51], v[152:155], a[56:59], v[48:51]
    ds_read_b128 v[148:151], v3 offset:20480
    v_add_f32 v161, v161, v169
    v_mfma_f32_16x16x32_bf16 v[52:55], v[152:155], a[60:63], v[52:55]
    buffer_load_dwordx4 a[92:95], v2, s[4:7], s81 offen offset:3072 sc1
    v_mfma_f32_16x16x32_bf16 v[56:59], v[156:159], a[56:59], v[56:59]
    ds_read_b128 v[152:155], v3 offset:21504
    v_mov_b32 v169, v161
    v_mfma_f32_16x16x32_bf16 v[60:63], v[156:159], a[60:63], v[60:63]
    v_mfma_f32_16x16x32_bf16 v[64:67], v[184:187], a[56:59], v[64:67]
    ds_read_b128 v[156:159], v3 offset:22528
    v_permlane32_swap_b32 v161, v169
    v_mfma_f32_16x16x32_bf16 v[68:71], v[184:187], a[60:63], v[68:71]
    v_mfma_f32_16x16x32_bf16 v[72:75], v[128:131], a[56:59], v[72:75]
    ds_read_b128 v[184:187], v3 offset:23552
    v_add_f32 v161, v161, v169
    v_mfma_f32_16x16x32_bf16 v[76:79], v[128:131], a[60:63], v[76:79]
    s_waitcnt vmcnt(7) lgkmcnt(4)
    v_mfma_f32_16x16x32_bf16 v[16:19], v[132:135], a[64:67], v[16:19]
    ds_read_b128 v[128:131], v3 offset:24576
    s_add_u32 s80, s80, 4096
    v_mfma_f32_16x16x32_bf16 v[20:23], v[132:135], a[68:71], v[20:23]
    buffer_load_dwordx4 a[96:99], v2, s[4:7], s80 offen sc1
    v_mfma_f32_16x16x32_bf16 v[24:27], v[136:139], a[64:67], v[24:27]
    ds_read_b128 v[132:135], v3 offset:25600
    v_mov_b32 v163, 0x3727c5ac
    v_mfma_f32_16x16x32_bf16 v[28:31], v[136:139], a[68:71], v[28:31]
    v_mfma_f32_16x16x32_bf16 v[32:35], v[140:143], a[64:67], v[32:35]
    ds_read_b128 v[136:139], v3 offset:26624
    v_fmac_f32 v163, 0x3acccccd, v161
    v_mfma_f32_16x16x32_bf16 v[36:39], v[140:143], a[68:71], v[36:39]
    v_mfma_f32_16x16x32_bf16 v[40:43], v[144:147], a[64:67], v[40:43]
    ds_read_b128 v[140:143], v3 offset:27648
    v_rsq_f32 v188, v163
    v_mfma_f32_16x16x32_bf16 v[44:47], v[144:147], a[68:71], v[44:47]
    s_waitcnt lgkmcnt(4)
    v_mfma_f32_16x16x32_bf16 v[48:51], v[148:151], a[64:67], v[48:51]
    ds_read_b128 v[144:147], v3 offset:28672
    s_add_u32 s81, s81, 4096
    v_mfma_f32_16x16x32_bf16 v[52:55], v[148:151], a[68:71], v[52:55]
    buffer_load_dwordx4 a[100:103], v2, s[4:7], s81 offen sc1
    v_mfma_f32_16x16x32_bf16 v[56:59], v[152:155], a[64:67], v[56:59]
    ds_read_b128 v[148:151], v3 offset:29696
    v_mul_f32 v189, v188, v168
    v_mfma_f32_16x16x32_bf16 v[60:63], v[152:155], a[68:71], v[60:63]
    v_mfma_f32_16x16x32_bf16 v[64:67], v[156:159], a[64:67], v[64:67]
    ds_read_b128 v[152:155], v3 offset:30720
    v_add_f32 v172, v164, v166
    v_mfma_f32_16x16x32_bf16 v[68:71], v[156:159], a[68:71], v[68:71]
    v_mfma_f32_16x16x32_bf16 v[72:75], v[184:187], a[64:67], v[72:75]
    ds_read_b128 v[156:159], v3 offset:31744
    v_mov_b32 v173, v172
    v_mfma_f32_16x16x32_bf16 v[76:79], v[184:187], a[68:71], v[76:79]
    s_waitcnt vmcnt(6) lgkmcnt(4)
    v_mfma_f32_16x16x32_bf16 v[16:19], v[128:131], a[72:75], v[16:19]
    ds_read_b128 v[184:187], v3 offset:32768
    v_permlane16_swap_b32 v172, v173
    v_mfma_f32_16x16x32_bf16 v[20:23], v[128:131], a[76:79], v[20:23]
    buffer_load_dwordx4 a[104:107], v2, s[4:7], s80 offen offset:1024 sc1
    v_mfma_f32_16x16x32_bf16 v[24:27], v[132:135], a[72:75], v[24:27]
    ds_read_b128 v[128:131], v3 offset:33792
    v_add_f32 v172, v172, v173
    v_mfma_f32_16x16x32_bf16 v[28:31], v[132:135], a[76:79], v[28:31]
    v_mfma_f32_16x16x32_bf16 v[32:35], v[136:139], a[72:75], v[32:35]
    ds_read_b128 v[132:135], v3 offset:34816
    v_mov_b32 v173, v172
    v_mfma_f32_16x16x32_bf16 v[36:39], v[136:139], a[76:79], v[36:39]
    v_mfma_f32_16x16x32_bf16 v[40:43], v[140:143], a[72:75], v[40:43]
    ds_read_b128 v[136:139], v3 offset:35840
    v_permlane32_swap_b32 v172, v173
    v_mfma_f32_16x16x32_bf16 v[44:47], v[140:143], a[76:79], v[44:47]
    s_waitcnt lgkmcnt(4)
    v_mfma_f32_16x16x32_bf16 v[48:51], v[144:147], a[72:75], v[48:51]
    ds_read_b128 v[140:143], v3 offset:36864
    v_add_f32 v172, v172, v173
    v_mfma_f32_16x16x32_bf16 v[52:55], v[144:147], a[76:79], v[52:55]
    buffer_load_dwordx4 a[108:111], v2, s[4:7], s81 offen offset:1024 sc1
    v_mfma_f32_16x16x32_bf16 v[56:59], v[148:151], a[72:75], v[56:59]
    ds_read_b128 v[144:147], v3 offset:37888
    v_mul_f32 v172, 0xbe000000, v172
    v_mfma_f32_16x16x32_bf16 v[60:63], v[148:151], a[76:79], v[60:63]
    v_mfma_f32_16x16x32_bf16 v[64:67], v[152:155], a[72:75], v[64:67]
    ds_read_b128 v[148:151], v3 offset:38912
    v_add_f32 v164, v164, v172
    v_mfma_f32_16x16x32_bf16 v[68:71], v[152:155], a[76:79], v[68:71]
    v_mfma_f32_16x16x32_bf16 v[72:75], v[156:159], a[72:75], v[72:75]
    ds_read_b128 v[152:155], v3 offset:39936
    v_add_f32 v166, v166, v172
    v_mfma_f32_16x16x32_bf16 v[76:79], v[156:159], a[76:79], v[76:79]
    s_barrier
    s_waitcnt vmcnt(6) lgkmcnt(4)
    v_mfma_f32_16x16x32_bf16 v[16:19], v[184:187], a[80:83], v[16:19]
    ds_read_b128 v[156:159], v3 offset:40960
    s_add_u32 s83, s86, 147456
    v_mfma_f32_16x16x32_bf16 v[20:23], v[184:187], a[84:87], v[20:23]
    buffer_load_dwordx4 a[112:115], v2, s[4:7], s80 offen offset:2048 sc1
    v_mfma_f32_16x16x32_bf16 v[24:27], v[128:131], a[80:83], v[24:27]
    ds_read_b128 v[184:187], v3 offset:41984
    s_add_u32 m0, s94, 0
    v_mfma_f32_16x16x32_bf16 v[28:31], v[128:131], a[84:87], v[28:31]
    buffer_load_dwordx4 v2, s[4:7], s83 offen sc1 lds
    v_mfma_f32_16x16x32_bf16 v[32:35], v[132:135], a[80:83], v[32:35]
    ds_read_b128 v[128:131], v3 offset:43008
    v_mul_f32 v164, v164, v164
    v_mfma_f32_16x16x32_bf16 v[36:39], v[132:135], a[84:87], v[36:39]
    v_mfma_f32_16x16x32_bf16 v[40:43], v[136:139], a[80:83], v[40:43]
    ds_read_b128 v[132:135], v3 offset:44032
    v_fmac_f32 v164, v166, v166
    v_mfma_f32_16x16x32_bf16 v[44:47], v[136:139], a[84:87], v[44:47]
    s_waitcnt lgkmcnt(4)
    v_mfma_f32_16x16x32_bf16 v[48:51], v[140:143], a[80:83], v[48:51]
    ds_read_b128 v[136:139], v3 offset:45056
    v_add_f32 v165, v165, v167
    v_mfma_f32_16x16x32_bf16 v[52:55], v[140:143], a[84:87], v[52:55]
    buffer_load_dwordx4 a[116:119], v2, s[4:7], s81 offen offset:2048 sc1
    v_mfma_f32_16x16x32_bf16 v[56:59], v[144:147], a[80:83], v[56:59]
    ds_read_b128 v[140:143], v3 offset:46080
    buffer_load_dwordx4 v2, s[4:7], s83 offen offset:1024 sc1 lds
    v_mfma_f32_16x16x32_bf16 v[60:63], v[144:147], a[84:87], v[60:63]
    v_fmac_f32 v165, 0x42a00000, v164
    v_mfma_f32_16x16x32_bf16 v[64:67], v[148:151], a[80:83], v[64:67]
    ds_read_b128 v[144:147], v3 offset:47104
    v_mfma_f32_16x16x32_bf16 v[68:71], v[148:151], a[84:87], v[68:71]
    buffer_load_dwordx4 v2, s[4:7], s83 offen offset:2048 sc1 lds
    v_mfma_f32_16x16x32_bf16 v[72:75], v[152:155], a[80:83], v[72:75]
    ds_read_b128 v[148:151], v3 offset:48128
    v_mov_b32 v173, v165
    v_mfma_f32_16x16x32_bf16 v[76:79], v[152:155], a[84:87], v[76:79]
    s_waitcnt vmcnt(9) lgkmcnt(4)
    v_mfma_f32_16x16x32_bf16 v[16:19], v[156:159], a[88:91], v[16:19]
    ds_read_b128 v[152:155], v3 offset:49152
    v_permlane16_swap_b32 v165, v173
    v_mfma_f32_16x16x32_bf16 v[20:23], v[156:159], a[92:95], v[20:23]
    buffer_load_dwordx4 a[120:123], v2, s[4:7], s80 offen offset:3072 sc1
    v_mfma_f32_16x16x32_bf16 v[24:27], v[184:187], a[88:91], v[24:27]
    ds_read_b128 v[156:159], v3 offset:50176
    v_add_f32 v165, v165, v173
    v_mfma_f32_16x16x32_bf16 v[28:31], v[184:187], a[92:95], v[28:31]
    buffer_load_dwordx4 v2, s[4:7], s83 offen offset:3072 sc1 lds
    v_mfma_f32_16x16x32_bf16 v[32:35], v[128:131], a[88:91], v[32:35]
    ds_read_b128 v[184:187], v3 offset:51200
    v_mov_b32 v173, v165
    v_mfma_f32_16x16x32_bf16 v[36:39], v[128:131], a[92:95], v[36:39]
    v_mfma_f32_16x16x32_bf16 v[40:43], v[132:135], a[88:91], v[40:43]
    ds_read_b128 v[128:131], v3 offset:52224
    v_permlane32_swap_b32 v165, v173
    v_mfma_f32_16x16x32_bf16 v[44:47], v[132:135], a[92:95], v[44:47]
    s_waitcnt lgkmcnt(4)
    v_mfma_f32_16x16x32_bf16 v[48:51], v[136:139], a[88:91], v[48:51]
    ds_read_b128 v[132:135], v3 offset:53248
    s_add_u32 s83, s87, 0
    v_mfma_f32_16x16x32_bf16 v[52:55], v[136:139], a[92:95], v[52:55]
    buffer_load_dwordx4 a[124:127], v2, s[4:7], s81 offen offset:3072 sc1
    v_mfma_f32_16x16x32_bf16 v[56:59], v[140:143], a[88:91], v[56:59]
    ds_read_b128 v[136:139], v3 offset:54272
    s_add_u32 m0, s95, 24576
    v_mfma_f32_16x16x32_bf16 v[60:63], v[140:143], a[92:95], v[60:63]
    buffer_load_dwordx4 v2, s[4:7], s83 offen sc1 lds
    v_mfma_f32_16x16x32_bf16 v[64:67], v[144:147], a[88:91], v[64:67]
    ds_read_b128 v[140:143], v3 offset:55296
    v_add_f32 v165, v165, v173
    v_mfma_f32_16x16x32_bf16 v[68:71], v[144:147], a[92:95], v[68:71]
    v_mfma_f32_16x16x32_bf16 v[72:75], v[148:151], a[88:91], v[72:75]
    ds_read_b128 v[144:147], v3 offset:56320
    v_mov_b32 v167, 0x3727c5ac
    v_mfma_f32_16x16x32_bf16 v[76:79], v[148:151], a[92:95], v[76:79]
    s_waitcnt vmcnt(11) lgkmcnt(4)
    v_mfma_f32_16x16x32_bf16 v[16:19], v[152:155], a[96:99], v[16:19]
    ds_read_b128 v[148:151], v3 offset:57344
    s_add_u32 s80, s80, 4096
    v_mfma_f32_16x16x32_bf16 v[20:23], v[152:155], a[100:103], v[20:23]
    buffer_load_dwordx4 a[128:131], v2, s[4:7], s80 offen sc1
    v_mfma_f32_16x16x32_bf16 v[24:27], v[156:159], a[96:99], v[24:27]
    ds_read_b128 v[152:155], v3 offset:58368
    buffer_load_dwordx4 v2, s[4:7], s83 offen offset:1024 sc1 lds
    v_mfma_f32_16x16x32_bf16 v[28:31], v[156:159], a[100:103], v[28:31]
    v_fmac_f32 v167, 0x3acccccd, v165
    v_mfma_f32_16x16x32_bf16 v[32:35], v[184:187], a[96:99], v[32:35]
    ds_read_b128 v[156:159], v3 offset:59392
    v_mfma_f32_16x16x32_bf16 v[36:39], v[184:187], a[100:103], v[36:39]
    buffer_load_dwordx4 v2, s[4:7], s83 offen offset:2048 sc1 lds
    v_mfma_f32_16x16x32_bf16 v[40:43], v[128:131], a[96:99], v[40:43]
    ds_read_b128 v[184:187], v3 offset:60416
    v_rsq_f32 v190, v167
    v_mfma_f32_16x16x32_bf16 v[44:47], v[128:131], a[100:103], v[44:47]
    s_waitcnt lgkmcnt(4)
    v_mfma_f32_16x16x32_bf16 v[48:51], v[132:135], a[96:99], v[48:51]
    ds_read_b128 v[128:131], v3 offset:61440
    s_add_u32 s81, s81, 4096
    v_mfma_f32_16x16x32_bf16 v[52:55], v[132:135], a[100:103], v[52:55]
    buffer_load_dwordx4 a[132:135], v2, s[4:7], s81 offen sc1
    v_mfma_f32_16x16x32_bf16 v[56:59], v[136:139], a[96:99], v[56:59]
    ds_read_b128 v[132:135], v3 offset:62464
    s_add_u32 s83, s87, 180224
    v_mfma_f32_16x16x32_bf16 v[60:63], v[136:139], a[100:103], v[60:63]
    s_add_u32 m0, s95, 36864
    v_mul_f32 v191, v190, v172
    v_mfma_f32_16x16x32_bf16 v[64:67], v[140:143], a[96:99], v[64:67]
    ds_read_b128 v[136:139], v3 offset:63488
    v_mfma_f32_16x16x32_bf16 v[68:71], v[140:143], a[100:103], v[68:71]
    buffer_load_dwordx4 v2, s[4:7], s83 offen sc1 lds
    v_mfma_f32_16x16x32_bf16 v[72:75], v[144:147], a[96:99], v[72:75]
    ds_read_b128 v[140:143], v3 offset:64512
    v_mfma_f32_16x16x32_bf16 v[76:79], v[144:147], a[100:103], v[76:79]
    s_waitcnt vmcnt(14) lgkmcnt(4)
    v_mfma_f32_16x16x32_bf16 v[16:19], v[148:151], a[104:107], v[16:19]
    ds_read_b128 v[144:147], v14
    v_mfma_f32_16x16x32_bf16 v[20:23], v[148:151], a[108:111], v[20:23]
    buffer_load_dwordx4 a[136:139], v2, s[4:7], s80 offen offset:1024 sc1
    v_mfma_f32_16x16x32_bf16 v[24:27], v[152:155], a[104:107], v[24:27]
    ds_read_b128 v[148:151], v14 offset:1024
    v_mfma_f32_16x16x32_bf16 v[28:31], v[152:155], a[108:111], v[28:31]
    buffer_load_dwordx4 v2, s[4:7], s83 offen offset:1024 sc1 lds
    v_mfma_f32_16x16x32_bf16 v[32:35], v[156:159], a[104:107], v[32:35]
    ds_read_b128 v[152:155], v14 offset:2048
    v_mfma_f32_16x16x32_bf16 v[36:39], v[156:159], a[108:111], v[36:39]
    v_mfma_f32_16x16x32_bf16 v[40:43], v[184:187], a[104:107], v[40:43]
    ds_read_b128 v[156:159], v14 offset:3072
    v_mfma_f32_16x16x32_bf16 v[44:47], v[184:187], a[108:111], v[44:47]
    s_waitcnt lgkmcnt(4)
    v_mfma_f32_16x16x32_bf16 v[48:51], v[128:131], a[104:107], v[48:51]
    ds_read_b128 v[184:187], v14 offset:4096
    v_mfma_f32_16x16x32_bf16 v[52:55], v[128:131], a[108:111], v[52:55]
    buffer_load_dwordx4 a[140:143], v2, s[4:7], s81 offen offset:1024 sc1
    v_mfma_f32_16x16x32_bf16 v[56:59], v[132:135], a[104:107], v[56:59]
    ds_read_b128 v[128:131], v14 offset:5120
    buffer_load_dwordx4 v2, s[4:7], s83 offen offset:2048 sc1 lds
    v_mfma_f32_16x16x32_bf16 v[60:63], v[132:135], a[108:111], v[60:63]
    v_mfma_f32_16x16x32_bf16 v[64:67], v[136:139], a[104:107], v[64:67]
    ds_read_b128 v[132:135], v14 offset:6144
    s_add_u32 s83, s87, 360448
    v_mfma_f32_16x16x32_bf16 v[68:71], v[136:139], a[108:111], v[68:71]
    s_add_u32 m0, s95, 61440
    v_mfma_f32_16x16x32_bf16 v[72:75], v[140:143], a[104:107], v[72:75]
    ds_read_b128 v[136:139], v14 offset:7168
    v_mfma_f32_16x16x32_bf16 v[76:79], v[140:143], a[108:111], v[76:79]
    buffer_load_dwordx4 v2, s[4:7], s83 offen sc1 lds
    s_waitcnt vmcnt(16) lgkmcnt(4)
    v_mfma_f32_16x16x32_bf16 v[16:19], v[144:147], a[112:115], v[16:19]
    ds_read_b128 v[140:143], v14 offset:8192
    v_mfma_f32_16x16x32_bf16 v[20:23], v[144:147], a[116:119], v[20:23]
    buffer_load_dwordx4 a[144:147], v2, s[4:7], s80 offen offset:2048 sc1
    v_mfma_f32_16x16x32_bf16 v[24:27], v[148:151], a[112:115], v[24:27]
    ds_read_b128 v[144:147], v14 offset:9216
    v_mfma_f32_16x16x32_bf16 v[28:31], v[148:151], a[116:119], v[28:31]
    buffer_load_dwordx4 v2, s[4:7], s83 offen offset:1024 sc1 lds
    v_mfma_f32_16x16x32_bf16 v[32:35], v[152:155], a[112:115], v[32:35]
    ds_read_b128 v[148:151], v14 offset:10240
    v_mfma_f32_16x16x32_bf16 v[36:39], v[152:155], a[116:119], v[36:39]
    v_mfma_f32_16x16x32_bf16 v[40:43], v[156:159], a[112:115], v[40:43]
    ds_read_b128 v[152:155], v14 offset:11264
    v_mfma_f32_16x16x32_bf16 v[44:47], v[156:159], a[116:119], v[44:47]
    s_waitcnt lgkmcnt(4)
    v_mfma_f32_16x16x32_bf16 v[48:51], v[184:187], a[112:115], v[48:51]
    ds_read_b128 v[156:159], v14 offset:12288
    v_mfma_f32_16x16x32_bf16 v[52:55], v[184:187], a[116:119], v[52:55]
    buffer_load_dwordx4 a[148:151], v2, s[4:7], s81 offen offset:2048 sc1
    v_mfma_f32_16x16x32_bf16 v[56:59], v[128:131], a[112:115], v[56:59]
    ds_read_b128 v[184:187], v14 offset:13312
    v_mfma_f32_16x16x32_bf16 v[60:63], v[128:131], a[116:119], v[60:63]
    buffer_load_dwordx4 v2, s[4:7], s83 offen offset:2048 sc1 lds
    v_mfma_f32_16x16x32_bf16 v[64:67], v[132:135], a[112:115], v[64:67]
    ds_read_b128 v[128:131], v14 offset:14336
    v_mfma_f32_16x16x32_bf16 v[68:71], v[132:135], a[116:119], v[68:71]
    v_mfma_f32_16x16x32_bf16 v[72:75], v[136:139], a[112:115], v[72:75]
    ds_read_b128 v[132:135], v14 offset:15360
    s_add_u32 s83, s87, 540672
    v_mfma_f32_16x16x32_bf16 v[76:79], v[136:139], a[116:119], v[76:79]
    s_add_u32 m0, s95, 73728
    s_waitcnt vmcnt(15) lgkmcnt(4)
    v_mfma_f32_16x16x32_bf16 v[16:19], v[140:143], a[120:123], v[16:19]
    ds_read_b128 v[136:139], v14 offset:16384
    v_mfma_f32_16x16x32_bf16 v[20:23], v[140:143], a[124:127], v[20:23]
    buffer_load_dwordx4 a[152:155], v2, s[4:7], s80 offen offset:3072 sc1
    v_mfma_f32_16x16x32_bf16 v[24:27], v[144:147], a[120:123], v[24:27]
    ds_read_b128 v[140:143], v14 offset:17408
    buffer_load_dwordx4 v2, s[4:7], s83 offen sc1 lds
    v_mfma_f32_16x16x32_bf16 v[28:31], v[144:147], a[124:127], v[28:31]
    v_mfma_f32_16x16x32_bf16 v[32:35], v[148:151], a[120:123], v[32:35]
    ds_read_b128 v[144:147], v14 offset:18432
    v_mfma_f32_16x16x32_bf16 v[36:39], v[148:151], a[124:127], v[36:39]
    buffer_load_dwordx4 v2, s[4:7], s83 offen offset:1024 sc1 lds
    v_mfma_f32_16x16x32_bf16 v[40:43], v[152:155], a[120:123], v[40:43]
    ds_read_b128 v[148:151], v14 offset:19456
    v_mfma_f32_16x16x32_bf16 v[44:47], v[152:155], a[124:127], v[44:47]
    s_waitcnt lgkmcnt(4)
    v_mfma_f32_16x16x32_bf16 v[48:51], v[156:159], a[120:123], v[48:51]
    ds_read_b128 v[152:155], v14 offset:20480
    v_mfma_f32_16x16x32_bf16 v[52:55], v[156:159], a[124:127], v[52:55]
    buffer_load_dwordx4 a[156:159], v2, s[4:7], s81 offen offset:3072 sc1
    v_mfma_f32_16x16x32_bf16 v[56:59], v[184:187], a[120:123], v[56:59]
    ds_read_b128 v[156:159], v14 offset:21504
    v_mfma_f32_16x16x32_bf16 v[60:63], v[184:187], a[124:127], v[60:63]
    buffer_load_dwordx4 v2, s[4:7], s83 offen offset:2048 sc1 lds
    v_mfma_f32_16x16x32_bf16 v[64:67], v[128:131], a[120:123], v[64:67]
    ds_read_b128 v[184:187], v14 offset:22528
    v_mfma_f32_16x16x32_bf16 v[68:71], v[128:131], a[124:127], v[68:71]
    v_mfma_f32_16x16x32_bf16 v[72:75], v[132:135], a[120:123], v[72:75]
    ds_read_b128 v[128:131], v14 offset:23552
    v_mfma_f32_16x16x32_bf16 v[76:79], v[132:135], a[124:127], v[76:79]
    s_waitcnt vmcnt(15) lgkmcnt(4)
    v_mfma_f32_16x16x32_bf16 v[16:19], v[136:139], a[128:131], v[16:19]
    ds_read_b128 v[132:135], v14 offset:24576
    v_mfma_f32_16x16x32_bf16 v[20:23], v[136:139], a[132:135], v[20:23]
    v_mfma_f32_16x16x32_bf16 v[24:27], v[140:143], a[128:131], v[24:27]
    ds_read_b128 v[136:139], v14 offset:25600
    v_mfma_f32_16x16x32_bf16 v[28:31], v[140:143], a[132:135], v[28:31]
    v_mfma_f32_16x16x32_bf16 v[32:35], v[144:147], a[128:131], v[32:35]
    ds_read_b128 v[140:143], v14 offset:26624
    v_mfma_f32_16x16x32_bf16 v[36:39], v[144:147], a[132:135], v[36:39]
    v_mfma_f32_16x16x32_bf16 v[40:43], v[148:151], a[128:131], v[40:43]
    ds_read_b128 v[144:147], v14 offset:27648
    v_mfma_f32_16x16x32_bf16 v[44:47], v[148:151], a[132:135], v[44:47]
    s_waitcnt lgkmcnt(4)
    v_mfma_f32_16x16x32_bf16 v[48:51], v[152:155], a[128:131], v[48:51]
    ds_read_b128 v[148:151], v14 offset:28672
    v_mfma_f32_16x16x32_bf16 v[52:55], v[152:155], a[132:135], v[52:55]
    v_mfma_f32_16x16x32_bf16 v[56:59], v[156:159], a[128:131], v[56:59]
    ds_read_b128 v[152:155], v14 offset:29696
    v_mfma_f32_16x16x32_bf16 v[60:63], v[156:159], a[132:135], v[60:63]
    v_mfma_f32_16x16x32_bf16 v[64:67], v[184:187], a[128:131], v[64:67]
    ds_read_b128 v[156:159], v14 offset:30720
    v_mfma_f32_16x16x32_bf16 v[68:71], v[184:187], a[132:135], v[68:71]
    v_mfma_f32_16x16x32_bf16 v[72:75], v[128:131], a[128:131], v[72:75]
    ds_read_b128 v[184:187], v14 offset:31744
    v_mfma_f32_16x16x32_bf16 v[76:79], v[128:131], a[132:135], v[76:79]
    s_waitcnt vmcnt(10)
    s_barrier
    s_waitcnt lgkmcnt(4)
    v_mfma_f32_16x16x32_bf16 v[16:19], v[132:135], a[136:139], v[16:19]
    ds_read_b128 v[128:131], v2
    s_add_u32 s83, s87, 720896
    v_mfma_f32_16x16x32_bf16 v[20:23], v[132:135], a[140:143], v[20:23]
    s_add_u32 m0, s95, 86016
    v_mfma_f32_16x16x32_bf16 v[24:27], v[136:139], a[136:139], v[24:27]
    ds_read_b128 v[132:135], v2 offset:1024
    v_mfma_f32_16x16x32_bf16 v[28:31], v[136:139], a[140:143], v[28:31]
    buffer_load_dwordx4 v2, s[4:7], s83 offen sc1 lds
    v_mfma_f32_16x16x32_bf16 v[32:35], v[140:143], a[136:139], v[32:35]
    ds_read_b128 v[136:139], v2 offset:2048
    v_mfma_f32_16x16x32_bf16 v[36:39], v[140:143], a[140:143], v[36:39]
    v_mfma_f32_16x16x32_bf16 v[40:43], v[144:147], a[136:139], v[40:43]
    ds_read_b128 v[140:143], v2 offset:3072
    v_mfma_f32_16x16x32_bf16 v[44:47], v[144:147], a[140:143], v[44:47]
    s_waitcnt lgkmcnt(4)
    v_mfma_f32_16x16x32_bf16 v[48:51], v[148:151], a[136:139], v[48:51]
    ds_read_b128 v[144:147], v2 offset:4096
    v_mfma_f32_16x16x32_bf16 v[52:55], v[148:151], a[140:143], v[52:55]
    buffer_load_dwordx4 v2, s[4:7], s83 offen offset:1024 sc1 lds
    v_mfma_f32_16x16x32_bf16 v[56:59], v[152:155], a[136:139], v[56:59]
    ds_read_b128 v[148:151], v2 offset:5120
    v_mfma_f32_16x16x32_bf16 v[60:63], v[152:155], a[140:143], v[60:63]
    v_mfma_f32_16x16x32_bf16 v[64:67], v[156:159], a[136:139], v[64:67]
    ds_read_b128 v[152:155], v2 offset:6144
    v_mfma_f32_16x16x32_bf16 v[68:71], v[156:159], a[140:143], v[68:71]
    buffer_load_dwordx4 v2, s[4:7], s83 offen offset:2048 sc1 lds
    v_mfma_f32_16x16x32_bf16 v[72:75], v[184:187], a[136:139], v[72:75]
    ds_read_b128 v[156:159], v2 offset:7168
    v_mfma_f32_16x16x32_bf16 v[76:79], v[184:187], a[140:143], v[76:79]
    s_waitcnt vmcnt(9) lgkmcnt(4)
    v_mfma_f32_16x16x32_bf16 v[16:19], v[128:131], a[144:147], v[16:19]
    ds_read_b128 v[184:187], v2 offset:8192
    v_mfma_f32_16x16x32_bf16 v[20:23], v[128:131], a[148:151], v[20:23]
    v_mfma_f32_16x16x32_bf16 v[24:27], v[132:135], a[144:147], v[24:27]
    ds_read_b128 v[128:131], v2 offset:9216
    s_add_u32 s83, s87, 901120
    v_mfma_f32_16x16x32_bf16 v[28:31], v[132:135], a[148:151], v[28:31]
    s_add_u32 m0, s95, 98304
    v_mfma_f32_16x16x32_bf16 v[32:35], v[136:139], a[144:147], v[32:35]
    ds_read_b128 v[132:135], v2 offset:10240
    v_mfma_f32_16x16x32_bf16 v[36:39], v[136:139], a[148:151], v[36:39]
    buffer_load_dwordx4 v2, s[4:7], s83 offen sc1 lds
    v_mfma_f32_16x16x32_bf16 v[40:43], v[140:143], a[144:147], v[40:43]
    ds_read_b128 v[136:139], v2 offset:11264
    v_mfma_f32_16x16x32_bf16 v[44:47], v[140:143], a[148:151], v[44:47]
    s_waitcnt lgkmcnt(4)
    v_mfma_f32_16x16x32_bf16 v[48:51], v[144:147], a[144:147], v[48:51]
    ds_read_b128 v[140:143], v2 offset:12288
    v_mfma_f32_16x16x32_bf16 v[52:55], v[144:147], a[148:151], v[52:55]
    buffer_load_dwordx4 v2, s[4:7], s83 offen offset:1024 sc1 lds
    v_mfma_f32_16x16x32_bf16 v[56:59], v[148:151], a[144:147], v[56:59]
    ds_read_b128 v[144:147], v2 offset:13312
    v_mfma_f32_16x16x32_bf16 v[60:63], v[148:151], a[148:151], v[60:63]
    v_mfma_f32_16x16x32_bf16 v[64:67], v[152:155], a[144:147], v[64:67]
    ds_read_b128 v[148:151], v2 offset:14336
    v_mfma_f32_16x16x32_bf16 v[68:71], v[152:155], a[148:151], v[68:71]
    v_mfma_f32_16x16x32_bf16 v[72:75], v[156:159], a[144:147], v[72:75]
    ds_read_b128 v[152:155], v2 offset:15360
    v_mfma_f32_16x16x32_bf16 v[76:79], v[156:159], a[148:151], v[76:79]
    s_waitcnt vmcnt(6) lgkmcnt(4)
    v_mfma_f32_16x16x32_bf16 v[16:19], v[184:187], a[152:155], v[16:19]
    buffer_load_dwordx4 v2, s[4:7], s83 offen offset:2048 sc1 lds
    v_mfma_f32_16x16x32_bf16 v[20:23], v[184:187], a[156:159], v[20:23]
    v_mfma_f32_16x16x32_bf16 v[24:27], v[128:131], a[152:155], v[24:27]
    v_mfma_f32_16x16x32_bf16 v[28:31], v[128:131], a[156:159], v[28:31]
    v_mfma_f32_16x16x32_bf16 v[32:35], v[132:135], a[152:155], v[32:35]
    s_add_u32 s84, s84, 4096
    v_mfma_f32_16x16x32_bf16 v[36:39], v[132:135], a[156:159], v[36:39]
    buffer_load_dwordx4 a[240:243], v2, s[4:7], s84 offen sc1
    v_mfma_f32_16x16x32_bf16 v[40:43], v[136:139], a[152:155], v[40:43]
    v_mfma_f32_16x16x32_bf16 v[44:47], v[136:139], a[156:159], v[44:47]
    s_waitcnt lgkmcnt(0)
    v_mfma_f32_16x16x32_bf16 v[48:51], v[140:143], a[152:155], v[48:51]
    v_mfma_f32_16x16x32_bf16 v[52:55], v[140:143], a[156:159], v[52:55]
    v_mfma_f32_16x16x32_bf16 v[56:59], v[144:147], a[152:155], v[56:59]
    buffer_load_dwordx4 a[244:247], v2, s[4:7], s84 offen offset:1024 sc1
    v_mfma_f32_16x16x32_bf16 v[60:63], v[144:147], a[156:159], v[60:63]
    v_mfma_f32_16x16x32_bf16 v[64:67], v[148:151], a[152:155], v[64:67]
    v_mfma_f32_16x16x32_bf16 v[68:71], v[148:151], a[156:159], v[68:71]
    v_mfma_f32_16x16x32_bf16 v[72:75], v[152:155], a[152:155], v[72:75]
    v_mfma_f32_16x16x32_bf16 v[76:79], v[152:155], a[156:159], v[76:79]
    buffer_load_dwordx4 a[248:251], v2, s[4:7], s84 offen offset:2048 sc1
    buffer_load_dwordx4 a[252:255], v2, s[4:7], s84 offen offset:3072 sc1
    s_add_u32 s84, s84, 4096
    buffer_load_dwordx4 v[200:203], v2, s[4:7], s84 offen sc1
    buffer_load_dwordx4 v[204:207], v2, s[4:7], s84 offen offset:1024 sc1
    buffer_load_dwordx4 v[208:211], v2, s[4:7], s84 offen offset:2048 sc1
    buffer_load_dwordx4 v[212:215], v2, s[4:7], s84 offen offset:3072 sc1
    ds_read_b128 v[128:131], v179
    ds_read_b128 v[132:135], v179 offset:64
    ds_read_b128 v[136:139], v179 offset:128
    ds_read_b128 v[140:143], v179 offset:192
    ds_read_b128 v[144:147], v179 offset:256
    ds_read_b128 v[148:151], v179 offset:320
    ds_read_b128 v[152:155], v179 offset:384
    ds_read_b128 v[156:159], v179 offset:448
    s_waitcnt lgkmcnt(4)
    v_pk_fma_f32 v[160:161], v[128:129], v[188:189], v[132:133] op_sel:[0,1,0] op_sel_hi:[1,1,1]
    v_pk_fma_f32 v[162:163], v[130:131], v[188:189], v[134:135] op_sel:[0,1,0] op_sel_hi:[1,1,1]
    v_pk_fma_f32 v[164:165], v[128:129], v[190:191], v[132:133] op_sel:[0,1,0] op_sel_hi:[1,1,1]
    v_pk_fma_f32 v[166:167], v[130:131], v[190:191], v[134:135] op_sel:[0,1,0] op_sel_hi:[1,1,1]
    v_pk_fma_f32 v[16:17], v[16:17], v[188:189], v[160:161] op_sel_hi:[1,0,1]
    v_pk_fma_f32 v[18:19], v[18:19], v[188:189], v[162:163] op_sel_hi:[1,0,1]
    v_pk_fma_f32 v[20:21], v[20:21], v[190:191], v[164:165] op_sel_hi:[1,0,1]
    v_pk_fma_f32 v[22:23], v[22:23], v[190:191], v[166:167] op_sel_hi:[1,0,1]
    v_pk_fma_f32 v[160:161], v[136:137], v[188:189], v[140:141] op_sel:[0,1,0] op_sel_hi:[1,1,1]
    v_pk_fma_f32 v[162:163], v[138:139], v[188:189], v[142:143] op_sel:[0,1,0] op_sel_hi:[1,1,1]
    s_add_u32 s83, s87, 1081344
    s_add_u32 m0, s95, 110592
    s_nop 0
    buffer_load_dwordx4 v2, s[4:7], s83 offen sc1 lds
    v_pk_fma_f32 v[164:165], v[136:137], v[190:191], v[140:141] op_sel:[0,1,0] op_sel_hi:[1,1,1]
    v_pk_fma_f32 v[166:167], v[138:139], v[190:191], v[142:143] op_sel:[0,1,0] op_sel_hi:[1,1,1]
    v_pk_fma_f32 v[24:25], v[24:25], v[188:189], v[160:161] op_sel_hi:[1,0,1]
    v_pk_fma_f32 v[26:27], v[26:27], v[188:189], v[162:163] op_sel_hi:[1,0,1]
    v_pk_fma_f32 v[28:29], v[28:29], v[190:191], v[164:165] op_sel_hi:[1,0,1]
    v_pk_fma_f32 v[30:31], v[30:31], v[190:191], v[166:167] op_sel_hi:[1,0,1]
    v_pk_mul_f32 v[160:161], v[16:17], s[62:63] neg_lo:[1,0] neg_hi:[1,0]
    v_pk_mul_f32 v[162:163], v[18:19], s[62:63] neg_lo:[1,0] neg_hi:[1,0]
    v_pk_mul_f32 v[164:165], v[20:21], s[62:63] neg_lo:[1,0] neg_hi:[1,0]
    v_pk_mul_f32 v[166:167], v[22:23], s[62:63] neg_lo:[1,0] neg_hi:[1,0]
    v_exp_f32 v160, v160
    v_exp_f32 v161, v161
    v_exp_f32 v162, v162
    buffer_load_dwordx4 v2, s[4:7], s83 offen offset:1024 sc1 lds
    v_exp_f32 v163, v163
    v_exp_f32 v164, v164
    v_exp_f32 v165, v165
    v_exp_f32 v166, v166
    v_exp_f32 v167, v167
    v_pk_add_f32 v[160:161], v[160:161], 1.0 op_sel_hi:[1,0]
    v_pk_add_f32 v[162:163], v[162:163], 1.0 op_sel_hi:[1,0]
    v_pk_add_f32 v[164:165], v[164:165], 1.0 op_sel_hi:[1,0]
    v_pk_add_f32 v[166:167], v[166:167], 1.0 op_sel_hi:[1,0]
    v_rcp_f32 v160, v160
    v_rcp_f32 v161, v161
    v_rcp_f32 v162, v162
    v_rcp_f32 v163, v163
    buffer_load_dwordx4 v2, s[4:7], s83 offen offset:2048 sc1 lds
    v_rcp_f32 v164, v164
    v_rcp_f32 v165, v165
    v_rcp_f32 v166, v166
    v_rcp_f32 v167, v167
    v_pk_mul_f32 v[16:17], v[16:17], v[160:161]
    v_pk_mul_f32 v[18:19], v[18:19], v[162:163]
    v_pk_mul_f32 v[20:21], v[20:21], v[164:165]
    v_pk_mul_f32 v[22:23], v[22:23], v[166:167]
    v_pk_mul_f32 v[16:17], v[16:17], v[24:25]
    v_pk_mul_f32 v[18:19], v[18:19], v[26:27]
    v_pk_mul_f32 v[20:21], v[20:21], v[28:29]
    v_pk_mul_f32 v[22:23], v[22:23], v[30:31]
    v_cvt_pk_bf16_f32 v168, v16, v17
    s_add_u32 s83, s87, 1261568
    s_add_u32 m0, s95, 122880
    s_nop 0
    buffer_load_dwordx4 v2, s[4:7], s83 offen sc1 lds
    v_cvt_pk_bf16_f32 v169, v18, v19
    v_cvt_pk_bf16_f32 v170, v20, v21
    v_cvt_pk_bf16_f32 v171, v22, v23
    s_nop 0
    v_permlane16_swap_b32 v168, v170
    v_permlane16_swap_b32 v169, v171
    buffer_store_dwordx4 v[168:171], v176, s[4:7], s90 offen sc1
    ds_read_b128 v[128:131], v179 offset:512
    ds_read_b128 v[132:135], v179 offset:576
    ds_read_b128 v[136:139], v179 offset:640
    ds_read_b128 v[140:143], v179 offset:704
    s_waitcnt lgkmcnt(4)
    v_pk_fma_f32 v[160:161], v[144:145], v[188:189], v[148:149] op_sel:[0,1,0] op_sel_hi:[1,1,1]
    v_pk_fma_f32 v[162:163], v[146:147], v[188:189], v[150:151] op_sel:[0,1,0] op_sel_hi:[1,1,1]
    v_pk_fma_f32 v[164:165], v[144:145], v[190:191], v[148:149] op_sel:[0,1,0] op_sel_hi:[1,1,1]
    v_pk_fma_f32 v[166:167], v[146:147], v[190:191], v[150:151] op_sel:[0,1,0] op_sel_hi:[1,1,1]
    buffer_load_dwordx4 v2, s[4:7], s83 offen offset:1024 sc1 lds
    v_pk_fma_f32 v[32:33], v[32:33], v[188:189], v[160:161] op_sel_hi:[1,0,1]
    v_pk_fma_f32 v[34:35], v[34:35], v[188:189], v[162:163] op_sel_hi:[1,0,1]
    v_pk_fma_f32 v[36:37], v[36:37], v[190:191], v[164:165] op_sel_hi:[1,0,1]
    v_pk_fma_f32 v[38:39], v[38:39], v[190:191], v[166:167] op_sel_hi:[1,0,1]
    v_pk_fma_f32 v[160:161], v[152:153], v[188:189], v[156:157] op_sel:[0,1,0] op_sel_hi:[1,1,1]
    v_pk_fma_f32 v[162:163], v[154:155], v[188:189], v[158:159] op_sel:[0,1,0] op_sel_hi:[1,1,1]
    v_pk_fma_f32 v[164:165], v[152:153], v[190:191], v[156:157] op_sel:[0,1,0] op_sel_hi:[1,1,1]
    v_pk_fma_f32 v[166:167], v[154:155], v[190:191], v[158:159] op_sel:[0,1,0] op_sel_hi:[1,1,1]
    v_pk_fma_f32 v[40:41], v[40:41], v[188:189], v[160:161] op_sel_hi:[1,0,1]
    v_pk_fma_f32 v[42:43], v[42:43], v[188:189], v[162:163] op_sel_hi:[1,0,1]
    v_pk_fma_f32 v[44:45], v[44:45], v[190:191], v[164:165] op_sel_hi:[1,0,1]
    v_pk_fma_f32 v[46:47], v[46:47], v[190:191], v[166:167] op_sel_hi:[1,0,1]
    v_pk_mul_f32 v[160:161], v[32:33], s[62:63] neg_lo:[1,0] neg_hi:[1,0]
    buffer_load_dwordx4 v2, s[4:7], s83 offen offset:2048 sc1 lds
    v_pk_mul_f32 v[162:163], v[34:35], s[62:63] neg_lo:[1,0] neg_hi:[1,0]
    v_pk_mul_f32 v[164:165], v[36:37], s[62:63] neg_lo:[1,0] neg_hi:[1,0]
    v_pk_mul_f32 v[166:167], v[38:39], s[62:63] neg_lo:[1,0] neg_hi:[1,0]
    v_exp_f32 v160, v160
    v_exp_f32 v161, v161
    v_exp_f32 v162, v162
    v_exp_f32 v163, v163
    v_exp_f32 v164, v164
    v_exp_f32 v165, v165
    v_exp_f32 v166, v166
    v_exp_f32 v167, v167
    v_pk_add_f32 v[160:161], v[160:161], 1.0 op_sel_hi:[1,0]
    v_pk_add_f32 v[162:163], v[162:163], 1.0 op_sel_hi:[1,0]
    s_add_u32 s83, s87, 1441792
    s_add_u32 m0, s95, 135168
    s_nop 0
    buffer_load_dwordx4 v2, s[4:7], s83 offen sc1 lds
    v_pk_add_f32 v[164:165], v[164:165], 1.0 op_sel_hi:[1,0]
    v_pk_add_f32 v[166:167], v[166:167], 1.0 op_sel_hi:[1,0]
    v_rcp_f32 v160, v160
    v_rcp_f32 v161, v161
    v_rcp_f32 v162, v162
    v_rcp_f32 v163, v163
    v_rcp_f32 v164, v164
    v_rcp_f32 v165, v165
    v_rcp_f32 v166, v166
    v_rcp_f32 v167, v167
    v_pk_mul_f32 v[32:33], v[32:33], v[160:161]
    v_pk_mul_f32 v[34:35], v[34:35], v[162:163]
    v_pk_mul_f32 v[36:37], v[36:37], v[164:165]
    buffer_load_dwordx4 v2, s[4:7], s83 offen offset:1024 sc1 lds
    v_pk_mul_f32 v[38:39], v[38:39], v[166:167]
    v_pk_mul_f32 v[32:33], v[32:33], v[40:41]
    v_pk_mul_f32 v[34:35], v[34:35], v[42:43]
    v_pk_mul_f32 v[36:37], v[36:37], v[44:45]
    v_pk_mul_f32 v[38:39], v[38:39], v[46:47]
    v_cvt_pk_bf16_f32 v172, v32, v33
    v_cvt_pk_bf16_f32 v173, v34, v35
    v_cvt_pk_bf16_f32 v174, v36, v37
    v_cvt_pk_bf16_f32 v175, v38, v39
    s_nop 0
    v_permlane16_swap_b32 v172, v174
    v_permlane16_swap_b32 v173, v175
    buffer_store_dwordx4 v[172:175], v176, s[4:7], s90 offen offset:512 sc1
    buffer_load_dwordx4 v2, s[4:7], s83 offen offset:2048 sc1 lds
    ds_read_b128 v[144:147], v179 offset:768
    ds_read_b128 v[148:151], v179 offset:832
    ds_read_b128 v[152:155], v179 offset:896
    ds_read_b128 v[156:159], v179 offset:960
    s_waitcnt lgkmcnt(4)
    v_pk_fma_f32 v[160:161], v[128:129], v[188:189], v[132:133] op_sel:[0,1,0] op_sel_hi:[1,1,1]
    v_pk_fma_f32 v[162:163], v[130:131], v[188:189], v[134:135] op_sel:[0,1,0] op_sel_hi:[1,1,1]
    v_pk_fma_f32 v[164:165], v[128:129], v[190:191], v[132:133] op_sel:[0,1,0] op_sel_hi:[1,1,1]
    v_pk_fma_f32 v[166:167], v[130:131], v[190:191], v[134:135] op_sel:[0,1,0] op_sel_hi:[1,1,1]
    v_pk_fma_f32 v[48:49], v[48:49], v[188:189], v[160:161] op_sel_hi:[1,0,1]
    v_pk_fma_f32 v[50:51], v[50:51], v[188:189], v[162:163] op_sel_hi:[1,0,1]
    v_pk_fma_f32 v[52:53], v[52:53], v[190:191], v[164:165] op_sel_hi:[1,0,1]
    v_pk_fma_f32 v[54:55], v[54:55], v[190:191], v[166:167] op_sel_hi:[1,0,1]
    v_pk_fma_f32 v[160:161], v[136:137], v[188:189], v[140:141] op_sel:[0,1,0] op_sel_hi:[1,1,1]
    v_pk_fma_f32 v[162:163], v[138:139], v[188:189], v[142:143] op_sel:[0,1,0] op_sel_hi:[1,1,1]
    v_pk_fma_f32 v[164:165], v[136:137], v[190:191], v[140:141] op_sel:[0,1,0] op_sel_hi:[1,1,1]
    v_pk_fma_f32 v[166:167], v[138:139], v[190:191], v[142:143] op_sel:[0,1,0] op_sel_hi:[1,1,1]
    v_pk_fma_f32 v[56:57], v[56:57], v[188:189], v[160:161] op_sel_hi:[1,0,1]
    v_pk_fma_f32 v[58:59], v[58:59], v[188:189], v[162:163] op_sel_hi:[1,0,1]
    v_pk_fma_f32 v[60:61], v[60:61], v[190:191], v[164:165] op_sel_hi:[1,0,1]
    v_pk_fma_f32 v[62:63], v[62:63], v[190:191], v[166:167] op_sel_hi:[1,0,1]
    v_pk_mul_f32 v[160:161], v[48:49], s[62:63] neg_lo:[1,0] neg_hi:[1,0]
    v_pk_mul_f32 v[162:163], v[50:51], s[62:63] neg_lo:[1,0] neg_hi:[1,0]
    v_pk_mul_f32 v[164:165], v[52:53], s[62:63] neg_lo:[1,0] neg_hi:[1,0]
    v_pk_mul_f32 v[166:167], v[54:55], s[62:63] neg_lo:[1,0] neg_hi:[1,0]
    v_exp_f32 v160, v160
    v_exp_f32 v161, v161
    v_exp_f32 v162, v162
    v_exp_f32 v163, v163
    v_exp_f32 v164, v164
    v_exp_f32 v165, v165
    v_exp_f32 v166, v166
    v_exp_f32 v167, v167
    v_pk_add_f32 v[160:161], v[160:161], 1.0 op_sel_hi:[1,0]
    v_pk_add_f32 v[162:163], v[162:163], 1.0 op_sel_hi:[1,0]
    v_pk_add_f32 v[164:165], v[164:165], 1.0 op_sel_hi:[1,0]
    v_pk_add_f32 v[166:167], v[166:167], 1.0 op_sel_hi:[1,0]
    v_rcp_f32 v160, v160
    v_rcp_f32 v161, v161
    v_rcp_f32 v162, v162
    v_rcp_f32 v163, v163
    v_rcp_f32 v164, v164
    v_rcp_f32 v165, v165
    v_rcp_f32 v166, v166
    v_rcp_f32 v167, v167
    v_pk_mul_f32 v[48:49], v[48:49], v[160:161]
    v_pk_mul_f32 v[50:51], v[50:51], v[162:163]
    v_pk_mul_f32 v[52:53], v[52:53], v[164:165]
    v_pk_mul_f32 v[54:55], v[54:55], v[166:167]
    v_pk_mul_f32 v[48:49], v[48:49], v[56:57]
    v_pk_mul_f32 v[50:51], v[50:51], v[58:59]
    v_pk_mul_f32 v[52:53], v[52:53], v[60:61]
    v_pk_mul_f32 v[54:55], v[54:55], v[62:63]
    v_cvt_pk_bf16_f32 v168, v48, v49
    v_cvt_pk_bf16_f32 v169, v50, v51
    v_cvt_pk_bf16_f32 v170, v52, v53
    v_cvt_pk_bf16_f32 v171, v54, v55
    s_nop 0
    v_permlane16_swap_b32 v168, v170
    v_permlane16_swap_b32 v169, v171
    buffer_store_dwordx4 v[168:171], v176, s[4:7], s90 offen offset:1024 sc1
    s_waitcnt lgkmcnt(0)
    v_pk_fma_f32 v[160:161], v[144:145], v[188:189], v[148:149] op_sel:[0,1,0] op_sel_hi:[1,1,1]
    v_pk_fma_f32 v[162:163], v[146:147], v[188:189], v[150:151] op_sel:[0,1,0] op_sel_hi:[1,1,1]
    v_pk_fma_f32 v[164:165], v[144:145], v[190:191], v[148:149] op_sel:[0,1,0] op_sel_hi:[1,1,1]
    v_pk_fma_f32 v[166:167], v[146:147], v[190:191], v[150:151] op_sel:[0,1,0] op_sel_hi:[1,1,1]
    v_pk_fma_f32 v[64:65], v[64:65], v[188:189], v[160:161] op_sel_hi:[1,0,1]
    v_pk_fma_f32 v[66:67], v[66:67], v[188:189], v[162:163] op_sel_hi:[1,0,1]
    v_pk_fma_f32 v[68:69], v[68:69], v[190:191], v[164:165] op_sel_hi:[1,0,1]
    v_pk_fma_f32 v[70:71], v[70:71], v[190:191], v[166:167] op_sel_hi:[1,0,1]
    v_pk_fma_f32 v[160:161], v[152:153], v[188:189], v[156:157] op_sel:[0,1,0] op_sel_hi:[1,1,1]
    v_pk_fma_f32 v[162:163], v[154:155], v[188:189], v[158:159] op_sel:[0,1,0] op_sel_hi:[1,1,1]
    v_pk_fma_f32 v[164:165], v[152:153], v[190:191], v[156:157] op_sel:[0,1,0] op_sel_hi:[1,1,1]
    v_pk_fma_f32 v[166:167], v[154:155], v[190:191], v[158:159] op_sel:[0,1,0] op_sel_hi:[1,1,1]
    v_pk_fma_f32 v[72:73], v[72:73], v[188:189], v[160:161] op_sel_hi:[1,0,1]
    v_pk_fma_f32 v[74:75], v[74:75], v[188:189], v[162:163] op_sel_hi:[1,0,1]
    v_pk_fma_f32 v[76:77], v[76:77], v[190:191], v[164:165] op_sel_hi:[1,0,1]
    v_pk_fma_f32 v[78:79], v[78:79], v[190:191], v[166:167] op_sel_hi:[1,0,1]
    v_pk_mul_f32 v[160:161], v[64:65], s[62:63] neg_lo:[1,0] neg_hi:[1,0]
    v_pk_mul_f32 v[162:163], v[66:67], s[62:63] neg_lo:[1,0] neg_hi:[1,0]
    v_pk_mul_f32 v[164:165], v[68:69], s[62:63] neg_lo:[1,0] neg_hi:[1,0]
    v_pk_mul_f32 v[166:167], v[70:71], s[62:63] neg_lo:[1,0] neg_hi:[1,0]
    v_exp_f32 v160, v160
    v_exp_f32 v161, v161
    v_exp_f32 v162, v162
    v_exp_f32 v163, v163
    v_exp_f32 v164, v164
    v_exp_f32 v165, v165
    v_exp_f32 v166, v166
    v_exp_f32 v167, v167
    v_pk_add_f32 v[160:161], v[160:161], 1.0 op_sel_hi:[1,0]
    v_pk_add_f32 v[162:163], v[162:163], 1.0 op_sel_hi:[1,0]
    v_pk_add_f32 v[164:165], v[164:165], 1.0 op_sel_hi:[1,0]
    v_pk_add_f32 v[166:167], v[166:167], 1.0 op_sel_hi:[1,0]
    v_rcp_f32 v160, v160
    v_rcp_f32 v161, v161
    v_rcp_f32 v162, v162
    v_rcp_f32 v163, v163
    v_rcp_f32 v164, v164
    v_rcp_f32 v165, v165
    v_rcp_f32 v166, v166
    v_rcp_f32 v167, v167
    v_pk_mul_f32 v[64:65], v[64:65], v[160:161]
    v_pk_mul_f32 v[66:67], v[66:67], v[162:163]
    v_pk_mul_f32 v[68:69], v[68:69], v[164:165]
    v_pk_mul_f32 v[70:71], v[70:71], v[166:167]
    v_pk_mul_f32 v[64:65], v[64:65], v[72:73]
    v_pk_mul_f32 v[66:67], v[66:67], v[74:75]
    v_pk_mul_f32 v[68:69], v[68:69], v[76:77]
    v_pk_mul_f32 v[70:71], v[70:71], v[78:79]
    v_cvt_pk_bf16_f32 v172, v64, v65
    v_cvt_pk_bf16_f32 v173, v66, v67
    v_cvt_pk_bf16_f32 v174, v68, v69
    v_cvt_pk_bf16_f32 v175, v70, v71
    s_nop 0
    v_permlane16_swap_b32 v172, v174
    v_permlane16_swap_b32 v173, v175
    buffer_store_dwordx4 v[172:175], v176, s[4:7], s90 offen offset:1536 sc1
    s_add_u32 s90, s90, 2048
    s_waitcnt vmcnt(21)
    s_barrier
    ds_read_b128 v[128:131], v2 offset:24576
    ds_read_b128 v[132:135], v2 offset:25600
    ds_read_b128 v[136:139], v2 offset:26624
    ds_read_b128 v[140:143], v2 offset:27648
    ds_read_b128 v[144:147], v2 offset:28672
    ds_read_b128 v[148:151], v2 offset:29696
    s_waitcnt lgkmcnt(3)
    v_mfma_f32_16x16x32_bf16 v[80:83], v[128:131], a[0:3], 0
    ds_read_b128 v[152:155], v2 offset:30720
    v_mfma_f32_16x16x32_bf16 v[84:87], v[128:131], a[4:7], 0
    s_add_u32 s83, s87, 1622016
    s_add_u32 m0, s95, 147456
    v_mfma_f32_16x16x32_bf16 v[88:91], v[132:135], a[0:3], 0
    ds_read_b128 v[156:159], v2 offset:31744
    v_mfma_f32_16x16x32_bf16 v[92:95], v[132:135], a[4:7], 0
    buffer_load_dwordx4 v2, s[4:7], s83 offen sc1 lds
    v_mfma_f32_16x16x32_bf16 v[96:99], v[136:139], a[0:3], 0
    ds_read_b128 v[184:187], v2 offset:32768
    v_mfma_f32_16x16x32_bf16 v[100:103], v[136:139], a[4:7], 0
    s_waitcnt lgkmcnt(3)
    v_mfma_f32_16x16x32_bf16 v[104:107], v[140:143], a[0:3], 0
    ds_read_b128 v[128:131], v2 offset:33792
    v_mfma_f32_16x16x32_bf16 v[108:111], v[140:143], a[4:7], 0
    buffer_load_dwordx4 v2, s[4:7], s83 offen offset:1024 sc1 lds
    v_mfma_f32_16x16x32_bf16 v[112:115], v[144:147], a[0:3], 0
    ds_read_b128 v[132:135], v2 offset:34816
    v_mfma_f32_16x16x32_bf16 v[116:119], v[144:147], a[4:7], 0
    v_mfma_f32_16x16x32_bf16 v[120:123], v[148:151], a[0:3], 0
    ds_read_b128 v[136:139], v2 offset:35840
    v_mfma_f32_16x16x32_bf16 v[124:127], v[148:151], a[4:7], 0
    s_waitcnt lgkmcnt(3)
    v_mfma_f32_16x16x32_bf16 v[80:83], v[152:155], a[8:11], v[80:83]
    ds_read_b128 v[140:143], v2 offset:36864
    v_mfma_f32_16x16x32_bf16 v[84:87], v[152:155], a[12:15], v[84:87]
    buffer_load_dwordx4 v2, s[4:7], s83 offen offset:2048 sc1 lds
    v_mfma_f32_16x16x32_bf16 v[88:91], v[156:159], a[8:11], v[88:91]
    ds_read_b128 v[144:147], v2 offset:37888
    v_mfma_f32_16x16x32_bf16 v[92:95], v[156:159], a[12:15], v[92:95]
    v_mfma_f32_16x16x32_bf16 v[96:99], v[184:187], a[8:11], v[96:99]
    ds_read_b128 v[148:151], v2 offset:38912
    v_mfma_f32_16x16x32_bf16 v[100:103], v[184:187], a[12:15], v[100:103]
    s_waitcnt lgkmcnt(3)
    v_mfma_f32_16x16x32_bf16 v[104:107], v[128:131], a[8:11], v[104:107]
    ds_read_b128 v[152:155], v2 offset:39936
    v_mfma_f32_16x16x32_bf16 v[108:111], v[128:131], a[12:15], v[108:111]
    s_add_u32 s84, s84, 4096
    v_mfma_f32_16x16x32_bf16 v[112:115], v[132:135], a[8:11], v[112:115]
    ds_read_b128 v[156:159], v2 offset:40960
    v_mfma_f32_16x16x32_bf16 v[116:119], v[132:135], a[12:15], v[116:119]
    buffer_load_dwordx4 v[216:219], v2, s[4:7], s84 offen sc1
    v_mfma_f32_16x16x32_bf16 v[120:123], v[136:139], a[8:11], v[120:123]
    ds_read_b128 v[184:187], v2 offset:41984
    v_mfma_f32_16x16x32_bf16 v[124:127], v[136:139], a[12:15], v[124:127]
    s_waitcnt lgkmcnt(3)
    v_mfma_f32_16x16x32_bf16 v[80:83], v[140:143], a[16:19], v[80:83]
    ds_read_b128 v[128:131], v2 offset:43008
    v_mfma_f32_16x16x32_bf16 v[84:87], v[140:143], a[20:23], v[84:87]
    buffer_load_dwordx4 v[220:223], v2, s[4:7], s84 offen offset:1024 sc1
    v_mfma_f32_16x16x32_bf16 v[88:91], v[144:147], a[16:19], v[88:91]
    ds_read_b128 v[132:135], v2 offset:44032
    v_mfma_f32_16x16x32_bf16 v[92:95], v[144:147], a[20:23], v[92:95]
    v_mfma_f32_16x16x32_bf16 v[96:99], v[148:151], a[16:19], v[96:99]
    ds_read_b128 v[136:139], v2 offset:45056
    v_mfma_f32_16x16x32_bf16 v[100:103], v[148:151], a[20:23], v[100:103]
    s_waitcnt lgkmcnt(3)
    v_mfma_f32_16x16x32_bf16 v[104:107], v[152:155], a[16:19], v[104:107]
    ds_read_b128 v[140:143], v2 offset:46080
    v_mfma_f32_16x16x32_bf16 v[108:111], v[152:155], a[20:23], v[108:111]
    buffer_load_dwordx4 v[224:227], v2, s[4:7], s84 offen offset:2048 sc1
    v_mfma_f32_16x16x32_bf16 v[112:115], v[156:159], a[16:19], v[112:115]
    ds_read_b128 v[144:147], v2 offset:47104
    v_mfma_f32_16x16x32_bf16 v[116:119], v[156:159], a[20:23], v[116:119]
    v_mfma_f32_16x16x32_bf16 v[120:123], v[184:187], a[16:19], v[120:123]
    ds_read_b128 v[148:151], v2 offset:48128
    v_mfma_f32_16x16x32_bf16 v[124:127], v[184:187], a[20:23], v[124:127]
    s_waitcnt lgkmcnt(3)
    v_mfma_f32_16x16x32_bf16 v[80:83], v[128:131], a[24:27], v[80:83]
    ds_read_b128 v[152:155], v3
    v_mfma_f32_16x16x32_bf16 v[84:87], v[128:131], a[28:31], v[84:87]
    buffer_load_dwordx4 v[228:231], v2, s[4:7], s84 offen offset:3072 sc1
    v_mfma_f32_16x16x32_bf16 v[88:91], v[132:135], a[24:27], v[88:91]
    ds_read_b128 v[156:159], v3 offset:1024
    v_mfma_f32_16x16x32_bf16 v[92:95], v[132:135], a[28:31], v[92:95]
    v_mfma_f32_16x16x32_bf16 v[96:99], v[136:139], a[24:27], v[96:99]
    ds_read_b128 v[184:187], v3 offset:2048
    v_mfma_f32_16x16x32_bf16 v[100:103], v[136:139], a[28:31], v[100:103]
    s_waitcnt vmcnt(7)
    v_mov_b32 v177, s40
    s_mov_b64 exec, 1
    buffer_store_dword v177, off, s[4:7], s88 sc1
    s_mov_b64 exec, -1
    s_waitcnt lgkmcnt(3)
    v_mfma_f32_16x16x32_bf16 v[104:107], v[140:143], a[24:27], v[104:107]
    ds_read_b128 v[128:131], v3 offset:3072
    v_mfma_f32_16x16x32_bf16 v[108:111], v[140:143], a[28:31], v[108:111]
    s_add_u32 s84, s84, 4096
    v_mfma_f32_16x16x32_bf16 v[112:115], v[144:147], a[24:27], v[112:115]
    ds_read_b128 v[132:135], v3 offset:4096
    v_mfma_f32_16x16x32_bf16 v[116:119], v[144:147], a[28:31], v[116:119]
    buffer_load_dwordx4 v[232:235], v2, s[4:7], s84 offen sc1
    v_mfma_f32_16x16x32_bf16 v[120:123], v[148:151], a[24:27], v[120:123]
    ds_read_b128 v[136:139], v3 offset:5120
    v_mfma_f32_16x16x32_bf16 v[124:127], v[148:151], a[28:31], v[124:127]
    s_waitcnt lgkmcnt(3)
    v_mfma_f32_16x16x32_bf16 v[80:83], v[152:155], a[32:35], v[80:83]
    ds_read_b128 v[140:143], v3 offset:6144
    v_mfma_f32_16x16x32_bf16 v[84:87], v[152:155], a[36:39], v[84:87]
    buffer_load_dwordx4 v[236:239], v2, s[4:7], s84 offen offset:1024 sc1
    v_mfma_f32_16x16x32_bf16 v[88:91], v[156:159], a[32:35], v[88:91]
    ds_read_b128 v[144:147], v3 offset:7168
    v_mfma_f32_16x16x32_bf16 v[92:95], v[156:159], a[36:39], v[92:95]
    v_mfma_f32_16x16x32_bf16 v[96:99], v[184:187], a[32:35], v[96:99]
    ds_read_b128 v[148:151], v3 offset:8192
    v_mfma_f32_16x16x32_bf16 v[100:103], v[184:187], a[36:39], v[100:103]
    s_waitcnt lgkmcnt(3)
    v_mfma_f32_16x16x32_bf16 v[104:107], v[128:131], a[32:35], v[104:107]
    ds_read_b128 v[152:155], v3 offset:9216
    v_mfma_f32_16x16x32_bf16 v[108:111], v[128:131], a[36:39], v[108:111]
    buffer_load_dwordx4 v[240:243], v2, s[4:7], s84 offen offset:2048 sc1
    v_mfma_f32_16x16x32_bf16 v[112:115], v[132:135], a[32:35], v[112:115]
    ds_read_b128 v[156:159], v3 offset:10240
    v_mfma_f32_16x16x32_bf16 v[116:119], v[132:135], a[36:39], v[116:119]
    v_mfma_f32_16x16x32_bf16 v[120:123], v[136:139], a[32:35], v[120:123]
    ds_read_b128 v[184:187], v3 offset:11264
    v_mfma_f32_16x16x32_bf16 v[124:127], v[136:139], a[36:39], v[124:127]
    s_waitcnt lgkmcnt(3)
    v_mfma_f32_16x16x32_bf16 v[80:83], v[140:143], a[40:43], v[80:83]
    ds_read_b128 v[128:131], v3 offset:12288
    v_mfma_f32_16x16x32_bf16 v[84:87], v[140:143], a[44:47], v[84:87]
    buffer_load_dwordx4 v[244:247], v2, s[4:7], s84 offen offset:3072 sc1
    v_mfma_f32_16x16x32_bf16 v[88:91], v[144:147], a[40:43], v[88:91]
    ds_read_b128 v[132:135], v3 offset:13312
    v_mfma_f32_16x16x32_bf16 v[92:95], v[144:147], a[44:47], v[92:95]
    v_mfma_f32_16x16x32_bf16 v[96:99], v[148:151], a[40:43], v[96:99]
    ds_read_b128 v[136:139], v3 offset:14336
    v_mfma_f32_16x16x32_bf16 v[100:103], v[148:151], a[44:47], v[100:103]
    s_waitcnt lgkmcnt(3)
    v_mfma_f32_16x16x32_bf16 v[104:107], v[152:155], a[40:43], v[104:107]
    ds_read_b128 v[140:143], v3 offset:15360
    v_mfma_f32_16x16x32_bf16 v[108:111], v[152:155], a[44:47], v[108:111]
    s_add_u32 s84, s84, 4096
    v_mfma_f32_16x16x32_bf16 v[112:115], v[156:159], a[40:43], v[112:115]
    ds_read_b128 v[144:147], v3 offset:16384
    v_mfma_f32_16x16x32_bf16 v[116:119], v[156:159], a[44:47], v[116:119]
    buffer_load_dwordx4 v[248:251], v2, s[4:7], s84 offen sc1
    v_mfma_f32_16x16x32_bf16 v[120:123], v[184:187], a[40:43], v[120:123]
    ds_read_b128 v[148:151], v3 offset:17408
    v_mfma_f32_16x16x32_bf16 v[124:127], v[184:187], a[44:47], v[124:127]
    s_waitcnt lgkmcnt(3)
    v_mfma_f32_16x16x32_bf16 v[80:83], v[128:131], a[48:51], v[80:83]
    ds_read_b128 v[152:155], v3 offset:18432
    v_mfma_f32_16x16x32_bf16 v[84:87], v[128:131], a[52:55], v[84:87]
    buffer_load_dwordx4 v[252:255], v2, s[4:7], s84 offen offset:1024 sc1
    v_mfma_f32_16x16x32_bf16 v[88:91], v[132:135], a[48:51], v[88:91]
    ds_read_b128 v[156:159], v3 offset:19456
    v_mfma_f32_16x16x32_bf16 v[92:95], v[132:135], a[52:55], v[92:95]
    v_mfma_f32_16x16x32_bf16 v[96:99], v[136:139], a[48:51], v[96:99]
    ds_read_b128 v[184:187], v3 offset:20480
    v_mfma_f32_16x16x32_bf16 v[100:103], v[136:139], a[52:55], v[100:103]
    s_waitcnt lgkmcnt(3)
    v_mfma_f32_16x16x32_bf16 v[104:107], v[140:143], a[48:51], v[104:107]
    ds_read_b128 v[128:131], v3 offset:21504
    v_mfma_f32_16x16x32_bf16 v[108:111], v[140:143], a[52:55], v[108:111]
    buffer_load_dwordx4 v[192:195], v2, s[4:7], s84 offen offset:2048 sc1
    v_mfma_f32_16x16x32_bf16 v[112:115], v[144:147], a[48:51], v[112:115]
    ds_read_b128 v[132:135], v3 offset:22528
    v_mfma_f32_16x16x32_bf16 v[116:119], v[144:147], a[52:55], v[116:119]
    v_mfma_f32_16x16x32_bf16 v[120:123], v[148:151], a[48:51], v[120:123]
    ds_read_b128 v[136:139], v3 offset:23552
    v_mfma_f32_16x16x32_bf16 v[124:127], v[148:151], a[52:55], v[124:127]
    s_waitcnt lgkmcnt(3)
    v_mfma_f32_16x16x32_bf16 v[80:83], v[152:155], a[56:59], v[80:83]
    ds_read_b128 v[140:143], v3 offset:24576
    v_mfma_f32_16x16x32_bf16 v[84:87], v[152:155], a[60:63], v[84:87]
    buffer_load_dwordx4 v[196:199], v2, s[4:7], s84 offen offset:3072 sc1
    v_mfma_f32_16x16x32_bf16 v[88:91], v[156:159], a[56:59], v[88:91]
    ds_read_b128 v[144:147], v3 offset:25600
    v_mfma_f32_16x16x32_bf16 v[92:95], v[156:159], a[60:63], v[92:95]
    v_mfma_f32_16x16x32_bf16 v[96:99], v[184:187], a[56:59], v[96:99]
    ds_read_b128 v[148:151], v3 offset:26624
    v_mfma_f32_16x16x32_bf16 v[100:103], v[184:187], a[60:63], v[100:103]
    s_waitcnt lgkmcnt(3)
    v_mfma_f32_16x16x32_bf16 v[104:107], v[128:131], a[56:59], v[104:107]
    ds_read_b128 v[152:155], v3 offset:27648
    v_mfma_f32_16x16x32_bf16 v[108:111], v[128:131], a[60:63], v[108:111]
    buffer_load_dwordx4 a[0:3], v2, s[4:7], s85 offen sc1
    v_mfma_f32_16x16x32_bf16 v[112:115], v[132:135], a[56:59], v[112:115]
    ds_read_b128 v[156:159], v3 offset:28672
    v_mfma_f32_16x16x32_bf16 v[116:119], v[132:135], a[60:63], v[116:119]
    v_mfma_f32_16x16x32_bf16 v[120:123], v[136:139], a[56:59], v[120:123]
    ds_read_b128 v[184:187], v3 offset:29696
    v_mfma_f32_16x16x32_bf16 v[124:127], v[136:139], a[60:63], v[124:127]
    s_waitcnt lgkmcnt(3)
    v_mfma_f32_16x16x32_bf16 v[80:83], v[140:143], a[64:67], v[80:83]
    ds_read_b128 v[128:131], v3 offset:30720
    v_mfma_f32_16x16x32_bf16 v[84:87], v[140:143], a[68:71], v[84:87]
    buffer_load_dwordx4 a[4:7], v2, s[4:7], s85 offen offset:1024 sc1
    v_mfma_f32_16x16x32_bf16 v[88:91], v[144:147], a[64:67], v[88:91]
    ds_read_b128 v[132:135], v3 offset:31744
    v_mfma_f32_16x16x32_bf16 v[92:95], v[144:147], a[68:71], v[92:95]
    v_mfma_f32_16x16x32_bf16 v[96:99], v[148:151], a[64:67], v[96:99]
    ds_read_b128 v[136:139], v3 offset:32768
    v_mfma_f32_16x16x32_bf16 v[100:103], v[148:151], a[68:71], v[100:103]
    s_waitcnt lgkmcnt(3)
    v_mfma_f32_16x16x32_bf16 v[104:107], v[152:155], a[64:67], v[104:107]
    ds_read_b128 v[140:143], v3 offset:33792
    v_mfma_f32_16x16x32_bf16 v[108:111], v[152:155], a[68:71], v[108:111]
    buffer_load_dwordx4 a[8:11], v2, s[4:7], s85 offen offset:2048 sc1
    v_mfma_f32_16x16x32_bf16 v[112:115], v[156:159], a[64:67], v[112:115]
    ds_read_b128 v[144:147], v3 offset:34816
    v_mfma_f32_16x16x32_bf16 v[116:119], v[156:159], a[68:71], v[116:119]
    v_mfma_f32_16x16x32_bf16 v[120:123], v[184:187], a[64:67], v[120:123]
    ds_read_b128 v[148:151], v3 offset:35840
    v_mfma_f32_16x16x32_bf16 v[124:127], v[184:187], a[68:71], v[124:127]
    s_waitcnt lgkmcnt(3)
    v_mfma_f32_16x16x32_bf16 v[80:83], v[128:131], a[72:75], v[80:83]
    ds_read_b128 v[152:155], v3 offset:36864
    v_mfma_f32_16x16x32_bf16 v[84:87], v[128:131], a[76:79], v[84:87]
    buffer_load_dwordx4 a[12:15], v2, s[4:7], s85 offen offset:3072 sc1
    v_mfma_f32_16x16x32_bf16 v[88:91], v[132:135], a[72:75], v[88:91]
    ds_read_b128 v[156:159], v3 offset:37888
    v_mfma_f32_16x16x32_bf16 v[92:95], v[132:135], a[76:79], v[92:95]
    v_mfma_f32_16x16x32_bf16 v[96:99], v[136:139], a[72:75], v[96:99]
    ds_read_b128 v[184:187], v3 offset:38912
    v_mfma_f32_16x16x32_bf16 v[100:103], v[136:139], a[76:79], v[100:103]
    s_waitcnt lgkmcnt(3)
    v_mfma_f32_16x16x32_bf16 v[104:107], v[140:143], a[72:75], v[104:107]
    ds_read_b128 v[128:131], v3 offset:39936
    v_mfma_f32_16x16x32_bf16 v[108:111], v[140:143], a[76:79], v[108:111]
    s_add_u32 s85, s85, 4096
    v_mfma_f32_16x16x32_bf16 v[112:115], v[144:147], a[72:75], v[112:115]
    ds_read_b128 v[132:135], v3 offset:40960
    v_mfma_f32_16x16x32_bf16 v[116:119], v[144:147], a[76:79], v[116:119]
    buffer_load_dwordx4 a[16:19], v2, s[4:7], s85 offen sc1
    v_mfma_f32_16x16x32_bf16 v[120:123], v[148:151], a[72:75], v[120:123]
    ds_read_b128 v[136:139], v3 offset:41984
    v_mfma_f32_16x16x32_bf16 v[124:127], v[148:151], a[76:79], v[124:127]
    s_waitcnt lgkmcnt(3)
    v_mfma_f32_16x16x32_bf16 v[80:83], v[152:155], a[80:83], v[80:83]
    ds_read_b128 v[140:143], v3 offset:43008
    v_mfma_f32_16x16x32_bf16 v[84:87], v[152:155], a[84:87], v[84:87]
    buffer_load_dwordx4 a[20:23], v2, s[4:7], s85 offen offset:1024 sc1
    v_mfma_f32_16x16x32_bf16 v[88:91], v[156:159], a[80:83], v[88:91]
    ds_read_b128 v[144:147], v3 offset:44032
    v_mfma_f32_16x16x32_bf16 v[92:95], v[156:159], a[84:87], v[92:95]
    v_mfma_f32_16x16x32_bf16 v[96:99], v[184:187], a[80:83], v[96:99]
    ds_read_b128 v[148:151], v3 offset:45056
    v_mfma_f32_16x16x32_bf16 v[100:103], v[184:187], a[84:87], v[100:103]
    s_waitcnt lgkmcnt(3)
    v_mfma_f32_16x16x32_bf16 v[104:107], v[128:131], a[80:83], v[104:107]
    ds_read_b128 v[152:155], v3 offset:46080
    v_mfma_f32_16x16x32_bf16 v[108:111], v[128:131], a[84:87], v[108:111]
    buffer_load_dwordx4 a[24:27], v2, s[4:7], s85 offen offset:2048 sc1
    v_mfma_f32_16x16x32_bf16 v[112:115], v[132:135], a[80:83], v[112:115]
    ds_read_b128 v[156:159], v3 offset:47104
    v_mfma_f32_16x16x32_bf16 v[116:119], v[132:135], a[84:87], v[116:119]
    v_mfma_f32_16x16x32_bf16 v[120:123], v[136:139], a[80:83], v[120:123]
    ds_read_b128 v[184:187], v3 offset:48128
    v_mfma_f32_16x16x32_bf16 v[124:127], v[136:139], a[84:87], v[124:127]
    s_waitcnt vmcnt(20)
    s_barrier
    s_waitcnt lgkmcnt(3)
    v_mfma_f32_16x16x32_bf16 v[80:83], v[140:143], a[88:91], v[80:83]
    ds_read_b128 v[128:131], v3 offset:49152
    v_mfma_f32_16x16x32_bf16 v[84:87], v[140:143], a[92:95], v[84:87]
    buffer_load_dwordx4 a[28:31], v2, s[4:7], s85 offen offset:3072 sc1
    v_mfma_f32_16x16x32_bf16 v[88:91], v[144:147], a[88:91], v[88:91]
    ds_read_b128 v[132:135], v3 offset:50176
    v_mfma_f32_16x16x32_bf16 v[92:95], v[144:147], a[92:95], v[92:95]
    v_mfma_f32_16x16x32_bf16 v[96:99], v[148:151], a[88:91], v[96:99]
    ds_read_b128 v[136:139], v3 offset:51200
    v_mfma_f32_16x16x32_bf16 v[100:103], v[148:151], a[92:95], v[100:103]
    s_waitcnt lgkmcnt(3)
    v_mfma_f32_16x16x32_bf16 v[104:107], v[152:155], a[88:91], v[104:107]
    ds_read_b128 v[140:143], v3 offset:52224
    v_mfma_f32_16x16x32_bf16 v[108:111], v[152:155], a[92:95], v[108:111]
    s_add_u32 s85, s85, 4096
    v_mfma_f32_16x16x32_bf16 v[112:115], v[156:159], a[88:91], v[112:115]
    ds_read_b128 v[144:147], v3 offset:53248
    v_mfma_f32_16x16x32_bf16 v[116:119], v[156:159], a[92:95], v[116:119]
    buffer_load_dwordx4 a[32:35], v2, s[4:7], s85 offen sc1
    v_mfma_f32_16x16x32_bf16 v[120:123], v[184:187], a[88:91], v[120:123]
    ds_read_b128 v[148:151], v3 offset:54272
    v_mfma_f32_16x16x32_bf16 v[124:127], v[184:187], a[92:95], v[124:127]
    s_waitcnt lgkmcnt(3)
    v_mfma_f32_16x16x32_bf16 v[80:83], v[128:131], a[96:99], v[80:83]
    ds_read_b128 v[152:155], v3 offset:55296
    v_mfma_f32_16x16x32_bf16 v[84:87], v[128:131], a[100:103], v[84:87]
    buffer_load_dwordx4 a[36:39], v2, s[4:7], s85 offen offset:1024 sc1
    v_mfma_f32_16x16x32_bf16 v[88:91], v[132:135], a[96:99], v[88:91]
    ds_read_b128 v[156:159], v3 offset:56320
    v_mfma_f32_16x16x32_bf16 v[92:95], v[132:135], a[100:103], v[92:95]
    v_mfma_f32_16x16x32_bf16 v[96:99], v[136:139], a[96:99], v[96:99]
    ds_read_b128 v[184:187], v3 offset:57344
    v_mfma_f32_16x16x32_bf16 v[100:103], v[136:139], a[100:103], v[100:103]
    s_waitcnt lgkmcnt(3)
    v_mfma_f32_16x16x32_bf16 v[104:107], v[140:143], a[96:99], v[104:107]
    ds_read_b128 v[128:131], v3 offset:58368
    v_mfma_f32_16x16x32_bf16 v[108:111], v[140:143], a[100:103], v[108:111]
    buffer_load_dwordx4 a[40:43], v2, s[4:7], s85 offen offset:2048 sc1
    v_mfma_f32_16x16x32_bf16 v[112:115], v[144:147], a[96:99], v[112:115]
    ds_read_b128 v[132:135], v3 offset:59392
    v_mfma_f32_16x16x32_bf16 v[116:119], v[144:147], a[100:103], v[116:119]
    v_mfma_f32_16x16x32_bf16 v[120:123], v[148:151], a[96:99], v[120:123]
    ds_read_b128 v[136:139], v3 offset:60416
    v_mfma_f32_16x16x32_bf16 v[124:127], v[148:151], a[100:103], v[124:127]
    s_waitcnt lgkmcnt(3)
    v_mfma_f32_16x16x32_bf16 v[80:83], v[152:155], a[104:107], v[80:83]
    ds_read_b128 v[140:143], v3 offset:61440
    v_mfma_f32_16x16x32_bf16 v[84:87], v[152:155], a[108:111], v[84:87]
    buffer_load_dwordx4 a[44:47], v2, s[4:7], s85 offen offset:3072 sc1
    v_mfma_f32_16x16x32_bf16 v[88:91], v[156:159], a[104:107], v[88:91]
    ds_read_b128 v[144:147], v3 offset:62464
    v_mfma_f32_16x16x32_bf16 v[92:95], v[156:159], a[108:111], v[92:95]
    v_mfma_f32_16x16x32_bf16 v[96:99], v[184:187], a[104:107], v[96:99]
    ds_read_b128 v[148:151], v3 offset:63488
    v_mfma_f32_16x16x32_bf16 v[100:103], v[184:187], a[108:111], v[100:103]
    s_waitcnt lgkmcnt(3)
    v_mfma_f32_16x16x32_bf16 v[104:107], v[128:131], a[104:107], v[104:107]
    ds_read_b128 v[152:155], v3 offset:64512
    v_mfma_f32_16x16x32_bf16 v[108:111], v[128:131], a[108:111], v[108:111]
    s_add_u32 s85, s85, 4096
    v_mfma_f32_16x16x32_bf16 v[112:115], v[132:135], a[104:107], v[112:115]
    ds_read_b128 v[156:159], v14
    v_mfma_f32_16x16x32_bf16 v[116:119], v[132:135], a[108:111], v[116:119]
    buffer_load_dwordx4 a[48:51], v2, s[4:7], s85 offen sc1
    v_mfma_f32_16x16x32_bf16 v[120:123], v[136:139], a[104:107], v[120:123]
    ds_read_b128 v[184:187], v14 offset:1024
    v_mfma_f32_16x16x32_bf16 v[124:127], v[136:139], a[108:111], v[124:127]
    s_waitcnt lgkmcnt(3)
    v_mfma_f32_16x16x32_bf16 v[80:83], v[140:143], a[112:115], v[80:83]
    ds_read_b128 v[128:131], v14 offset:2048
    v_mfma_f32_16x16x32_bf16 v[84:87], v[140:143], a[116:119], v[84:87]
    buffer_load_dwordx4 a[52:55], v2, s[4:7], s85 offen offset:1024 sc1
    v_mfma_f32_16x16x32_bf16 v[88:91], v[144:147], a[112:115], v[88:91]
    ds_read_b128 v[132:135], v14 offset:3072
    v_mfma_f32_16x16x32_bf16 v[92:95], v[144:147], a[116:119], v[92:95]
    v_mfma_f32_16x16x32_bf16 v[96:99], v[148:151], a[112:115], v[96:99]
    ds_read_b128 v[136:139], v14 offset:4096
    v_mfma_f32_16x16x32_bf16 v[100:103], v[148:151], a[116:119], v[100:103]
    s_waitcnt lgkmcnt(3)
    v_mfma_f32_16x16x32_bf16 v[104:107], v[152:155], a[112:115], v[104:107]
    ds_read_b128 v[140:143], v14 offset:5120
    v_mfma_f32_16x16x32_bf16 v[108:111], v[152:155], a[116:119], v[108:111]
    buffer_load_dwordx4 a[56:59], v2, s[4:7], s85 offen offset:2048 sc1
    v_mfma_f32_16x16x32_bf16 v[112:115], v[156:159], a[112:115], v[112:115]
    ds_read_b128 v[144:147], v14 offset:6144
    v_mfma_f32_16x16x32_bf16 v[116:119], v[156:159], a[116:119], v[116:119]
    v_mfma_f32_16x16x32_bf16 v[120:123], v[184:187], a[112:115], v[120:123]
    ds_read_b128 v[148:151], v14 offset:7168
    v_mfma_f32_16x16x32_bf16 v[124:127], v[184:187], a[116:119], v[124:127]
    s_waitcnt lgkmcnt(3)
    v_mfma_f32_16x16x32_bf16 v[80:83], v[128:131], a[120:123], v[80:83]
    ds_read_b128 v[152:155], v14 offset:8192
    v_mfma_f32_16x16x32_bf16 v[84:87], v[128:131], a[124:127], v[84:87]
    buffer_load_dwordx4 a[60:63], v2, s[4:7], s85 offen offset:3072 sc1
    v_mfma_f32_16x16x32_bf16 v[88:91], v[132:135], a[120:123], v[88:91]
    ds_read_b128 v[156:159], v14 offset:9216
    v_mfma_f32_16x16x32_bf16 v[92:95], v[132:135], a[124:127], v[92:95]
    v_mfma_f32_16x16x32_bf16 v[96:99], v[136:139], a[120:123], v[96:99]
    ds_read_b128 v[184:187], v14 offset:10240
    v_mfma_f32_16x16x32_bf16 v[100:103], v[136:139], a[124:127], v[100:103]
    s_waitcnt lgkmcnt(3)
    v_mfma_f32_16x16x32_bf16 v[104:107], v[140:143], a[120:123], v[104:107]
    ds_read_b128 v[128:131], v14 offset:11264
    v_mfma_f32_16x16x32_bf16 v[108:111], v[140:143], a[124:127], v[108:111]
    s_add_u32 s85, s85, 4096
    v_mfma_f32_16x16x32_bf16 v[112:115], v[144:147], a[120:123], v[112:115]
    ds_read_b128 v[132:135], v14 offset:12288
    v_mfma_f32_16x16x32_bf16 v[116:119], v[144:147], a[124:127], v[116:119]
    buffer_load_dwordx4 a[64:67], v2, s[4:7], s85 offen sc1
    v_mfma_f32_16x16x32_bf16 v[120:123], v[148:151], a[120:123], v[120:123]
    ds_read_b128 v[136:139], v14 offset:13312
    v_mfma_f32_16x16x32_bf16 v[124:127], v[148:151], a[124:127], v[124:127]
    s_waitcnt lgkmcnt(3)
    v_mfma_f32_16x16x32_bf16 v[80:83], v[152:155], a[128:131], v[80:83]
    ds_read_b128 v[140:143], v14 offset:14336
    v_mfma_f32_16x16x32_bf16 v[84:87], v[152:155], a[132:135], v[84:87]
    buffer_load_dwordx4 a[68:71], v2, s[4:7], s85 offen offset:1024 sc1
    v_mfma_f32_16x16x32_bf16 v[88:91], v[156:159], a[128:131], v[88:91]
    ds_read_b128 v[144:147], v14 offset:15360
    v_mfma_f32_16x16x32_bf16 v[92:95], v[156:159], a[132:135], v[92:95]
    v_mfma_f32_16x16x32_bf16 v[96:99], v[184:187], a[128:131], v[96:99]
    ds_read_b128 v[148:151], v14 offset:16384
    v_mfma_f32_16x16x32_bf16 v[100:103], v[184:187], a[132:135], v[100:103]
    s_waitcnt lgkmcnt(3)
    v_mfma_f32_16x16x32_bf16 v[104:107], v[128:131], a[128:131], v[104:107]
    ds_read_b128 v[152:155], v14 offset:17408
    v_mfma_f32_16x16x32_bf16 v[108:111], v[128:131], a[132:135], v[108:111]
    buffer_load_dwordx4 a[72:75], v2, s[4:7], s85 offen offset:2048 sc1
    v_mfma_f32_16x16x32_bf16 v[112:115], v[132:135], a[128:131], v[112:115]
    ds_read_b128 v[156:159], v14 offset:18432
    v_mfma_f32_16x16x32_bf16 v[116:119], v[132:135], a[132:135], v[116:119]
    v_mfma_f32_16x16x32_bf16 v[120:123], v[136:139], a[128:131], v[120:123]
    ds_read_b128 v[184:187], v14 offset:19456
    v_mfma_f32_16x16x32_bf16 v[124:127], v[136:139], a[132:135], v[124:127]
    s_waitcnt lgkmcnt(3)
    v_mfma_f32_16x16x32_bf16 v[80:83], v[140:143], a[136:139], v[80:83]
    ds_read_b128 v[128:131], v14 offset:20480
    v_mfma_f32_16x16x32_bf16 v[84:87], v[140:143], a[140:143], v[84:87]
    buffer_load_dwordx4 a[76:79], v2, s[4:7], s85 offen offset:3072 sc1
    v_mfma_f32_16x16x32_bf16 v[88:91], v[144:147], a[136:139], v[88:91]
    ds_read_b128 v[132:135], v14 offset:21504
    v_mfma_f32_16x16x32_bf16 v[92:95], v[144:147], a[140:143], v[92:95]
    v_mfma_f32_16x16x32_bf16 v[96:99], v[148:151], a[136:139], v[96:99]
    ds_read_b128 v[136:139], v14 offset:22528
    v_mfma_f32_16x16x32_bf16 v[100:103], v[148:151], a[140:143], v[100:103]
    s_waitcnt lgkmcnt(3)
    v_mfma_f32_16x16x32_bf16 v[104:107], v[152:155], a[136:139], v[104:107]
    ds_read_b128 v[140:143], v14 offset:23552
    v_mfma_f32_16x16x32_bf16 v[108:111], v[152:155], a[140:143], v[108:111]
    s_add_u32 s85, s85, 4096
    v_mfma_f32_16x16x32_bf16 v[112:115], v[156:159], a[136:139], v[112:115]
    ds_read_b128 v[144:147], v14 offset:24576
    v_mfma_f32_16x16x32_bf16 v[116:119], v[156:159], a[140:143], v[116:119]
    buffer_load_dwordx4 a[80:83], v2, s[4:7], s85 offen sc1
    v_mfma_f32_16x16x32_bf16 v[120:123], v[184:187], a[136:139], v[120:123]
    ds_read_b128 v[148:151], v14 offset:25600
    v_mfma_f32_16x16x32_bf16 v[124:127], v[184:187], a[140:143], v[124:127]
    s_waitcnt lgkmcnt(3)
    v_mfma_f32_16x16x32_bf16 v[80:83], v[128:131], a[144:147], v[80:83]
    ds_read_b128 v[152:155], v14 offset:26624
    v_mfma_f32_16x16x32_bf16 v[84:87], v[128:131], a[148:151], v[84:87]
    buffer_load_dwordx4 a[84:87], v2, s[4:7], s85 offen offset:1024 sc1
    v_mfma_f32_16x16x32_bf16 v[88:91], v[132:135], a[144:147], v[88:91]
    ds_read_b128 v[156:159], v14 offset:27648
    v_mfma_f32_16x16x32_bf16 v[92:95], v[132:135], a[148:151], v[92:95]
    v_mfma_f32_16x16x32_bf16 v[96:99], v[136:139], a[144:147], v[96:99]
    ds_read_b128 v[184:187], v14 offset:28672
    v_mfma_f32_16x16x32_bf16 v[100:103], v[136:139], a[148:151], v[100:103]
    s_waitcnt lgkmcnt(3)
    v_mfma_f32_16x16x32_bf16 v[104:107], v[140:143], a[144:147], v[104:107]
    ds_read_b128 v[128:131], v14 offset:29696
    v_mfma_f32_16x16x32_bf16 v[108:111], v[140:143], a[148:151], v[108:111]
    buffer_load_dwordx4 a[88:91], v2, s[4:7], s85 offen offset:2048 sc1
    v_mfma_f32_16x16x32_bf16 v[112:115], v[144:147], a[144:147], v[112:115]
    ds_read_b128 v[132:135], v14 offset:30720
    v_mfma_f32_16x16x32_bf16 v[116:119], v[144:147], a[148:151], v[116:119]
    v_mfma_f32_16x16x32_bf16 v[120:123], v[148:151], a[144:147], v[120:123]
    ds_read_b128 v[136:139], v14 offset:31744
    v_mfma_f32_16x16x32_bf16 v[124:127], v[148:151], a[148:151], v[124:127]
    s_waitcnt lgkmcnt(3)
    v_mfma_f32_16x16x32_bf16 v[80:83], v[152:155], a[152:155], v[80:83]
    v_mfma_f32_16x16x32_bf16 v[84:87], v[152:155], a[156:159], v[84:87]
    buffer_load_dwordx4 a[92:95], v2, s[4:7], s85 offen offset:3072 sc1
    v_mfma_f32_16x16x32_bf16 v[88:91], v[156:159], a[152:155], v[88:91]
    v_mfma_f32_16x16x32_bf16 v[92:95], v[156:159], a[156:159], v[92:95]
    v_mfma_f32_16x16x32_bf16 v[96:99], v[184:187], a[152:155], v[96:99]
    v_mfma_f32_16x16x32_bf16 v[100:103], v[184:187], a[156:159], v[100:103]
    s_waitcnt lgkmcnt(0)
    v_mfma_f32_16x16x32_bf16 v[104:107], v[128:131], a[152:155], v[104:107]
    v_mfma_f32_16x16x32_bf16 v[108:111], v[128:131], a[156:159], v[108:111]
    s_add_u32 s85, s85, 4096
    v_mfma_f32_16x16x32_bf16 v[112:115], v[132:135], a[152:155], v[112:115]
    buffer_load_dwordx4 a[96:99], v2, s[4:7], s85 offen sc1
    v_mfma_f32_16x16x32_bf16 v[116:119], v[132:135], a[156:159], v[116:119]
    v_mfma_f32_16x16x32_bf16 v[120:123], v[136:139], a[152:155], v[120:123]
    v_mfma_f32_16x16x32_bf16 v[124:127], v[136:139], a[156:159], v[124:127]
    s_cmp_lt_u32 s42, 2
    s_cselect_b32 s85, s85, s100
    buffer_load_dwordx4 a[100:103], v2, s[4:7], s85 offen offset:1024 sc1
    buffer_load_dwordx4 a[104:107], v2, s[4:7], s85 offen offset:2048 sc1
    buffer_load_dwordx4 a[108:111], v2, s[4:7], s85 offen offset:3072 sc1
    s_add_u32 s85, s85, 4096
    buffer_load_dwordx4 a[112:115], v2, s[4:7], s85 offen sc1
    buffer_load_dwordx4 a[116:119], v2, s[4:7], s85 offen offset:1024 sc1
    buffer_load_dword v181, v180, s[4:7], 0 offen sc1
    ds_read_b128 v[128:131], v179 offset:1024
    ds_read_b128 v[132:135], v179 offset:1088
    ds_read_b128 v[136:139], v179 offset:1152
    ds_read_b128 v[140:143], v179 offset:1216
    ds_read_b128 v[144:147], v179 offset:1280
    ds_read_b128 v[148:151], v179 offset:1344
    ds_read_b128 v[152:155], v179 offset:1408
    ds_read_b128 v[156:159], v179 offset:1472
    s_waitcnt lgkmcnt(4)
    v_pk_fma_f32 v[160:161], v[128:129], v[188:189], v[132:133] op_sel:[0,1,0] op_sel_hi:[1,1,1]
    v_pk_fma_f32 v[162:163], v[130:131], v[188:189], v[134:135] op_sel:[0,1,0] op_sel_hi:[1,1,1]
    v_pk_fma_f32 v[164:165], v[128:129], v[190:191], v[132:133] op_sel:[0,1,0] op_sel_hi:[1,1,1]
    v_pk_fma_f32 v[166:167], v[130:131], v[190:191], v[134:135] op_sel:[0,1,0] op_sel_hi:[1,1,1]
    v_pk_fma_f32 v[80:81], v[80:81], v[188:189], v[160:161] op_sel_hi:[1,0,1]
    v_pk_fma_f32 v[82:83], v[82:83], v[188:189], v[162:163] op_sel_hi:[1,0,1]
    v_pk_fma_f32 v[84:85], v[84:85], v[190:191], v[164:165] op_sel_hi:[1,0,1]
    v_pk_fma_f32 v[86:87], v[86:87], v[190:191], v[166:167] op_sel_hi:[1,0,1]
    v_pk_fma_f32 v[160:161], v[136:137], v[188:189], v[140:141] op_sel:[0,1,0] op_sel_hi:[1,1,1]
    v_pk_fma_f32 v[162:163], v[138:139], v[188:189], v[142:143] op_sel:[0,1,0] op_sel_hi:[1,1,1]
    v_pk_fma_f32 v[164:165], v[136:137], v[190:191], v[140:141] op_sel:[0,1,0] op_sel_hi:[1,1,1]
    v_pk_fma_f32 v[166:167], v[138:139], v[190:191], v[142:143] op_sel:[0,1,0] op_sel_hi:[1,1,1]
    v_pk_fma_f32 v[88:89], v[88:89], v[188:189], v[160:161] op_sel_hi:[1,0,1]
    v_pk_fma_f32 v[90:91], v[90:91], v[188:189], v[162:163] op_sel_hi:[1,0,1]
    v_pk_fma_f32 v[92:93], v[92:93], v[190:191], v[164:165] op_sel_hi:[1,0,1]
    v_pk_fma_f32 v[94:95], v[94:95], v[190:191], v[166:167] op_sel_hi:[1,0,1]
    v_pk_mul_f32 v[160:161], v[80:81], s[62:63] neg_lo:[1,0] neg_hi:[1,0]
    v_pk_mul_f32 v[162:163], v[82:83], s[62:63] neg_lo:[1,0] neg_hi:[1,0]
    v_pk_mul_f32 v[164:165], v[84:85], s[62:63] neg_lo:[1,0] neg_hi:[1,0]
    v_pk_mul_f32 v[166:167], v[86:87], s[62:63] neg_lo:[1,0] neg_hi:[1,0]
    v_exp_f32 v160, v160
    v_exp_f32 v161, v161
    v_exp_f32 v162, v162
    v_exp_f32 v163, v163
    v_exp_f32 v164, v164
    v_exp_f32 v165, v165
    v_exp_f32 v166, v166
    v_exp_f32 v167, v167
    v_pk_add_f32 v[160:161], v[160:161], 1.0 op_sel_hi:[1,0]
    v_pk_add_f32 v[162:163], v[162:163], 1.0 op_sel_hi:[1,0]
    v_pk_add_f32 v[164:165], v[164:165], 1.0 op_sel_hi:[1,0]
    v_pk_add_f32 v[166:167], v[166:167], 1.0 op_sel_hi:[1,0]
    v_rcp_f32 v160, v160
    v_rcp_f32 v161, v161
    v_rcp_f32 v162, v162
    v_rcp_f32 v163, v163
    v_rcp_f32 v164, v164
    s_mov_b32 s96, 400000
    s_waitcnt vmcnt(0)
L_spin_21:
    v_cmp_ne_u32 vcc, s40, v181
    s_nop 0
    s_cmp_eq_u64 vcc, 0
    s_cbranch_scc1 L_seen_22
    s_sleep 1
    buffer_load_dword v181, v180, s[4:7], 0 offen sc1
    s_waitcnt vmcnt(0)
    s_sub_u32 s96, s96, 1
    s_cbranch_scc0 L_spin_21
L_seen_22:
    v_rcp_f32 v165, v165
    v_rcp_f32 v166, v166
    v_rcp_f32 v167, v167
    v_pk_mul_f32 v[80:81], v[80:81], v[160:161]
    buffer_load_dwordx4 v[16:19], v2, s[4:7], s68 offen sc1
    v_pk_mul_f32 v[82:83], v[82:83], v[162:163]
    v_pk_mul_f32 v[84:85], v[84:85], v[164:165]
    v_pk_mul_f32 v[86:87], v[86:87], v[166:167]
    v_pk_mul_f32 v[80:81], v[80:81], v[88:89]
    buffer_load_dwordx4 v[20:23], v2, s[4:7], s69 offen sc1
    v_pk_mul_f32 v[82:83], v[82:83], v[90:91]
    v_pk_mul_f32 v[84:85], v[84:85], v[92:93]
    v_pk_mul_f32 v[86:87], v[86:87], v[94:95]
    v_cvt_pk_bf16_f32 v168, v80, v81
    buffer_load_dwordx4 v[24:27], v2, s[4:7], s70 offen sc1
    v_cvt_pk_bf16_f32 v169, v82, v83
    v_cvt_pk_bf16_f32 v170, v84, v85
    v_cvt_pk_bf16_f32 v171, v86, v87
    buffer_load_dwordx4 v[28:31], v2, s[4:7], s71 offen sc1
    v_permlane16_swap_b32 v168, v170
    v_permlane16_swap_b32 v169, v171
    buffer_store_dwordx4 v[168:171], v176, s[4:7], s91 offen sc1
    ds_read_b128 v[128:131], v179 offset:1536
    ds_read_b128 v[132:135], v179 offset:1600
    ds_read_b128 v[136:139], v179 offset:1664
    ds_read_b128 v[140:143], v179 offset:1728
    s_waitcnt lgkmcnt(4)
    v_pk_fma_f32 v[160:161], v[144:145], v[188:189], v[148:149] op_sel:[0,1,0] op_sel_hi:[1,1,1]
    v_pk_fma_f32 v[162:163], v[146:147], v[188:189], v[150:151] op_sel:[0,1,0] op_sel_hi:[1,1,1]
    v_pk_fma_f32 v[164:165], v[144:145], v[190:191], v[148:149] op_sel:[0,1,0] op_sel_hi:[1,1,1]
    v_pk_fma_f32 v[166:167], v[146:147], v[190:191], v[150:151] op_sel:[0,1,0] op_sel_hi:[1,1,1]
    v_pk_fma_f32 v[96:97], v[96:97], v[188:189], v[160:161] op_sel_hi:[1,0,1]
    v_pk_fma_f32 v[98:99], v[98:99], v[188:189], v[162:163] op_sel_hi:[1,0,1]
    v_pk_fma_f32 v[100:101], v[100:101], v[190:191], v[164:165] op_sel_hi:[1,0,1]
    v_pk_fma_f32 v[102:103], v[102:103], v[190:191], v[166:167] op_sel_hi:[1,0,1]
    v_pk_fma_f32 v[160:161], v[152:153], v[188:189], v[156:157] op_sel:[0,1,0] op_sel_hi:[1,1,1]
    v_pk_fma_f32 v[162:163], v[154:155], v[188:189], v[158:159] op_sel:[0,1,0] op_sel_hi:[1,1,1]
    v_pk_fma_f32 v[164:165], v[152:153], v[190:191], v[156:157] op_sel:[0,1,0] op_sel_hi:[1,1,1]
    v_pk_fma_f32 v[166:167], v[154:155], v[190:191], v[158:159] op_sel:[0,1,0] op_sel_hi:[1,1,1]
    v_pk_fma_f32 v[104:105], v[104:105], v[188:189], v[160:161] op_sel_hi:[1,0,1]
    v_pk_fma_f32 v[106:107], v[106:107], v[188:189], v[162:163] op_sel_hi:[1,0,1]
    v_pk_fma_f32 v[108:109], v[108:109], v[190:191], v[164:165] op_sel_hi:[1,0,1]
    v_pk_fma_f32 v[110:111], v[110:111], v[190:191], v[166:167] op_sel_hi:[1,0,1]
    v_pk_mul_f32 v[160:161], v[96:97], s[62:63] neg_lo:[1,0] neg_hi:[1,0]
    v_pk_mul_f32 v[162:163], v[98:99], s[62:63] neg_lo:[1,0] neg_hi:[1,0]
    v_pk_mul_f32 v[164:165], v[100:101], s[62:63] neg_lo:[1,0] neg_hi:[1,0]
    v_pk_mul_f32 v[166:167], v[102:103], s[62:63] neg_lo:[1,0] neg_hi:[1,0]
    v_exp_f32 v160, v160
    v_exp_f32 v161, v161
    v_exp_f32 v162, v162
    v_exp_f32 v163, v163
    v_exp_f32 v164, v164
    v_exp_f32 v165, v165
    v_exp_f32 v166, v166
    v_exp_f32 v167, v167
    v_pk_add_f32 v[160:161], v[160:161], 1.0 op_sel_hi:[1,0]
    v_pk_add_f32 v[162:163], v[162:163], 1.0 op_sel_hi:[1,0]
    v_pk_add_f32 v[164:165], v[164:165], 1.0 op_sel_hi:[1,0]
    v_pk_add_f32 v[166:167], v[166:167], 1.0 op_sel_hi:[1,0]
    v_rcp_f32 v160, v160
    v_rcp_f32 v161, v161
    v_rcp_f32 v162, v162
    v_rcp_f32 v163, v163
    v_rcp_f32 v164, v164
    v_rcp_f32 v165, v165
    v_rcp_f32 v166, v166
    v_rcp_f32 v167, v167
    v_pk_mul_f32 v[96:97], v[96:97], v[160:161]
    v_pk_mul_f32 v[98:99], v[98:99], v[162:163]
    v_pk_mul_f32 v[100:101], v[100:101], v[164:165]
    v_pk_mul_f32 v[102:103], v[102:103], v[166:167]
    v_pk_mul_f32 v[96:97], v[96:97], v[104:105]
    v_pk_mul_f32 v[98:99], v[98:99], v[106:107]
    v_pk_mul_f32 v[100:101], v[100:101], v[108:109]
    v_pk_mul_f32 v[102:103], v[102:103], v[110:111]
    v_cvt_pk_bf16_f32 v172, v96, v97
    v_cvt_pk_bf16_f32 v173, v98, v99
    v_cvt_pk_bf16_f32 v174, v100, v101
    v_cvt_pk_bf16_f32 v175, v102, v103
    s_nop 0
    v_permlane16_swap_b32 v172, v174
    v_permlane16_swap_b32 v173, v175
    buffer_store_dwordx4 v[172:175], v176, s[4:7], s91 offen offset:512 sc1
    s_waitcnt lgkmcnt(0)
    v_pk_fma_f32 v[160:161], v[128:129], v[188:189], v[132:133] op_sel:[0,1,0] op_sel_hi:[1,1,1]
    v_pk_fma_f32 v[162:163], v[130:131], v[188:189], v[134:135] op_sel:[0,1,0] op_sel_hi:[1,1,1]
    v_pk_fma_f32 v[164:165], v[128:129], v[190:191], v[132:133] op_sel:[0,1,0] op_sel_hi:[1,1,1]
    v_pk_fma_f32 v[166:167], v[130:131], v[190:191], v[134:135] op_sel:[0,1,0] op_sel_hi:[1,1,1]
    v_pk_fma_f32 v[112:113], v[112:113], v[188:189], v[160:161] op_sel_hi:[1,0,1]
    v_pk_fma_f32 v[114:115], v[114:115], v[188:189], v[162:163] op_sel_hi:[1,0,1]
    v_pk_fma_f32 v[116:117], v[116:117], v[190:191], v[164:165] op_sel_hi:[1,0,1]
    v_pk_fma_f32 v[118:119], v[118:119], v[190:191], v[166:167] op_sel_hi:[1,0,1]
    v_pk_fma_f32 v[160:161], v[136:137], v[188:189], v[140:141] op_sel:[0,1,0] op_sel_hi:[1,1,1]
    v_pk_fma_f32 v[162:163], v[138:139], v[188:189], v[142:143] op_sel:[0,1,0] op_sel_hi:[1,1,1]
    v_pk_fma_f32 v[164:165], v[136:137], v[190:191], v[140:141] op_sel:[0,1,0] op_sel_hi:[1,1,1]
    v_pk_fma_f32 v[166:167], v[138:139], v[190:191], v[142:143] op_sel:[0,1,0] op_sel_hi:[1,1,1]
    v_pk_fma_f32 v[120:121], v[120:121], v[188:189], v[160:161] op_sel_hi:[1,0,1]
    v_pk_fma_f32 v[122:123], v[122:123], v[188:189], v[162:163] op_sel_hi:[1,0,1]
    v_pk_fma_f32 v[124:125], v[124:125], v[190:191], v[164:165] op_sel_hi:[1,0,1]
    v_pk_fma_f32 v[126:127], v[126:127], v[190:191], v[166:167] op_sel_hi:[1,0,1]
    v_pk_mul_f32 v[160:161], v[112:113], s[62:63] neg_lo:[1,0] neg_hi:[1,0]
    v_pk_mul_f32 v[162:163], v[114:115], s[62:63] neg_lo:[1,0] neg_hi:[1,0]
    v_pk_mul_f32 v[164:165], v[116:117], s[62:63] neg_lo:[1,0] neg_hi:[1,0]
    v_pk_mul_f32 v[166:167], v[118:119], s[62:63] neg_lo:[1,0] neg_hi:[1,0]
    v_exp_f32 v160, v160
    v_exp_f32 v161, v161
    v_exp_f32 v162, v162
    v_exp_f32 v163, v163
    v_exp_f32 v164, v164
    v_exp_f32 v165, v165
    v_exp_f32 v166, v166
    v_exp_f32 v167, v167
    v_pk_add_f32 v[160:161], v[160:161], 1.0 op_sel_hi:[1,0]
    v_pk_add_f32 v[162:163], v[162:163], 1.0 op_sel_hi:[1,0]
    v_pk_add_f32 v[164:165], v[164:165], 1.0 op_sel_hi:[1,0]
    v_pk_add_f32 v[166:167], v[166:167], 1.0 op_sel_hi:[1,0]
    v_rcp_f32 v160, v160
    v_rcp_f32 v161, v161
    v_rcp_f32 v162, v162
    v_rcp_f32 v163, v163
    v_rcp_f32 v164, v164
    v_rcp_f32 v165, v165
    v_rcp_f32 v166, v166
    v_rcp_f32 v167, v167
    v_pk_mul_f32 v[112:113], v[112:113], v[160:161]
    v_pk_mul_f32 v[114:115], v[114:115], v[162:163]
    v_pk_mul_f32 v[116:117], v[116:117], v[164:165]
    v_pk_mul_f32 v[118:119], v[118:119], v[166:167]
    v_pk_mul_f32 v[112:113], v[112:113], v[120:121]
    v_pk_mul_f32 v[114:115], v[114:115], v[122:123]
    v_pk_mul_f32 v[116:117], v[116:117], v[124:125]
    v_pk_mul_f32 v[118:119], v[118:119], v[126:127]
    v_cvt_pk_bf16_f32 v168, v112, v113
    v_cvt_pk_bf16_f32 v169, v114, v115
    v_cvt_pk_bf16_f32 v170, v116, v117
    v_cvt_pk_bf16_f32 v171, v118, v119
    s_nop 0
    v_permlane16_swap_b32 v168, v170
    v_permlane16_swap_b32 v169, v171
    buffer_store_dwordx4 v[168:171], v176, s[4:7], s91 offen offset:1024 sc1
    buffer_load_dwordx4 v[32:35], v2, s[4:7], s68 offen offset:1024 sc1
    buffer_load_dwordx4 v[36:39], v2, s[4:7], s69 offen offset:1024 sc1
    buffer_load_dwordx4 v[40:43], v2, s[4:7], s70 offen offset:1024 sc1
    buffer_load_dwordx4 v[44:47], v2, s[4:7], s71 offen offset:1024 sc1
    s_waitcnt vmcnt(10)
    v_mfma_f32_16x16x32_bf16 v[80:83], a[160:163], v[16:19], 0
    buffer_load_dwordx4 v[48:51], v2, s[4:7], s68 offen offset:2048 sc1
    v_mfma_f32_16x16x32_bf16 v[84:87], a[164:167], v[16:19], 0
    v_mfma_f32_16x16x32_bf16 v[88:91], a[168:171], v[16:19], 0
    v_mfma_f32_16x16x32_bf16 v[92:95], a[172:175], v[16:19], 0
    v_mfma_f32_16x16x32_bf16 v[96:99], a[176:179], v[16:19], 0
    s_waitcnt vmcnt(10)
    v_mfma_f32_16x16x32_bf16 v[100:103], a[160:163], v[20:23], 0
    buffer_load_dwordx4 v[52:55], v2, s[4:7], s69 offen offset:2048 sc1
    v_mfma_f32_16x16x32_bf16 v[104:107], a[164:167], v[20:23], 0
    v_mfma_f32_16x16x32_bf16 v[108:111], a[168:171], v[20:23], 0
    v_mfma_f32_16x16x32_bf16 v[112:115], a[172:175], v[20:23], 0
    v_mfma_f32_16x16x32_bf16 v[116:119], a[176:179], v[20:23], 0
    s_waitcnt vmcnt(10)
    v_mfma_f32_16x16x32_bf16 v[120:123], a[160:163], v[24:27], 0
    buffer_load_dwordx4 v[56:59], v2, s[4:7], s70 offen offset:2048 sc1
    v_mfma_f32_16x16x32_bf16 v[124:127], a[164:167], v[24:27], 0
    v_mfma_f32_16x16x32_bf16 v[128:131], a[168:171], v[24:27], 0
    v_mfma_f32_16x16x32_bf16 v[132:135], a[172:175], v[24:27], 0
    v_mfma_f32_16x16x32_bf16 v[136:139], a[176:179], v[24:27], 0
    s_waitcnt vmcnt(10)
    v_mfma_f32_16x16x32_bf16 v[140:143], a[160:163], v[28:31], 0
    buffer_load_dwordx4 v[60:63], v2, s[4:7], s71 offen offset:2048 sc1
    v_mfma_f32_16x16x32_bf16 v[144:147], a[164:167], v[28:31], 0
    v_mfma_f32_16x16x32_bf16 v[148:151], a[168:171], v[28:31], 0
    v_mfma_f32_16x16x32_bf16 v[152:155], a[172:175], v[28:31], 0
    v_mfma_f32_16x16x32_bf16 v[156:159], a[176:179], v[28:31], 0
    s_waitcnt vmcnt(7)
    v_mfma_f32_16x16x32_bf16 v[80:83], a[180:183], v[32:35], v[80:83]
    v_mov_b32 v177, s40
    s_mov_b64 exec, 1
    buffer_store_dword v177, off, s[4:7], s89 sc1
    s_mov_b64 exec, -1
    v_mfma_f32_16x16x32_bf16 v[84:87], a[184:187], v[32:35], v[84:87]
    buffer_load_dwordx4 v[64:67], v2, s[4:7], s68 offen offset:3072 sc1
    v_mfma_f32_16x16x32_bf16 v[88:91], a[188:191], v[32:35], v[88:91]
    v_mfma_f32_16x16x32_bf16 v[92:95], a[192:195], v[32:35], v[92:95]
    v_mfma_f32_16x16x32_bf16 v[96:99], a[196:199], v[32:35], v[96:99]
    s_waitcnt vmcnt(8)
    v_mfma_f32_16x16x32_bf16 v[100:103], a[180:183], v[36:39], v[100:103]
    buffer_load_dwordx4 v[68:71], v2, s[4:7], s69 offen offset:3072 sc1
    v_mfma_f32_16x16x32_bf16 v[104:107], a[184:187], v[36:39], v[104:107]
    v_mfma_f32_16x16x32_bf16 v[108:111], a[188:191], v[36:39], v[108:111]
    v_mfma_f32_16x16x32_bf16 v[112:115], a[192:195], v[36:39], v[112:115]
    v_mfma_f32_16x16x32_bf16 v[116:119], a[196:199], v[36:39], v[116:119]
    s_waitcnt vmcnt(8)
    v_mfma_f32_16x16x32_bf16 v[120:123], a[180:183], v[40:43], v[120:123]
    buffer_load_dwordx4 v[72:75], v2, s[4:7], s70 offen offset:3072 sc1
    v_mfma_f32_16x16x32_bf16 v[124:127], a[184:187], v[40:43], v[124:127]
    v_mfma_f32_16x16x32_bf16 v[128:131], a[188:191], v[40:43], v[128:131]
    v_mfma_f32_16x16x32_bf16 v[132:135], a[192:195], v[40:43], v[132:135]
    v_mfma_f32_16x16x32_bf16 v[136:139], a[196:199], v[40:43], v[136:139]
    s_waitcnt vmcnt(8)
    v_mfma_f32_16x16x32_bf16 v[140:143], a[180:183], v[44:47], v[140:143]
    buffer_load_dwordx4 v[76:79], v2, s[4:7], s71 offen offset:3072 sc1
    v_mfma_f32_16x16x32_bf16 v[144:147], a[184:187], v[44:47], v[144:147]
    v_mfma_f32_16x16x32_bf16 v[148:151], a[188:191], v[44:47], v[148:151]
    v_mfma_f32_16x16x32_bf16 v[152:155], a[192:195], v[44:47], v[152:155]
    v_mfma_f32_16x16x32_bf16 v[156:159], a[196:199], v[44:47], v[156:159]
    s_waitcnt vmcnt(8)
    v_mfma_f32_16x16x32_bf16 v[80:83], a[200:203], v[48:51], v[80:83]
    s_add_u32 s68, s68, 4096
    v_mfma_f32_16x16x32_bf16 v[84:87], a[204:207], v[48:51], v[84:87]
    buffer_load_dwordx4 v[16:19], v2, s[4:7], s68 offen sc1
    v_mfma_f32_16x16x32_bf16 v[88:91], a[208:211], v[48:51], v[88:91]
    v_mfma_f32_16x16x32_bf16 v[92:95], a[212:215], v[48:51], v[92:95]
    v_mfma_f32_16x16x32_bf16 v[96:99], a[216:219], v[48:51], v[96:99]
    s_waitcnt vmcnt(8)
    v_mfma_f32_16x16x32_bf16 v[100:103], a[200:203], v[52:55], v[100:103]
    s_add_u32 s69, s69, 4096
    v_mfma_f32_16x16x32_bf16 v[104:107], a[204:207], v[52:55], v[104:107]
    buffer_load_dwordx4 v[20:23], v2, s[4:7], s69 offen sc1
    v_mfma_f32_16x16x32_bf16 v[108:111], a[208:211], v[52:55], v[108:111]
    v_mfma_f32_16x16x32_bf16 v[112:115], a[212:215], v[52:55], v[112:115]
    v_mfma_f32_16x16x32_bf16 v[116:119], a[216:219], v[52:55], v[116:119]
    s_waitcnt vmcnt(8)
    v_mfma_f32_16x16x32_bf16 v[120:123], a[200:203], v[56:59], v[120:123]
    s_add_u32 s70, s70, 4096
    v_mfma_f32_16x16x32_bf16 v[124:127], a[204:207], v[56:59], v[124:127]
    buffer_load_dwordx4 v[24:27], v2, s[4:7], s70 offen sc1
    v_mfma_f32_16x16x32_bf16 v[128:131], a[208:211], v[56:59], v[128:131]
    v_mfma_f32_16x16x32_bf16 v[132:135], a[212:215], v[56:59], v[132:135]
    v_mfma_f32_16x16x32_bf16 v[136:139], a[216:219], v[56:59], v[136:139]
    s_waitcnt vmcnt(8)
    v_mfma_f32_16x16x32_bf16 v[140:143], a[200:203], v[60:63], v[140:143]
    s_add_u32 s71, s71, 4096
    v_mfma_f32_16x16x32_bf16 v[144:147], a[204:207], v[60:63], v[144:147]
    buffer_load_dwordx4 v[28:31], v2, s[4:7], s71 offen sc1
    v_mfma_f32_16x16x32_bf16 v[148:151], a[208:211], v[60:63], v[148:151]
    v_mfma_f32_16x16x32_bf16 v[152:155], a[212:215], v[60:63], v[152:155]
    v_mfma_f32_16x16x32_bf16 v[156:159], a[216:219], v[60:63], v[156:159]
    s_waitcnt vmcnt(7)
    v_mfma_f32_16x16x32_bf16 v[80:83], a[220:223], v[64:67], v[80:83]
    buffer_load_dwordx4 v[32:35], v2, s[4:7], s68 offen offset:1024 sc1
    v_mfma_f32_16x16x32_bf16 v[84:87], a[224:227], v[64:67], v[84:87]
    v_mfma_f32_16x16x32_bf16 v[88:91], a[228:231], v[64:67], v[88:91]
    v_mfma_f32_16x16x32_bf16 v[92:95], a[232:235], v[64:67], v[92:95]
    v_mfma_f32_16x16x32_bf16 v[96:99], a[236:239], v[64:67], v[96:99]
    s_waitcnt vmcnt(7)
    v_mfma_f32_16x16x32_bf16 v[100:103], a[220:223], v[68:71], v[100:103]
    buffer_load_dwordx4 v[36:39], v2, s[4:7], s69 offen offset:1024 sc1
    v_mfma_f32_16x16x32_bf16 v[104:107], a[224:227], v[68:71], v[104:107]
    v_mfma_f32_16x16x32_bf16 v[108:111], a[228:231], v[68:71], v[108:111]
    v_mfma_f32_16x16x32_bf16 v[112:115], a[232:235], v[68:71], v[112:115]
    v_mfma_f32_16x16x32_bf16 v[116:119], a[236:239], v[68:71], v[116:119]
    s_waitcnt vmcnt(7)
    v_mfma_f32_16x16x32_bf16 v[120:123], a[220:223], v[72:75], v[120:123]
    buffer_load_dwordx4 v[40:43], v2, s[4:7], s70 offen offset:1024 sc1
    v_mfma_f32_16x16x32_bf16 v[124:127], a[224:227], v[72:75], v[124:127]
    v_mfma_f32_16x16x32_bf16 v[128:131], a[228:231], v[72:75], v[128:131]
    v_mfma_f32_16x16x32_bf16 v[132:135], a[232:235], v[72:75], v[132:135]
    v_mfma_f32_16x16x32_bf16 v[136:139], a[236:239], v[72:75], v[136:139]
    s_waitcnt vmcnt(7)
    v_mfma_f32_16x16x32_bf16 v[140:143], a[220:223], v[76:79], v[140:143]
    buffer_load_dwordx4 v[44:47], v2, s[4:7], s71 offen offset:1024 sc1
    v_mfma_f32_16x16x32_bf16 v[144:147], a[224:227], v[76:79], v[144:147]
    v_mfma_f32_16x16x32_bf16 v[148:151], a[228:231], v[76:79], v[148:151]
    v_mfma_f32_16x16x32_bf16 v[152:155], a[232:235], v[76:79], v[152:155]
    v_mfma_f32_16x16x32_bf16 v[156:159], a[236:239], v[76:79], v[156:159]
    s_waitcnt vmcnt(7)
    v_mfma_f32_16x16x32_bf16 v[80:83], a[240:243], v[16:19], v[80:83]
    buffer_load_dwordx4 v[48:51], v2, s[4:7], s68 offen offset:2048 sc1
    v_mfma_f32_16x16x32_bf16 v[84:87], a[244:247], v[16:19], v[84:87]
    v_mfma_f32_16x16x32_bf16 v[88:91], a[248:251], v[16:19], v[88:91]
    v_mfma_f32_16x16x32_bf16 v[92:95], a[252:255], v[16:19], v[92:95]
    v_mfma_f32_16x16x32_bf16 v[96:99], v[200:203], v[16:19], v[96:99]
    s_waitcnt vmcnt(7)
    v_mfma_f32_16x16x32_bf16 v[100:103], a[240:243], v[20:23], v[100:103]
    buffer_load_dword v183, v182, s[4:7], 0 offen sc1
    v_mfma_f32_16x16x32_bf16 v[104:107], a[244:247], v[20:23], v[104:107]
    buffer_load_dwordx4 v[52:55], v2, s[4:7], s69 offen offset:2048 sc1
    v_mfma_f32_16x16x32_bf16 v[108:111], a[248:251], v[20:23], v[108:111]
    v_mfma_f32_16x16x32_bf16 v[112:115], a[252:255], v[20:23], v[112:115]
    v_mfma_f32_16x16x32_bf16 v[116:119], v[200:203], v[20:23], v[116:119]
    s_waitcnt vmcnt(8)
    v_mfma_f32_16x16x32_bf16 v[120:123], a[240:243], v[24:27], v[120:123]
    buffer_load_dwordx4 v[56:59], v2, s[4:7], s70 offen offset:2048 sc1
    v_mfma_f32_16x16x32_bf16 v[124:127], a[244:247], v[24:27], v[124:127]
    v_mfma_f32_16x16x32_bf16 v[128:131], a[248:251], v[24:27], v[128:131]
    v_mfma_f32_16x16x32_bf16 v[132:135], a[252:255], v[24:27], v[132:135]
    v_mfma_f32_16x16x32_bf16 v[136:139], v[200:203], v[24:27], v[136:139]
    s_waitcnt vmcnt(8)
    v_mfma_f32_16x16x32_bf16 v[140:143], a[240:243], v[28:31], v[140:143]
    buffer_load_dwordx4 v[60:63], v2, s[4:7], s71 offen offset:2048 sc1
    v_mfma_f32_16x16x32_bf16 v[144:147], a[244:247], v[28:31], v[144:147]
    v_mfma_f32_16x16x32_bf16 v[148:151], a[248:251], v[28:31], v[148:151]
    v_mfma_f32_16x16x32_bf16 v[152:155], a[252:255], v[28:31], v[152:155]
    v_mfma_f32_16x16x32_bf16 v[156:159], v[200:203], v[28:31], v[156:159]
    s_waitcnt vmcnt(8)
    v_mfma_f32_16x16x32_bf16 v[80:83], v[204:207], v[32:35], v[80:83]
    buffer_load_dwordx4 v[64:67], v2, s[4:7], s68 offen offset:3072 sc1
    v_mfma_f32_16x16x32_bf16 v[84:87], v[208:211], v[32:35], v[84:87]
    v_mfma_f32_16x16x32_bf16 v[88:91], v[212:215], v[32:35], v[88:91]
    v_mfma_f32_16x16x32_bf16 v[92:95], v[216:219], v[32:35], v[92:95]
    v_mfma_f32_16x16x32_bf16 v[96:99], v[220:223], v[32:35], v[96:99]
    s_waitcnt vmcnt(8)
    v_mfma_f32_16x16x32_bf16 v[100:103], v[204:207], v[36:39], v[100:103]
    buffer_load_dwordx4 v[68:71], v2, s[4:7], s69 offen offset:3072 sc1
    v_mfma_f32_16x16x32_bf16 v[104:107], v[208:211], v[36:39], v[104:107]
    v_mfma_f32_16x16x32_bf16 v[108:111], v[212:215], v[36:39], v[108:111]
    v_mfma_f32_16x16x32_bf16 v[112:115], v[216:219], v[36:39], v[112:115]
    v_mfma_f32_16x16x32_bf16 v[116:119], v[220:223], v[36:39], v[116:119]
    s_waitcnt vmcnt(5)
    v_cmp_ne_u32 vcc, s40, v183
    s_nop 0
    s_cmp_eq_u64 vcc, 0
    s_cbranch_scc1 L_seen_24
    s_mov_b32 s96, 400000
    buffer_load_dword v183, v182, s[4:7], 0 offen sc1
L_spin_23:
    s_sleep 3
    buffer_load_dword v185, v182, s[4:7], 0 offen sc1
    s_waitcnt vmcnt(1)
    v_cmp_ne_u32 vcc, s40, v183
    s_nop 0
    s_cmp_eq_u64 vcc, 0
    s_cbranch_scc1 L_seen_24
    s_sleep 3
    buffer_load_dword v183, v182, s[4:7], 0 offen sc1
    s_waitcnt vmcnt(1)
    v_cmp_ne_u32 vcc, s40, v185
    s_nop 0
    s_cmp_eq_u64 vcc, 0
    s_cbranch_scc1 L_seen_24
    s_sub_u32 s96, s96, 1
    s_cbranch_scc0 L_spin_23
L_seen_24:
    v_mfma_f32_16x16x32_bf16 v[120:123], v[204:207], v[40:43], v[120:123]
    buffer_load_dwordx4 v[72:75], v2, s[4:7], s70 offen offset:3072 sc1
    v_mfma_f32_16x16x32_bf16 v[124:127], v[208:211], v[40:43], v[124:127]
    v_mfma_f32_16x16x32_bf16 v[128:131], v[212:215], v[40:43], v[128:131]
    v_mfma_f32_16x16x32_bf16 v[132:135], v[216:219], v[40:43], v[132:135]
    v_mfma_f32_16x16x32_bf16 v[136:139], v[220:223], v[40:43], v[136:139]
    v_mfma_f32_16x16x32_bf16 v[140:143], v[204:207], v[44:47], v[140:143]
    buffer_load_dwordx4 v[76:79], v2, s[4:7], s71 offen offset:3072 sc1
    v_mfma_f32_16x16x32_bf16 v[144:147], v[208:211], v[44:47], v[144:147]
    v_mfma_f32_16x16x32_bf16 v[148:151], v[212:215], v[44:47], v[148:151]
    v_mfma_f32_16x16x32_bf16 v[152:155], v[216:219], v[44:47], v[152:155]
    v_mfma_f32_16x16x32_bf16 v[156:159], v[220:223], v[44:47], v[156:159]
    v_mfma_f32_16x16x32_bf16 v[80:83], v[224:227], v[48:51], v[80:83]
    buffer_load_dwordx4 v[16:19], v2, s[4:7], s72 offen sc1
    v_mfma_f32_16x16x32_bf16 v[84:87], v[228:231], v[48:51], v[84:87]
    v_mfma_f32_16x16x32_bf16 v[88:91], v[232:235], v[48:51], v[88:91]
    v_mfma_f32_16x16x32_bf16 v[92:95], v[236:239], v[48:51], v[92:95]
    v_mfma_f32_16x16x32_bf16 v[96:99], v[240:243], v[48:51], v[96:99]
    s_waitcnt vmcnt(7)
    v_mfma_f32_16x16x32_bf16 v[100:103], v[224:227], v[52:55], v[100:103]
    buffer_load_dwordx4 v[20:23], v2, s[4:7], s73 offen sc1
    v_mfma_f32_16x16x32_bf16 v[104:107], v[228:231], v[52:55], v[104:107]
    v_mfma_f32_16x16x32_bf16 v[108:111], v[232:235], v[52:55], v[108:111]
    v_mfma_f32_16x16x32_bf16 v[112:115], v[236:239], v[52:55], v[112:115]
    v_mfma_f32_16x16x32_bf16 v[116:119], v[240:243], v[52:55], v[116:119]
    s_waitcnt vmcnt(7)
    v_mfma_f32_16x16x32_bf16 v[120:123], v[224:227], v[56:59], v[120:123]
    buffer_load_dwordx4 v[24:27], v2, s[4:7], s74 offen sc1
    v_mfma_f32_16x16x32_bf16 v[124:127], v[228:231], v[56:59], v[124:127]
    s_add_u32 s56, s42, 1
    s_and_b32 s56, s56, 3
    v_mfma_f32_16x16x32_bf16 v[128:131], v[232:235], v[56:59], v[128:131]
    s_mul_i32 s56, s56, 0x3c00
    s_add_u32 s56, s56, 0xf000
    v_mfma_f32_16x16x32_bf16 v[132:135], v[236:239], v[56:59], v[132:135]
    v_add_u32 v165, s56, v2
    s_add_u32 s56, s42, 2
    v_mfma_f32_16x16x32_bf16 v[136:139], v[240:243], v[56:59], v[136:139]
    s_and_b32 s56, s56, 3
    s_waitcnt vmcnt(7)
    v_mfma_f32_16x16x32_bf16 v[140:143], v[224:227], v[60:63], v[140:143]
    buffer_load_dwordx4 v[28:31], v2, s[4:7], s75 offen sc1
    v_mfma_f32_16x16x32_bf16 v[144:147], v[228:231], v[60:63], v[144:147]
    s_mul_i32 s56, s56, 0x3c00
    s_add_u32 s56, s56, 0x10400
    v_mfma_f32_16x16x32_bf16 v[148:151], v[232:235], v[60:63], v[148:151]
    v_add_u32 v166, s56, v2
    s_add_u32 s56, s42, 3
    v_mfma_f32_16x16x32_bf16 v[152:155], v[236:239], v[60:63], v[152:155]
    s_and_b32 s56, s56, 3
    s_mul_i32 s56, s56, 0x3c00
    v_mfma_f32_16x16x32_bf16 v[156:159], v[240:243], v[60:63], v[156:159]
    s_add_u32 s56, s56, 0x11800
    s_waitcnt vmcnt(7)
    v_mfma_f32_16x16x32_bf16 v[80:83], v[244:247], v[64:67], v[80:83]
    buffer_load_dwordx4 v[32:35], v2, s[4:7], s72 offen offset:1024 sc1
    v_mfma_f32_16x16x32_bf16 v[84:87], v[248:251], v[64:67], v[84:87]
    v_add_u32 v167, s56, v2
    v_lshrrev_b32 v164, 4, v1
    v_mfma_f32_16x16x32_bf16 v[88:91], v[252:255], v[64:67], v[88:91]
    v_mul_u32_u24 v163, 80, v164
    v_add_u32 v163, 59520, v163
    v_mfma_f32_16x16x32_bf16 v[92:95], v[192:195], v[64:67], v[92:95]
    v_and_b32 v164, 1, v164
    v_lshl_add_u32 v162, v164, 4, v163
    v_mfma_f32_16x16x32_bf16 v[96:99], v[196:199], v[64:67], v[96:99]
    v_xor_b32 v164, 1, v164
    s_waitcnt vmcnt(7)
    v_mfma_f32_16x16x32_bf16 v[100:103], v[244:247], v[68:71], v[100:103]
    buffer_load_dwordx4 v[36:39], v2, s[4:7], s73 offen offset:1024 sc1
    v_mfma_f32_16x16x32_bf16 v[104:107], v[248:251], v[68:71], v[104:107]
    v_lshl_add_u32 v163, v164, 6, v163
    s_mul_i32 s56, s42, 0x3c00
    v_mfma_f32_16x16x32_bf16 v[108:111], v[252:255], v[68:71], v[108:111]
    s_add_u32 s56, s56, 0xf000
    v_add_u32 v164, s56, v2
    v_mfma_f32_16x16x32_bf16 v[112:115], v[192:195], v[68:71], v[112:115]
    v_and_b32 v160, 15, v1
    v_mul_u32_u24 v160, 1280, v160
    v_mfma_f32_16x16x32_bf16 v[116:119], v[196:199], v[68:71], v[116:119]
    v_lshrrev_b32 v184, 4, v1
    s_waitcnt vmcnt(7)
    v_mfma_f32_16x16x32_bf16 v[120:123], v[244:247], v[72:75], v[120:123]
    buffer_load_dwordx4 v[40:43], v2, s[4:7], s74 offen offset:1024 sc1
    v_mfma_f32_16x16x32_bf16 v[124:127], v[248:251], v[72:75], v[124:127]
    v_mul_u32_u24 v161, 40, v184
    v_add_u32 v161, v161, v160
    v_mfma_f32_16x16x32_bf16 v[128:131], v[252:255], v[72:75], v[128:131]
    v_and_b32 v184, 1, v184
    v_lshl_add_u32 v160, v184, 3, v161
    v_mfma_f32_16x16x32_bf16 v[132:135], v[192:195], v[72:75], v[132:135]
    v_xor_b32 v184, 1, v184
    v_lshl_add_u32 v161, v184, 5, v161
    v_mfma_f32_16x16x32_bf16 v[136:139], v[196:199], v[72:75], v[136:139]
    s_waitcnt vmcnt(7)
    v_mfma_f32_16x16x32_bf16 v[140:143], v[244:247], v[76:79], v[140:143]
    buffer_load_dwordx4 v[44:47], v2, s[4:7], s75 offen offset:1024 sc1
    v_mfma_f32_16x16x32_bf16 v[144:147], v[248:251], v[76:79], v[144:147]
    v_mfma_f32_16x16x32_bf16 v[148:151], v[252:255], v[76:79], v[148:151]
    v_mfma_f32_16x16x32_bf16 v[152:155], v[192:195], v[76:79], v[152:155]
    v_mfma_f32_16x16x32_bf16 v[156:159], v[196:199], v[76:79], v[156:159]
    s_waitcnt vmcnt(7)
    v_mfma_f32_16x16x32_bf16 v[80:83], a[0:3], v[16:19], v[80:83]
    buffer_load_dwordx4 v[48:51], v2, s[4:7], s72 offen offset:2048 sc1
    v_mfma_f32_16x16x32_bf16 v[84:87], a[4:7], v[16:19], v[84:87]
    v_mfma_f32_16x16x32_bf16 v[88:91], a[8:11], v[16:19], v[88:91]
    v_mfma_f32_16x16x32_bf16 v[92:95], a[12:15], v[16:19], v[92:95]
    v_mfma_f32_16x16x32_bf16 v[96:99], a[16:19], v[16:19], v[96:99]
    s_waitcnt vmcnt(7)
    v_mfma_f32_16x16x32_bf16 v[100:103], a[0:3], v[20:23], v[100:103]
    buffer_load_dwordx4 v[52:55], v2, s[4:7], s73 offen offset:2048 sc1
    v_mfma_f32_16x16x32_bf16 v[104:107], a[4:7], v[20:23], v[104:107]
    v_mfma_f32_16x16x32_bf16 v[108:111], a[8:11], v[20:23], v[108:111]
    v_mfma_f32_16x16x32_bf16 v[112:115], a[12:15], v[20:23], v[112:115]
    v_mfma_f32_16x16x32_bf16 v[116:119], a[16:19], v[20:23], v[116:119]
    s_waitcnt vmcnt(7)
    v_mfma_f32_16x16x32_bf16 v[120:123], a[0:3], v[24:27], v[120:123]
    buffer_load_dwordx4 v[56:59], v2, s[4:7], s74 offen offset:2048 sc1
    v_mfma_f32_16x16x32_bf16 v[124:127], a[4:7], v[24:27], v[124:127]
    v_mfma_f32_16x16x32_bf16 v[128:131], a[8:11], v[24:27], v[128:131]
    v_mfma_f32_16x16x32_bf16 v[132:135], a[12:15], v[24:27], v[132:135]
    v_mfma_f32_16x16x32_bf16 v[136:139], a[16:19], v[24:27], v[136:139]
    s_waitcnt vmcnt(7)
    v_mfma_f32_16x16x32_bf16 v[140:143], a[0:3], v[28:31], v[140:143]
    buffer_load_dwordx4 v[60:63], v2, s[4:7], s75 offen offset:2048 sc1
    v_mfma_f32_16x16x32_bf16 v[144:147], a[4:7], v[28:31], v[144:147]
    v_mfma_f32_16x16x32_bf16 v[148:151], a[8:11], v[28:31], v[148:151]
    v_mfma_f32_16x16x32_bf16 v[152:155], a[12:15], v[28:31], v[152:155]
    v_mfma_f32_16x16x32_bf16 v[156:159], a[16:19], v[28:31], v[156:159]
    s_waitcnt vmcnt(7)
    v_mfma_f32_16x16x32_bf16 v[80:83], a[20:23], v[32:35], v[80:83]
    buffer_load_dwordx4 v[64:67], v2, s[4:7], s72 offen offset:3072 sc1
    v_mfma_f32_16x16x32_bf16 v[84:87], a[24:27], v[32:35], v[84:87]
    v_mfma_f32_16x16x32_bf16 v[88:91], a[28:31], v[32:35], v[88:91]
    v_mfma_f32_16x16x32_bf16 v[92:95], a[32:35], v[32:35], v[92:95]
    v_mfma_f32_16x16x32_bf16 v[96:99], a[36:39], v[32:35], v[96:99]
    s_waitcnt vmcnt(7)
    v_mfma_f32_16x16x32_bf16 v[100:103], a[20:23], v[36:39], v[100:103]
    buffer_load_dwordx4 v[68:71], v2, s[4:7], s73 offen offset:3072 sc1
    v_mfma_f32_16x16x32_bf16 v[104:107], a[24:27], v[36:39], v[104:107]
    v_mfma_f32_16x16x32_bf16 v[108:111], a[28:31], v[36:39], v[108:111]
    v_mfma_f32_16x16x32_bf16 v[112:115], a[32:35], v[36:39], v[112:115]
    v_mfma_f32_16x16x32_bf16 v[116:119], a[36:39], v[36:39], v[116:119]
    s_waitcnt vmcnt(7)
    v_mfma_f32_16x16x32_bf16 v[120:123], a[20:23], v[40:43], v[120:123]
    buffer_load_dwordx4 v[72:75], v2, s[4:7], s74 offen offset:3072 sc1
    v_mfma_f32_16x16x32_bf16 v[124:127], a[24:27], v[40:43], v[124:127]
    v_mfma_f32_16x16x32_bf16 v[128:131], a[28:31], v[40:43], v[128:131]
    v_mfma_f32_16x16x32_bf16 v[132:135], a[32:35], v[40:43], v[132:135]
    v_mfma_f32_16x16x32_bf16 v[136:139], a[36:39], v[40:43], v[136:139]
    s_waitcnt vmcnt(7)
    v_mfma_f32_16x16x32_bf16 v[140:143], a[20:23], v[44:47], v[140:143]
    buffer_load_dwordx4 v[76:79], v2, s[4:7], s75 offen offset:3072 sc1
    v_mfma_f32_16x16x32_bf16 v[144:147], a[24:27], v[44:47], v[144:147]
    v_mfma_f32_16x16x32_bf16 v[148:151], a[28:31], v[44:47], v[148:151]
    v_mfma_f32_16x16x32_bf16 v[152:155], a[32:35], v[44:47], v[152:155]
    v_mfma_f32_16x16x32_bf16 v[156:159], a[36:39], v[44:47], v[156:159]
    s_waitcnt vmcnt(7)
    v_mfma_f32_16x16x32_bf16 v[80:83], a[40:43], v[48:51], v[80:83]
    s_barrier
    v_mfma_f32_16x16x32_bf16 v[84:87], a[44:47], v[48:51], v[84:87]
    s_add_u32 s73, s73, 4096
    v_mfma_f32_16x16x32_bf16 v[88:91], a[48:51], v[48:51], v[88:91]
    buffer_load_dwordx4 v[16:19], v2, s[4:7], s73 offen sc1
    v_mfma_f32_16x16x32_bf16 v[92:95], a[52:55], v[48:51], v[92:95]
    v_mfma_f32_16x16x32_bf16 v[96:99], a[56:59], v[48:51], v[96:99]
    s_waitcnt vmcnt(7)
    v_mfma_f32_16x16x32_bf16 v[100:103], a[40:43], v[52:55], v[100:103]
    s_cmp_lt_u32 s42, 2
    s_cselect_b32 s73, s73, s100
    v_mfma_f32_16x16x32_bf16 v[104:107], a[44:47], v[52:55], v[104:107]
    buffer_load_dwordx4 v[20:23], v2, s[4:7], s73 offen offset:1024 sc1
    v_mfma_f32_16x16x32_bf16 v[108:111], a[48:51], v[52:55], v[108:111]
    v_mfma_f32_16x16x32_bf16 v[112:115], a[52:55], v[52:55], v[112:115]
    v_mfma_f32_16x16x32_bf16 v[116:119], a[56:59], v[52:55], v[116:119]
    s_waitcnt vmcnt(7)
    v_mfma_f32_16x16x32_bf16 v[120:123], a[40:43], v[56:59], v[120:123]
    ds_read_b128 v[192:195], v162 offset:960
    ds_read_b128 v[196:199], v162 offset:976
    ds_read_b128 v[200:203], v162 offset:992
    ds_read_b128 v[204:207], v162 offset:1008
    ds_read_b128 v[208:211], v163 offset:960
    v_mfma_f32_16x16x32_bf16 v[124:127], a[44:47], v[56:59], v[124:127]
    s_add_u32 s74, s74, 4096
    v_mfma_f32_16x16x32_bf16 v[128:131], a[48:51], v[56:59], v[128:131]
    buffer_load_dwordx4 v[24:27], v2, s[4:7], s74 offen sc1
    v_mfma_f32_16x16x32_bf16 v[132:135], a[52:55], v[56:59], v[132:135]
    v_mfma_f32_16x16x32_bf16 v[136:139], a[56:59], v[56:59], v[136:139]
    s_waitcnt vmcnt(7)
    v_mfma_f32_16x16x32_bf16 v[140:143], a[40:43], v[60:63], v[140:143]
    s_cmp_lt_u32 s42, 2
    s_cselect_b32 s74, s74, s100
    v_mfma_f32_16x16x32_bf16 v[144:147], a[44:47], v[60:63], v[144:147]
    buffer_load_dwordx4 v[28:31], v2, s[4:7], s74 offen offset:1024 sc1
    v_mfma_f32_16x16x32_bf16 v[148:151], a[48:51], v[60:63], v[148:151]
    v_mfma_f32_16x16x32_bf16 v[152:155], a[52:55], v[60:63], v[152:155]
    v_mfma_f32_16x16x32_bf16 v[156:159], a[56:59], v[60:63], v[156:159]
    s_waitcnt vmcnt(7)
    v_mfma_f32_16x16x32_bf16 v[80:83], a[60:63], v[64:67], v[80:83]
    s_add_u32 s75, s75, 4096
    v_mfma_f32_16x16x32_bf16 v[84:87], a[64:67], v[64:67], v[84:87]
    buffer_load_dwordx4 v[32:35], v2, s[4:7], s75 offen sc1
    v_mfma_f32_16x16x32_bf16 v[88:91], a[68:71], v[64:67], v[88:91]
    v_mfma_f32_16x16x32_bf16 v[92:95], a[72:75], v[64:67], v[92:95]
    v_mfma_f32_16x16x32_bf16 v[96:99], a[76:79], v[64:67], v[96:99]
    s_waitcnt vmcnt(7)
    v_mfma_f32_16x16x32_bf16 v[100:103], a[60:63], v[68:71], v[100:103]
    s_cmp_lt_u32 s42, 2
    s_cselect_b32 s75, s75, s100
    v_mfma_f32_16x16x32_bf16 v[104:107], a[64:67], v[68:71], v[104:107]
    buffer_load_dwordx4 v[36:39], v2, s[4:7], s75 offen offset:1024 sc1
    v_mfma_f32_16x16x32_bf16 v[108:111], a[68:71], v[68:71], v[108:111]
    v_mfma_f32_16x16x32_bf16 v[112:115], a[72:75], v[68:71], v[112:115]
    v_mfma_f32_16x16x32_bf16 v[116:119], a[76:79], v[68:71], v[116:119]
    s_waitcnt vmcnt(7)
    v_mfma_f32_16x16x32_bf16 v[120:123], a[60:63], v[72:75], v[120:123]
    s_add_u32 s72, s72, 4096
    v_mfma_f32_16x16x32_bf16 v[124:127], a[64:67], v[72:75], v[124:127]
    buffer_load_dwordx4 v[40:43], v2, s[4:7], s72 offen sc1
    v_mfma_f32_16x16x32_bf16 v[128:131], a[68:71], v[72:75], v[128:131]
    v_mfma_f32_16x16x32_bf16 v[132:135], a[72:75], v[72:75], v[132:135]
    v_mfma_f32_16x16x32_bf16 v[136:139], a[76:79], v[72:75], v[136:139]
    s_waitcnt vmcnt(7)
    v_mfma_f32_16x16x32_bf16 v[140:143], a[60:63], v[76:79], v[140:143]
    s_cmp_lt_u32 s42, 2
    s_cselect_b32 s72, s72, s100
    v_mfma_f32_16x16x32_bf16 v[144:147], a[64:67], v[76:79], v[144:147]
    buffer_load_dwordx4 v[44:47], v2, s[4:7], s72 offen offset:1024 sc1
    v_mfma_f32_16x16x32_bf16 v[148:151], a[68:71], v[76:79], v[148:151]
    v_mfma_f32_16x16x32_bf16 v[152:155], a[72:75], v[76:79], v[152:155]
    v_mfma_f32_16x16x32_bf16 v[156:159], a[76:79], v[76:79], v[156:159]
    s_waitcnt vmcnt(7)
    v_mfma_f32_16x16x32_bf16 v[100:103], a[80:83], v[16:19], v[100:103]
    v_mfma_f32_16x16x32_bf16 v[104:107], a[84:87], v[16:19], v[104:107]
    v_mfma_f32_16x16x32_bf16 v[108:111], a[88:91], v[16:19], v[108:111]
    v_mfma_f32_16x16x32_bf16 v[112:115], a[92:95], v[16:19], v[112:115]
    v_mfma_f32_16x16x32_bf16 v[116:119], a[96:99], v[16:19], v[116:119]
    s_waitcnt vmcnt(6)
    v_mfma_f32_16x16x32_bf16 v[100:103], a[100:103], v[20:23], v[100:103]
    v_mfma_f32_16x16x32_bf16 v[104:107], a[104:107], v[20:23], v[104:107]
    v_mfma_f32_16x16x32_bf16 v[108:111], a[108:111], v[20:23], v[108:111]
    v_mfma_f32_16x16x32_bf16 v[112:115], a[112:115], v[20:23], v[112:115]
    v_mfma_f32_16x16x32_bf16 v[116:119], a[116:119], v[20:23], v[116:119]
    s_waitcnt vmcnt(5)
    v_mfma_f32_16x16x32_bf16 v[120:123], a[80:83], v[24:27], v[120:123]
    v_mfma_f32_16x16x32_bf16 v[124:127], a[84:87], v[24:27], v[124:127]
    s_nop 0
    ds_write_b128 v165, v[100:103]
    v_mfma_f32_16x16x32_bf16 v[128:131], a[88:91], v[24:27], v[128:131]
    v_mfma_f32_16x16x32_bf16 v[132:135], a[92:95], v[24:27], v[132:135]
    ds_write_b128 v165, v[104:107] offset:1024
    v_mfma_f32_16x16x32_bf16 v[136:139], a[96:99], v[24:27], v[136:139]
    s_waitcnt vmcnt(4)
    v_mfma_f32_16x16x32_bf16 v[120:123], a[100:103], v[28:31], v[120:123]
    ds_write_b128 v165, v[108:111] offset:2048
    v_mfma_f32_16x16x32_bf16 v[124:127], a[104:107], v[28:31], v[124:127]
    v_mfma_f32_16x16x32_bf16 v[128:131], a[108:111], v[28:31], v[128:131]
    ds_write_b128 v165, v[112:115] offset:3072
    v_mfma_f32_16x16x32_bf16 v[132:135], a[112:115], v[28:31], v[132:135]
    v_mfma_f32_16x16x32_bf16 v[136:139], a[116:119], v[28:31], v[136:139]
    ds_write_b128 v165, v[116:119] offset:4096
    s_waitcnt vmcnt(3)
    v_mfma_f32_16x16x32_bf16 v[140:143], a[80:83], v[32:35], v[140:143]
    v_mfma_f32_16x16x32_bf16 v[144:147], a[84:87], v[32:35], v[144:147]
    ds_write_b128 v166, v[120:123]
    v_mfma_f32_16x16x32_bf16 v[148:151], a[88:91], v[32:35], v[148:151]
    v_mfma_f32_16x16x32_bf16 v[152:155], a[92:95], v[32:35], v[152:155]
    ds_write_b128 v166, v[124:127] offset:1024
    v_mfma_f32_16x16x32_bf16 v[156:159], a[96:99], v[32:35], v[156:159]
    s_waitcnt vmcnt(2)
    v_mfma_f32_16x16x32_bf16 v[140:143], a[100:103], v[36:39], v[140:143]
    ds_write_b128 v166, v[128:131] offset:2048
    v_mfma_f32_16x16x32_bf16 v[144:147], a[104:107], v[36:39], v[144:147]
    v_mfma_f32_16x16x32_bf16 v[148:151], a[108:111], v[36:39], v[148:151]
    ds_write_b128 v166, v[132:135] offset:3072
    v_mfma_f32_16x16x32_bf16 v[152:155], a[112:115], v[36:39], v[152:155]
    v_mfma_f32_16x16x32_bf16 v[156:159], a[116:119], v[36:39], v[156:159]
    ds_write_b128 v166, v[136:139] offset:4096
    s_waitcnt vmcnt(1)
    v_mfma_f32_16x16x32_bf16 v[80:83], a[80:83], v[40:43], v[80:83]
    v_mfma_f32_16x16x32_bf16 v[84:87], a[84:87], v[40:43], v[84:87]
    ds_write_b128 v167, v[140:143]
    v_mfma_f32_16x16x32_bf16 v[88:91], a[88:91], v[40:43], v[88:91]
    v_mfma_f32_16x16x32_bf16 v[92:95], a[92:95], v[40:43], v[92:95]
    ds_write_b128 v167, v[144:147] offset:1024
    v_mfma_f32_16x16x32_bf16 v[96:99], a[96:99], v[40:43], v[96:99]
    s_waitcnt vmcnt(0)
    v_mfma_f32_16x16x32_bf16 v[80:83], a[100:103], v[44:47], v[80:83]
    ds_write_b128 v167, v[148:151] offset:2048
    v_mfma_f32_16x16x32_bf16 v[84:87], a[104:107], v[44:47], v[84:87]
    v_mfma_f32_16x16x32_bf16 v[88:91], a[108:111], v[44:47], v[88:91]
    ds_write_b128 v167, v[152:155] offset:3072
    v_mfma_f32_16x16x32_bf16 v[92:95], a[112:115], v[44:47], v[92:95]
    v_mfma_f32_16x16x32_bf16 v[96:99], a[116:119], v[44:47], v[96:99]
    ds_write_b128 v167, v[156:159] offset:4096
    v_lshlrev_b32 v212, 16, v4
    v_and_b32 v213, 0xffff0000, v4
    v_lshlrev_b32 v214, 16, v5
    v_and_b32 v215, 0xffff0000, v5
    v_lshlrev_b32 v216, 16, v6
    v_and_b32 v217, 0xffff0000, v6
    v_lshlrev_b32 v218, 16, v7
    v_and_b32 v219, 0xffff0000, v7
    v_lshlrev_b32 v220, 16, v8
    v_and_b32 v221, 0xffff0000, v8
    v_lshlrev_b32 v222, 16, v9
    v_and_b32 v223, 0xffff0000, v9
    v_lshlrev_b32 v224, 16, v10
    v_and_b32 v225, 0xffff0000, v10
    v_lshlrev_b32 v226, 16, v11
    v_and_b32 v227, 0xffff0000, v11
    v_lshlrev_b32 v228, 16, v12
    v_and_b32 v229, 0xffff0000, v12
    v_lshlrev_b32 v230, 16, v13
    v_and_b32 v231, 0xffff0000, v13
    s_waitcnt lgkmcnt(0)
    s_barrier
    ds_read_b128 v[16:19], v164
    ds_read_b128 v[20:23], v164 offset:1024
    ds_read_b128 v[24:27], v164 offset:2048
    ds_read_b128 v[28:31], v164 offset:3072
    ds_read_b128 v[32:35], v164 offset:4096
    ds_read_b128 v[36:39], v164 offset:5120
    ds_read_b128 v[40:43], v164 offset:6144
    ds_read_b128 v[44:47], v164 offset:7168
    ds_read_b128 v[48:51], v164 offset:8192
    ds_read_b128 v[52:55], v164 offset:9216
    ds_read_b128 v[56:59], v164 offset:10240
    ds_read_b128 v[60:63], v164 offset:11264
    ds_read_b128 v[64:67], v164 offset:12288
    ds_read_b128 v[68:71], v164 offset:13312
    ds_read_b128 v[72:75], v164 offset:14336
    s_waitcnt lgkmcnt(10)
    v_pk_add_f32 v[80:81], v[80:81], v[16:17]
    v_pk_add_f32 v[82:83], v[82:83], v[18:19]
    v_pk_add_f32 v[84:85], v[84:85], v[20:21]
    v_pk_add_f32 v[86:87], v[86:87], v[22:23]
    v_pk_add_f32 v[88:89], v[88:89], v[24:25]
    v_pk_add_f32 v[90:91], v[90:91], v[26:27]
    v_pk_add_f32 v[92:93], v[92:93], v[28:29]
    v_pk_add_f32 v[94:95], v[94:95], v[30:31]
    v_pk_add_f32 v[96:97], v[96:97], v[32:33]
    v_pk_add_f32 v[98:99], v[98:99], v[34:35]
    s_waitcnt lgkmcnt(5)
    v_pk_add_f32 v[80:81], v[80:81], v[36:37]
    v_pk_add_f32 v[82:83], v[82:83], v[38:39]
    v_pk_add_f32 v[84:85], v[84:85], v[40:41]
    v_pk_add_f32 v[86:87], v[86:87], v[42:43]
    v_pk_add_f32 v[88:89], v[88:89], v[44:45]
    v_pk_add_f32 v[90:91], v[90:91], v[46:47]
    v_pk_add_f32 v[92:93], v[92:93], v[48:49]
    v_pk_add_f32 v[94:95], v[94:95], v[50:51]
    v_pk_add_f32 v[96:97], v[96:97], v[52:53]
    v_pk_add_f32 v[98:99], v[98:99], v[54:55]
    s_waitcnt lgkmcnt(0)
    v_pk_add_f32 v[80:81], v[80:81], v[56:57]
    v_pk_add_f32 v[82:83], v[82:83], v[58:59]
    v_pk_add_f32 v[84:85], v[84:85], v[60:61]
    v_pk_add_f32 v[86:87], v[86:87], v[62:63]
    v_pk_add_f32 v[88:89], v[88:89], v[64:65]
    v_pk_add_f32 v[90:91], v[90:91], v[66:67]
    v_pk_add_f32 v[92:93], v[92:93], v[68:69]
    v_pk_add_f32 v[94:95], v[94:95], v[70:71]
    v_pk_add_f32 v[96:97], v[96:97], v[72:73]
    v_pk_add_f32 v[98:99], v[98:99], v[74:75]
    v_pk_fma_f32 v[80:81], v[80:81], v[192:193], v[212:213]
    v_pk_fma_f32 v[82:83], v[82:83], v[194:195], v[214:215]
    v_pk_fma_f32 v[84:85], v[84:85], v[196:197], v[216:217]
    v_pk_fma_f32 v[86:87], v[86:87], v[198:199], v[218:219]
    v_pk_fma_f32 v[88:89], v[88:89], v[200:201], v[220:221]
    v_pk_fma_f32 v[90:91], v[90:91], v[202:203], v[222:223]
    v_pk_fma_f32 v[92:93], v[92:93], v[204:205], v[224:225]
    v_pk_fma_f32 v[94:95], v[94:95], v[206:207], v[226:227]
    v_pk_fma_f32 v[96:97], v[96:97], v[208:209], v[228:229]
    v_pk_fma_f32 v[98:99], v[98:99], v[210:211], v[230:231]
    v_cvt_pk_bf16_f32 v100, v80, v81
    v_cvt_pk_bf16_f32 v101, v82, v83
    v_cvt_pk_bf16_f32 v102, v84, v85
    v_cvt_pk_bf16_f32 v103, v86, v87
    v_cvt_pk_bf16_f32 v104, v88, v89
    v_cvt_pk_bf16_f32 v105, v90, v91
    v_cvt_pk_bf16_f32 v106, v92, v93
    v_cvt_pk_bf16_f32 v107, v94, v95
    v_cvt_pk_bf16_f32 v108, v96, v97
    v_cvt_pk_bf16_f32 v109, v98, v99
    buffer_store_dwordx4 v[100:103], v160, s[12:15], s101 offen
    buffer_store_dwordx4 v[104:107], v160, s[12:15], s101 offen offset:16
    buffer_store_dwordx2 v[108:109], v161, s[12:15], s101 offen
    s_add_u32 s58, s2, s42
    s_cmp_eq_u32 s58, 0
    s_cselect_b32 s50, 0, s100
    v_mov_b32 v112, s40
    s_mov_b64 exec, 1
    buffer_store_dword v112, off, s[4:7], s50 sc1
    s_mov_b64 exec, -1
L_end:
    s_endpgm
L_code_end:
.section .rodata,"a"
.p2align 6
.amdhsa_kernel adaLN_cond__linear_kernel_hedgehog__glu_gated_swiglu__prompt_kernel
  .amdhsa_next_free_vgpr 512
  .amdhsa_next_free_sgpr 102
  .amdhsa_accum_offset 256
  .amdhsa_group_segment_fixed_size 0
  .amdhsa_kernarg_size 104
  .amdhsa_user_sgpr_count 2
  .amdhsa_user_sgpr_kernarg_segment_ptr 1
  .amdhsa_system_sgpr_workgroup_id_x 1
  .amdhsa_float_denorm_mode_32 3
.end_amdhsa_kernel
```
